```python
import torch

def _softmax(x, axis=-1):
    return torch.softmax(x, dim=axis)
def _gelu(x):
    return torch.nn.functional.gelu(x, approximate="tanh")
def _silu(x):
    return torch.nn.functional.silu(x)
def _sigmoid(x):
    return torch.sigmoid(x)
def _layernorm(x, axis=-1, eps=1e-5):
    m = x.mean(dim=axis, keepdim=True)
    v = x.var(dim=axis, keepdim=True, unbiased=False)
    return (x - m) / torch.sqrt(v + eps)
def _scatter_add(tgt, idx, src, axis=0):
    return tgt.clone().index_add_(axis, idx, src)
def _segment_sum(src, seg, n):
    out = torch.zeros((n,) + src.shape[1:], dtype=src.dtype)
    return out.index_add_(0, seg, src)
def _pad(x, pw):
    flat = tuple(v for pair in reversed(pw) for v in pair)
    return torch.nn.functional.pad(x, flat)

kernel_name = 'interleave_layers__linear_attn_block__grouped_kv_mqa__prompt'

def setup_inputs():

    _w = (lambda a: (lambda t: t.to(torch.bfloat16) if t.is_floating_point() else t)(torch.as_tensor(a)))
    def _A_setup():
        B, S, D = 1, 2048, 512
        return {
            "x": _w((lambda *s: torch.randn(*s, dtype=torch.bfloat16) * 0.05)(B, S, D)),
            "wqkv": _w((lambda *s: torch.randn(*s, dtype=torch.bfloat16) * 0.05)(D, 3 * D)),
            "wo": _w((lambda *s: torch.randn(*s, dtype=torch.bfloat16) * 0.05)(D, D)),
        }
    _A_in = _A_setup()

    def _B_setup():
        B, S, D, H = 1, 2048, 512, 32
        Dh = D // H
        return {
            "x": _w((lambda *s: torch.randn(*s, dtype=torch.bfloat16) * 0.05)(B, S, D)),
            "wq": _w((lambda *s: torch.randn(*s, dtype=torch.bfloat16) * 0.1)(D, H * Dh)),
            "wk": _w((lambda *s: torch.randn(*s, dtype=torch.bfloat16) * 0.1)(D, Dh)),
            "wv": _w((lambda *s: torch.randn(*s, dtype=torch.bfloat16) * 0.05)(D, Dh)),
            "wo": _w((lambda *s: torch.randn(*s, dtype=torch.bfloat16) * 0.05)(H * Dh, D)),
        }
    _B_in = _B_setup()

    return {
        "A_x": _A_in["x"],
        "A_wqkv": _A_in["wqkv"],
        "A_wo": _A_in["wo"],
        "B_x": _B_in["x"],
        "B_wq": _B_in["wq"],
        "B_wk": _B_in["wk"],
        "B_wv": _B_in["wv"],
        "B_wo": _B_in["wo"],
    }

def reference(A_x, A_wqkv, A_wo, B_x, B_wq, B_wk, B_wv, B_wo):
    def _A_ref(x, wqkv, wo):
        B, S, D = x.shape
        H = 32; Dh = D // H
        qkv = (lambda x, *d: x.permute(*d))((x @ wqkv).reshape(B, S, 3, H, Dh), 2, 0, 3, 1, 4)
        q, k, v = qkv[0], qkv[1], qkv[2]
        phi = lambda t: torch.where(t > 0, t + 1, torch.exp(t)) + 1e-6
        pq, pk = phi(q), phi(k)
        kv = torch.einsum("bhsd,bhse->bhde", pk, v)
        z = torch.einsum("bhsd->bhd", pk)
        num = torch.einsum("bhqd,bhde->bhqe", pq, kv)
        den = torch.einsum("bhqd,bhd->bhq", pq, z)[..., None] + 1e-6
        o = num / den
        return (lambda x, *d: x.permute(*d))(o, 0, 2, 1, 3).reshape(B, S, D) @ wo

    def _B_ref(x, wq, wk, wv, wo):
        B, S, D = x.shape
        H = 32
        Dh = D // H
        q = (lambda x, *d: x.permute(*d))((x @ wq).reshape(B, S, H, Dh), 0, 2, 1, 3)
        k = x @ wk
        v = x @ wv
        scores = torch.einsum("bhqd,bkd->bhqk", q, k) * (Dh ** -0.5)
        p = _softmax(scores, axis=-1)
        o = torch.einsum("bhqk,bkd->bhqd", p, v)
        return (lambda x, *d: x.permute(*d))(o, 0, 2, 1, 3).reshape(B, S, H * Dh) @ wo

    x = A_x
    x = x + _A_ref(_layernorm(x, axis=-1), A_wqkv, A_wo)
    x = x + _B_ref(_layernorm(x, axis=-1), B_wq, B_wk, B_wv, B_wo)
    x = x + _A_ref(_layernorm(x, axis=-1), A_wqkv, A_wo)
    x = x + _B_ref(_layernorm(x, axis=-1), B_wq, B_wk, B_wv, B_wo)
    return x
```

```asm
; @launch kernel=k0_kernel grid=(256,1,1) block=(256,1,1) lds=0
; @launch kernel=k4a_kernel grid=(256,1,1) block=(512,1,1) lds=163328
.amdgcn_target "amdgcn-amd-amdhsa--gfx950"
.text
.globl k0_kernel
.p2align 8
.type k0_kernel,@function
k0_kernel:
    s_cmp_ge_u32 s2, 256
    s_cbranch_scc1 k0_end
    s_load_dwordx4 s[4:7], s[0:1], 0
    s_load_dwordx2 s[10:11], s[0:1], 80
    s_load_dwordx2 s[40:41], s[0:1], 16
    s_load_dwordx8 s[44:51], s[0:1], 32
    v_lshrrev_b32 v1, 6, v0
    v_and_b32 v2, 63, v0
    v_readfirstlane_b32 s3, v1
    s_waitcnt lgkmcnt(0)
    s_mov_b32 s20, s10
    s_mov_b32 s21, s11
    s_mov_b32 s22, 0x1300000
    s_mov_b32 s23, 0x20000
    v_lshlrev_b32 v13, 4, v2
    s_cmp_lg_u32 s3, 0
    s_cbranch_scc1 k0_prep
    s_mov_b32 s52, s4
    s_mov_b32 s53, s5
    s_mov_b32 s54, 0x200000
    s_mov_b32 s55, 0x20000
    v_and_b32 v3, 7, v2
    v_lshrrev_b32 v4, 3, v2
    v_lshlrev_b32 v5, 10, v3
    v_lshl_add_u32 v5, v4, 4, v5
    s_and_b32 s28, s2, 7
    s_lshl_b32 s28, s28, 5
    s_lshr_b32 s29, s2, 3
    s_add_u32 s28, s28, s29
    s_lshl_b32 s29, s28, 13
    s_and_b32 s33, s28, 3
    s_lshr_b32 s28, s28, 2
    s_lshl_b32 s28, s28, 15
    buffer_load_dwordx4 v[16:19], v5, s[52:55], s29 offen offset:0
    buffer_load_dwordx4 v[20:23], v5, s[52:55], s29 offen offset:128
    buffer_load_dwordx4 v[24:27], v5, s[52:55], s29 offen offset:256
    buffer_load_dwordx4 v[28:31], v5, s[52:55], s29 offen offset:384
    buffer_load_dwordx4 v[32:35], v5, s[52:55], s29 offen offset:512
    buffer_load_dwordx4 v[36:39], v5, s[52:55], s29 offen offset:640
    buffer_load_dwordx4 v[40:43], v5, s[52:55], s29 offen offset:768
    buffer_load_dwordx4 v[44:47], v5, s[52:55], s29 offen offset:896
    v_lshlrev_b32 v6, 9, v4
    v_lshl_add_u32 v6, v3, 4, v6
    s_lshl_b32 s30, s33, 7
    s_add_u32 s30, s30, s28
    s_add_u32 s30, s30, 0xd00000
    s_mov_b32 s34, 0x3b000000
    s_mov_b32 s35, 0x3727c5ac
    s_add_u32 s31, s29, 0x200000
    s_waitcnt vmcnt(7)
    v_lshlrev_b32 v48, 16, v16
    v_and_b32 v49, 0xffff0000, v16
    v_lshlrev_b32 v50, 16, v17
    v_and_b32 v51, 0xffff0000, v17
    v_lshlrev_b32 v52, 16, v18
    v_and_b32 v53, 0xffff0000, v18
    v_lshlrev_b32 v54, 16, v19
    v_and_b32 v55, 0xffff0000, v19
    v_add_f32 v10, v48, v49
    v_add_f32 v11, v50, v51
    v_add_f32 v12, v52, v53
    v_add_f32 v13, v54, v55
    s_waitcnt vmcnt(6)
    v_lshlrev_b32 v56, 16, v20
    v_and_b32 v57, 0xffff0000, v20
    v_lshlrev_b32 v58, 16, v21
    v_and_b32 v59, 0xffff0000, v21
    v_lshlrev_b32 v60, 16, v22
    v_and_b32 v61, 0xffff0000, v22
    v_lshlrev_b32 v62, 16, v23
    v_and_b32 v63, 0xffff0000, v23
    v_add_f32 v10, v10, v56
    v_add_f32 v10, v10, v57
    v_add_f32 v11, v11, v58
    v_add_f32 v11, v11, v59
    v_add_f32 v12, v12, v60
    v_add_f32 v12, v12, v61
    v_add_f32 v13, v13, v62
    v_add_f32 v13, v13, v63
    s_waitcnt vmcnt(5)
    v_lshlrev_b32 v64, 16, v24
    v_and_b32 v65, 0xffff0000, v24
    v_lshlrev_b32 v66, 16, v25
    v_and_b32 v67, 0xffff0000, v25
    v_lshlrev_b32 v68, 16, v26
    v_and_b32 v69, 0xffff0000, v26
    v_lshlrev_b32 v70, 16, v27
    v_and_b32 v71, 0xffff0000, v27
    v_add_f32 v10, v10, v64
    v_add_f32 v10, v10, v65
    v_add_f32 v11, v11, v66
    v_add_f32 v11, v11, v67
    v_add_f32 v12, v12, v68
    v_add_f32 v12, v12, v69
    v_add_f32 v13, v13, v70
    v_add_f32 v13, v13, v71
    s_waitcnt vmcnt(4)
    v_lshlrev_b32 v72, 16, v28
    v_and_b32 v73, 0xffff0000, v28
    v_lshlrev_b32 v74, 16, v29
    v_and_b32 v75, 0xffff0000, v29
    v_lshlrev_b32 v76, 16, v30
    v_and_b32 v77, 0xffff0000, v30
    v_lshlrev_b32 v78, 16, v31
    v_and_b32 v79, 0xffff0000, v31
    v_add_f32 v10, v10, v72
    v_add_f32 v10, v10, v73
    v_add_f32 v11, v11, v74
    v_add_f32 v11, v11, v75
    v_add_f32 v12, v12, v76
    v_add_f32 v12, v12, v77
    v_add_f32 v13, v13, v78
    v_add_f32 v13, v13, v79
    s_waitcnt vmcnt(3)
    v_lshlrev_b32 v80, 16, v32
    v_and_b32 v81, 0xffff0000, v32
    v_lshlrev_b32 v82, 16, v33
    v_and_b32 v83, 0xffff0000, v33
    v_lshlrev_b32 v84, 16, v34
    v_and_b32 v85, 0xffff0000, v34
    v_lshlrev_b32 v86, 16, v35
    v_and_b32 v87, 0xffff0000, v35
    v_add_f32 v10, v10, v80
    v_add_f32 v10, v10, v81
    v_add_f32 v11, v11, v82
    v_add_f32 v11, v11, v83
    v_add_f32 v12, v12, v84
    v_add_f32 v12, v12, v85
    v_add_f32 v13, v13, v86
    v_add_f32 v13, v13, v87
    s_waitcnt vmcnt(2)
    v_lshlrev_b32 v88, 16, v36
    v_and_b32 v89, 0xffff0000, v36
    v_lshlrev_b32 v90, 16, v37
    v_and_b32 v91, 0xffff0000, v37
    v_lshlrev_b32 v92, 16, v38
    v_and_b32 v93, 0xffff0000, v38
    v_lshlrev_b32 v94, 16, v39
    v_and_b32 v95, 0xffff0000, v39
    v_add_f32 v10, v10, v88
    v_add_f32 v10, v10, v89
    v_add_f32 v11, v11, v90
    v_add_f32 v11, v11, v91
    v_add_f32 v12, v12, v92
    v_add_f32 v12, v12, v93
    v_add_f32 v13, v13, v94
    v_add_f32 v13, v13, v95
    s_waitcnt vmcnt(1)
    v_lshlrev_b32 v96, 16, v40
    v_and_b32 v97, 0xffff0000, v40
    v_lshlrev_b32 v98, 16, v41
    v_and_b32 v99, 0xffff0000, v41
    v_lshlrev_b32 v100, 16, v42
    v_and_b32 v101, 0xffff0000, v42
    v_lshlrev_b32 v102, 16, v43
    v_and_b32 v103, 0xffff0000, v43
    v_add_f32 v10, v10, v96
    v_add_f32 v10, v10, v97
    v_add_f32 v11, v11, v98
    v_add_f32 v11, v11, v99
    v_add_f32 v12, v12, v100
    v_add_f32 v12, v12, v101
    v_add_f32 v13, v13, v102
    v_add_f32 v13, v13, v103
    s_waitcnt vmcnt(0)
    v_lshlrev_b32 v104, 16, v44
    v_and_b32 v105, 0xffff0000, v44
    v_lshlrev_b32 v106, 16, v45
    v_and_b32 v107, 0xffff0000, v45
    v_lshlrev_b32 v108, 16, v46
    v_and_b32 v109, 0xffff0000, v46
    v_lshlrev_b32 v110, 16, v47
    v_and_b32 v111, 0xffff0000, v47
    v_add_f32 v10, v10, v104
    v_add_f32 v10, v10, v105
    v_add_f32 v11, v11, v106
    v_add_f32 v11, v11, v107
    v_add_f32 v12, v12, v108
    v_add_f32 v12, v12, v109
    v_add_f32 v13, v13, v110
    v_add_f32 v13, v13, v111
    v_add_f32 v10, v10, v11
    v_add_f32 v12, v12, v13
    v_add_f32 v10, v10, v12
    s_nop 1
    v_add_f32_dpp v10, v10, v10 row_ror:8 row_mask:0xf bank_mask:0xf
    v_mov_b32 v9, v10
    s_nop 1
    v_permlane16_swap_b32 v10, v9
    v_add_f32 v10, v10, v9
    v_mov_b32 v9, v10
    s_nop 1
    v_permlane32_swap_b32 v10, v9
    v_add_f32 v10, v10, v9
    v_mul_f32 v10, s34, v10
    v_sub_f32 v48, v48, v10
    v_sub_f32 v49, v49, v10
    v_sub_f32 v50, v50, v10
    v_sub_f32 v51, v51, v10
    v_sub_f32 v52, v52, v10
    v_sub_f32 v53, v53, v10
    v_sub_f32 v54, v54, v10
    v_sub_f32 v55, v55, v10
    v_sub_f32 v56, v56, v10
    v_sub_f32 v57, v57, v10
    v_sub_f32 v58, v58, v10
    v_sub_f32 v59, v59, v10
    v_sub_f32 v60, v60, v10
    v_sub_f32 v61, v61, v10
    v_sub_f32 v62, v62, v10
    v_sub_f32 v63, v63, v10
    v_sub_f32 v64, v64, v10
    v_sub_f32 v65, v65, v10
    v_sub_f32 v66, v66, v10
    v_sub_f32 v67, v67, v10
    v_sub_f32 v68, v68, v10
    v_sub_f32 v69, v69, v10
    v_sub_f32 v70, v70, v10
    v_sub_f32 v71, v71, v10
    v_sub_f32 v72, v72, v10
    v_sub_f32 v73, v73, v10
    v_sub_f32 v74, v74, v10
    v_sub_f32 v75, v75, v10
    v_sub_f32 v76, v76, v10
    v_sub_f32 v77, v77, v10
    v_sub_f32 v78, v78, v10
    v_sub_f32 v79, v79, v10
    v_sub_f32 v80, v80, v10
    v_sub_f32 v81, v81, v10
    v_sub_f32 v82, v82, v10
    v_sub_f32 v83, v83, v10
    v_sub_f32 v84, v84, v10
    v_sub_f32 v85, v85, v10
    v_sub_f32 v86, v86, v10
    v_sub_f32 v87, v87, v10
    v_sub_f32 v88, v88, v10
    v_sub_f32 v89, v89, v10
    v_sub_f32 v90, v90, v10
    v_sub_f32 v91, v91, v10
    v_sub_f32 v92, v92, v10
    v_sub_f32 v93, v93, v10
    v_sub_f32 v94, v94, v10
    v_sub_f32 v95, v95, v10
    v_sub_f32 v96, v96, v10
    v_sub_f32 v97, v97, v10
    v_sub_f32 v98, v98, v10
    v_sub_f32 v99, v99, v10
    v_sub_f32 v100, v100, v10
    v_sub_f32 v101, v101, v10
    v_sub_f32 v102, v102, v10
    v_sub_f32 v103, v103, v10
    v_sub_f32 v104, v104, v10
    v_sub_f32 v105, v105, v10
    v_sub_f32 v106, v106, v10
    v_sub_f32 v107, v107, v10
    v_sub_f32 v108, v108, v10
    v_sub_f32 v109, v109, v10
    v_sub_f32 v110, v110, v10
    v_sub_f32 v111, v111, v10
    v_mul_f32 v11, v48, v48
    v_mul_f32 v12, v49, v49
    v_mul_f32 v13, v50, v50
    v_mul_f32 v14, v51, v51
    v_fmac_f32 v11, v52, v52
    v_fmac_f32 v12, v53, v53
    v_fmac_f32 v13, v54, v54
    v_fmac_f32 v14, v55, v55
    v_fmac_f32 v11, v56, v56
    v_fmac_f32 v12, v57, v57
    v_fmac_f32 v13, v58, v58
    v_fmac_f32 v14, v59, v59
    v_fmac_f32 v11, v60, v60
    v_fmac_f32 v12, v61, v61
    v_fmac_f32 v13, v62, v62
    v_fmac_f32 v14, v63, v63
    v_fmac_f32 v11, v64, v64
    v_fmac_f32 v12, v65, v65
    v_fmac_f32 v13, v66, v66
    v_fmac_f32 v14, v67, v67
    v_fmac_f32 v11, v68, v68
    v_fmac_f32 v12, v69, v69
    v_fmac_f32 v13, v70, v70
    v_fmac_f32 v14, v71, v71
    v_fmac_f32 v11, v72, v72
    v_fmac_f32 v12, v73, v73
    v_fmac_f32 v13, v74, v74
    v_fmac_f32 v14, v75, v75
    v_fmac_f32 v11, v76, v76
    v_fmac_f32 v12, v77, v77
    v_fmac_f32 v13, v78, v78
    v_fmac_f32 v14, v79, v79
    v_fmac_f32 v11, v80, v80
    v_fmac_f32 v12, v81, v81
    v_fmac_f32 v13, v82, v82
    v_fmac_f32 v14, v83, v83
    v_fmac_f32 v11, v84, v84
    v_fmac_f32 v12, v85, v85
    v_fmac_f32 v13, v86, v86
    v_fmac_f32 v14, v87, v87
    v_fmac_f32 v11, v88, v88
    v_fmac_f32 v12, v89, v89
    v_fmac_f32 v13, v90, v90
    v_fmac_f32 v14, v91, v91
    v_fmac_f32 v11, v92, v92
    v_fmac_f32 v12, v93, v93
    v_fmac_f32 v13, v94, v94
    v_fmac_f32 v14, v95, v95
    v_fmac_f32 v11, v96, v96
    v_fmac_f32 v12, v97, v97
    v_fmac_f32 v13, v98, v98
    v_fmac_f32 v14, v99, v99
    v_fmac_f32 v11, v100, v100
    v_fmac_f32 v12, v101, v101
    v_fmac_f32 v13, v102, v102
    v_fmac_f32 v14, v103, v103
    v_fmac_f32 v11, v104, v104
    v_fmac_f32 v12, v105, v105
    v_fmac_f32 v13, v106, v106
    v_fmac_f32 v14, v107, v107
    v_fmac_f32 v11, v108, v108
    v_fmac_f32 v12, v109, v109
    v_fmac_f32 v13, v110, v110
    v_fmac_f32 v14, v111, v111
    v_add_f32 v11, v11, v12
    v_add_f32 v13, v13, v14
    v_add_f32 v11, v11, v13
    s_nop 1
    v_add_f32_dpp v11, v11, v11 row_ror:8 row_mask:0xf bank_mask:0xf
    v_mov_b32 v9, v11
    s_nop 1
    v_permlane16_swap_b32 v11, v9
    v_add_f32 v11, v11, v9
    v_mov_b32 v9, v11
    s_nop 1
    v_permlane32_swap_b32 v11, v9
    v_add_f32 v11, v11, v9
    v_mov_b32 v12, s35
    v_fmac_f32 v12, s34, v11
    v_rsq_f32 v12, v12
    s_nop 0
    v_mul_f32 v48, v48, v12
    v_mul_f32 v49, v49, v12
    v_mul_f32 v50, v50, v12
    v_mul_f32 v51, v51, v12
    v_mul_f32 v52, v52, v12
    v_mul_f32 v53, v53, v12
    v_mul_f32 v54, v54, v12
    v_mul_f32 v55, v55, v12
    v_cvt_pk_bf16_f32 v16, v48, v49
    v_cvt_pk_bf16_f32 v17, v50, v51
    v_cvt_pk_bf16_f32 v18, v52, v53
    v_cvt_pk_bf16_f32 v19, v54, v55
    buffer_store_dwordx4 v[16:19], v6, s[20:23], s30 offen
    s_add_u32 s30, s30, 4096
    v_mul_f32 v56, v56, v12
    v_mul_f32 v57, v57, v12
    v_mul_f32 v58, v58, v12
    v_mul_f32 v59, v59, v12
    v_mul_f32 v60, v60, v12
    v_mul_f32 v61, v61, v12
    v_mul_f32 v62, v62, v12
    v_mul_f32 v63, v63, v12
    v_cvt_pk_bf16_f32 v20, v56, v57
    v_cvt_pk_bf16_f32 v21, v58, v59
    v_cvt_pk_bf16_f32 v22, v60, v61
    v_cvt_pk_bf16_f32 v23, v62, v63
    buffer_store_dwordx4 v[20:23], v6, s[20:23], s30 offen
    s_add_u32 s30, s30, 4096
    v_mul_f32 v64, v64, v12
    v_mul_f32 v65, v65, v12
    v_mul_f32 v66, v66, v12
    v_mul_f32 v67, v67, v12
    v_mul_f32 v68, v68, v12
    v_mul_f32 v69, v69, v12
    v_mul_f32 v70, v70, v12
    v_mul_f32 v71, v71, v12
    v_cvt_pk_bf16_f32 v24, v64, v65
    v_cvt_pk_bf16_f32 v25, v66, v67
    v_cvt_pk_bf16_f32 v26, v68, v69
    v_cvt_pk_bf16_f32 v27, v70, v71
    buffer_store_dwordx4 v[24:27], v6, s[20:23], s30 offen
    s_add_u32 s30, s30, 4096
    v_mul_f32 v72, v72, v12
    v_mul_f32 v73, v73, v12
    v_mul_f32 v74, v74, v12
    v_mul_f32 v75, v75, v12
    v_mul_f32 v76, v76, v12
    v_mul_f32 v77, v77, v12
    v_mul_f32 v78, v78, v12
    v_mul_f32 v79, v79, v12
    v_cvt_pk_bf16_f32 v28, v72, v73
    v_cvt_pk_bf16_f32 v29, v74, v75
    v_cvt_pk_bf16_f32 v30, v76, v77
    v_cvt_pk_bf16_f32 v31, v78, v79
    buffer_store_dwordx4 v[28:31], v6, s[20:23], s30 offen
    s_add_u32 s30, s30, 4096
    v_mul_f32 v80, v80, v12
    v_mul_f32 v81, v81, v12
    v_mul_f32 v82, v82, v12
    v_mul_f32 v83, v83, v12
    v_mul_f32 v84, v84, v12
    v_mul_f32 v85, v85, v12
    v_mul_f32 v86, v86, v12
    v_mul_f32 v87, v87, v12
    v_cvt_pk_bf16_f32 v32, v80, v81
    v_cvt_pk_bf16_f32 v33, v82, v83
    v_cvt_pk_bf16_f32 v34, v84, v85
    v_cvt_pk_bf16_f32 v35, v86, v87
    buffer_store_dwordx4 v[32:35], v6, s[20:23], s30 offen
    s_add_u32 s30, s30, 4096
    v_mul_f32 v88, v88, v12
    v_mul_f32 v89, v89, v12
    v_mul_f32 v90, v90, v12
    v_mul_f32 v91, v91, v12
    v_mul_f32 v92, v92, v12
    v_mul_f32 v93, v93, v12
    v_mul_f32 v94, v94, v12
    v_mul_f32 v95, v95, v12
    v_cvt_pk_bf16_f32 v36, v88, v89
    v_cvt_pk_bf16_f32 v37, v90, v91
    v_cvt_pk_bf16_f32 v38, v92, v93
    v_cvt_pk_bf16_f32 v39, v94, v95
    buffer_store_dwordx4 v[36:39], v6, s[20:23], s30 offen
    s_add_u32 s30, s30, 4096
    v_mul_f32 v96, v96, v12
    v_mul_f32 v97, v97, v12
    v_mul_f32 v98, v98, v12
    v_mul_f32 v99, v99, v12
    v_mul_f32 v100, v100, v12
    v_mul_f32 v101, v101, v12
    v_mul_f32 v102, v102, v12
    v_mul_f32 v103, v103, v12
    v_cvt_pk_bf16_f32 v40, v96, v97
    v_cvt_pk_bf16_f32 v41, v98, v99
    v_cvt_pk_bf16_f32 v42, v100, v101
    v_cvt_pk_bf16_f32 v43, v102, v103
    buffer_store_dwordx4 v[40:43], v6, s[20:23], s30 offen
    s_add_u32 s30, s30, 4096
    v_mul_f32 v104, v104, v12
    v_mul_f32 v105, v105, v12
    v_mul_f32 v106, v106, v12
    v_mul_f32 v107, v107, v12
    v_mul_f32 v108, v108, v12
    v_mul_f32 v109, v109, v12
    v_mul_f32 v110, v110, v12
    v_mul_f32 v111, v111, v12
    v_cvt_pk_bf16_f32 v44, v104, v105
    v_cvt_pk_bf16_f32 v45, v106, v107
    v_cvt_pk_bf16_f32 v46, v108, v109
    v_cvt_pk_bf16_f32 v47, v110, v111
    buffer_store_dwordx4 v[44:47], v6, s[20:23], s30 offen
    s_endpgm
k0_prep:
    s_mul_i32 s28, s2, 3
    s_add_u32 s28, s28, s3
    s_sub_u32 s28, s28, 1
    s_cmp_ge_u32 s28, 642
    s_cbranch_scc1 k0_end
    s_cmp_ge_u32 s28, 474
    s_cbranch_scc1 k0_early
    s_cmp_ge_u32 s28, 384
    s_cbranch_scc1 k0_zero
    s_and_b32 s30, s28, 3
    s_lshl_b32 s30, s30, 2
    s_lshr_b32 s28, s28, 2
    s_add_u32 s28, s28, 98
    s_branch k0_pqkv
k0_early:
    s_sub_u32 s28, s28, 474
    s_lshl_b32 s29, s28, 2
    s_movk_i32 s34, 1024
    s_mov_b32 s55, 0x20000
    s_mov_b32 s54, 0x80000
    s_cmp_ge_u32 s28, 160
    s_cbranch_scc1 k0_ewkv
    s_lshl_b32 s31, s29, 10
    s_add_u32 s31, s31, 0x800000
    s_cmp_ge_u32 s28, 128
    s_cbranch_scc1 k0_ewq
    s_mov_b32 s52, s40
    s_mov_b32 s53, s41
    v_and_b32 v3, 31, v2
    v_lshrrev_b32 v4, 5, v2
    v_lshlrev_b32 v4, 12, v4
    v_lshl_add_u32 v4, v3, 1, v4
    v_add_u32 v5, 8192, v4
    s_and_b32 s32, s29, 31
    s_lshl_b32 s32, s32, 14
    s_lshr_b32 s33, s29, 5
    s_lshl_b32 s33, s33, 6
    s_add_u32 s32, s32, s33
    buffer_load_ushort v16, v4, s[52:55], s32 offen offset:0
    buffer_load_ushort v32, v4, s[52:55], s32 offen offset:1024
    buffer_load_ushort v17, v4, s[52:55], s32 offen offset:2048
    buffer_load_ushort v33, v4, s[52:55], s32 offen offset:3072
    buffer_load_ushort v18, v5, s[52:55], s32 offen offset:0
    buffer_load_ushort v34, v5, s[52:55], s32 offen offset:1024
    buffer_load_ushort v19, v5, s[52:55], s32 offen offset:2048
    buffer_load_ushort v35, v5, s[52:55], s32 offen offset:3072
    s_add_u32 s32, s32, 0x4000
    buffer_load_ushort v20, v4, s[52:55], s32 offen offset:0
    buffer_load_ushort v36, v4, s[52:55], s32 offen offset:1024
    buffer_load_ushort v21, v4, s[52:55], s32 offen offset:2048
    buffer_load_ushort v37, v4, s[52:55], s32 offen offset:3072
    buffer_load_ushort v22, v5, s[52:55], s32 offen offset:0
    buffer_load_ushort v38, v5, s[52:55], s32 offen offset:1024
    buffer_load_ushort v23, v5, s[52:55], s32 offen offset:2048
    buffer_load_ushort v39, v5, s[52:55], s32 offen offset:3072
    s_add_u32 s32, s32, 0x4000
    buffer_load_ushort v24, v4, s[52:55], s32 offen offset:0
    buffer_load_ushort v40, v4, s[52:55], s32 offen offset:1024
    buffer_load_ushort v25, v4, s[52:55], s32 offen offset:2048
    buffer_load_ushort v41, v4, s[52:55], s32 offen offset:3072
    buffer_load_ushort v26, v5, s[52:55], s32 offen offset:0
    buffer_load_ushort v42, v5, s[52:55], s32 offen offset:1024
    buffer_load_ushort v27, v5, s[52:55], s32 offen offset:2048
    buffer_load_ushort v43, v5, s[52:55], s32 offen offset:3072
    s_add_u32 s32, s32, 0x4000
    buffer_load_ushort v28, v4, s[52:55], s32 offen offset:0
    buffer_load_ushort v44, v4, s[52:55], s32 offen offset:1024
    buffer_load_ushort v29, v4, s[52:55], s32 offen offset:2048
    buffer_load_ushort v45, v4, s[52:55], s32 offen offset:3072
    buffer_load_ushort v30, v5, s[52:55], s32 offen offset:0
    buffer_load_ushort v46, v5, s[52:55], s32 offen offset:1024
    buffer_load_ushort v31, v5, s[52:55], s32 offen offset:2048
    buffer_load_ushort v47, v5, s[52:55], s32 offen offset:3072
    s_branch k0_pst2
k0_ewq:
    s_and_b32 s29, s29, 511
    s_mov_b32 s52, s44
    s_mov_b32 s53, s45
    v_and_b32 v3, 15, v2
    v_lshrrev_b32 v4, 4, v2
    v_lshlrev_b32 v4, 13, v4
    v_lshl_add_u32 v4, v3, 1, v4
    v_add_u32 v5, 4096, v4
    s_and_b32 s32, s29, 15
    s_lshl_b32 s32, s32, 15
    s_lshr_b32 s33, s29, 4
    s_lshl_b32 s33, s33, 5
    s_add_u32 s32, s32, s33
    buffer_load_ushort v16, v4, s[52:55], s32 offen offset:0
    buffer_load_ushort v32, v4, s[52:55], s32 offen offset:1024
    buffer_load_ushort v17, v4, s[52:55], s32 offen offset:2048
    buffer_load_ushort v33, v4, s[52:55], s32 offen offset:3072
    buffer_load_ushort v18, v5, s[52:55], s32 offen offset:0
    buffer_load_ushort v34, v5, s[52:55], s32 offen offset:1024
    buffer_load_ushort v19, v5, s[52:55], s32 offen offset:2048
    buffer_load_ushort v35, v5, s[52:55], s32 offen offset:3072
    s_add_u32 s32, s32, 0x8000
    buffer_load_ushort v20, v4, s[52:55], s32 offen offset:0
    buffer_load_ushort v36, v4, s[52:55], s32 offen offset:1024
    buffer_load_ushort v21, v4, s[52:55], s32 offen offset:2048
    buffer_load_ushort v37, v4, s[52:55], s32 offen offset:3072
    buffer_load_ushort v22, v5, s[52:55], s32 offen offset:0
    buffer_load_ushort v38, v5, s[52:55], s32 offen offset:1024
    buffer_load_ushort v23, v5, s[52:55], s32 offen offset:2048
    buffer_load_ushort v39, v5, s[52:55], s32 offen offset:3072
    s_add_u32 s32, s32, 0x8000
    buffer_load_ushort v24, v4, s[52:55], s32 offen offset:0
    buffer_load_ushort v40, v4, s[52:55], s32 offen offset:1024
    buffer_load_ushort v25, v4, s[52:55], s32 offen offset:2048
    buffer_load_ushort v41, v4, s[52:55], s32 offen offset:3072
    buffer_load_ushort v26, v5, s[52:55], s32 offen offset:0
    buffer_load_ushort v42, v5, s[52:55], s32 offen offset:1024
    buffer_load_ushort v27, v5, s[52:55], s32 offen offset:2048
    buffer_load_ushort v43, v5, s[52:55], s32 offen offset:3072
    s_add_u32 s32, s32, 0x8000
    buffer_load_ushort v28, v4, s[52:55], s32 offen offset:0
    buffer_load_ushort v44, v4, s[52:55], s32 offen offset:1024
    buffer_load_ushort v29, v4, s[52:55], s32 offen offset:2048
    buffer_load_ushort v45, v4, s[52:55], s32 offen offset:3072
    buffer_load_ushort v30, v5, s[52:55], s32 offen offset:0
    buffer_load_ushort v46, v5, s[52:55], s32 offen offset:1024
    buffer_load_ushort v31, v5, s[52:55], s32 offen offset:2048
    buffer_load_ushort v47, v5, s[52:55], s32 offen offset:3072
    s_branch k0_pst2
k0_ewkv:
    s_sub_u32 s29, s29, 640
    s_lshl_b32 s31, s29, 10
    s_add_u32 s31, s31, 0x980000
    s_cmp_lt_u32 s29, 16
    s_cselect_b32 s52, s46, s48
    s_cselect_b32 s53, s47, s49
    s_mov_b32 s54, 0x4000
    v_and_b32 v3, 15, v2
    v_lshrrev_b32 v4, 4, v2
    v_lshlrev_b32 v4, 8, v4
    v_lshl_add_u32 v4, v3, 1, v4
    s_and_b32 s32, s29, 15
    s_lshl_b32 s32, s32, 10
    buffer_load_ushort v16, v4, s[52:55], s32 offen offset:0
    buffer_load_ushort v32, v4, s[52:55], s32 offen offset:32
    buffer_load_ushort v17, v4, s[52:55], s32 offen offset:64
    buffer_load_ushort v33, v4, s[52:55], s32 offen offset:96
    buffer_load_ushort v18, v4, s[52:55], s32 offen offset:128
    buffer_load_ushort v34, v4, s[52:55], s32 offen offset:160
    buffer_load_ushort v19, v4, s[52:55], s32 offen offset:192
    buffer_load_ushort v35, v4, s[52:55], s32 offen offset:224
    buffer_load_ushort v20, v4, s[52:55], s32 offen offset:1024
    buffer_load_ushort v36, v4, s[52:55], s32 offen offset:1056
    buffer_load_ushort v21, v4, s[52:55], s32 offen offset:1088
    buffer_load_ushort v37, v4, s[52:55], s32 offen offset:1120
    buffer_load_ushort v22, v4, s[52:55], s32 offen offset:1152
    buffer_load_ushort v38, v4, s[52:55], s32 offen offset:1184
    buffer_load_ushort v23, v4, s[52:55], s32 offen offset:1216
    buffer_load_ushort v39, v4, s[52:55], s32 offen offset:1248
    buffer_load_ushort v24, v4, s[52:55], s32 offen offset:2048
    buffer_load_ushort v40, v4, s[52:55], s32 offen offset:2080
    buffer_load_ushort v25, v4, s[52:55], s32 offen offset:2112
    buffer_load_ushort v41, v4, s[52:55], s32 offen offset:2144
    buffer_load_ushort v26, v4, s[52:55], s32 offen offset:2176
    buffer_load_ushort v42, v4, s[52:55], s32 offen offset:2208
    buffer_load_ushort v27, v4, s[52:55], s32 offen offset:2240
    buffer_load_ushort v43, v4, s[52:55], s32 offen offset:2272
    buffer_load_ushort v28, v4, s[52:55], s32 offen offset:3072
    buffer_load_ushort v44, v4, s[52:55], s32 offen offset:3104
    buffer_load_ushort v29, v4, s[52:55], s32 offen offset:3136
    buffer_load_ushort v45, v4, s[52:55], s32 offen offset:3168
    buffer_load_ushort v30, v4, s[52:55], s32 offen offset:3200
    buffer_load_ushort v46, v4, s[52:55], s32 offen offset:3232
    buffer_load_ushort v31, v4, s[52:55], s32 offen offset:3264
    buffer_load_ushort v47, v4, s[52:55], s32 offen offset:3296
k0_pst2:
    s_waitcnt vmcnt(24)
    v_lshl_or_b32 v16, v32, 16, v16
    v_lshl_or_b32 v17, v33, 16, v17
    v_lshl_or_b32 v18, v34, 16, v18
    v_lshl_or_b32 v19, v35, 16, v19
    buffer_store_dwordx4 v[16:19], v13, s[20:23], s31 offen
    s_add_u32 s31, s31, s34
    s_waitcnt vmcnt(17)
    v_lshl_or_b32 v20, v36, 16, v20
    v_lshl_or_b32 v21, v37, 16, v21
    v_lshl_or_b32 v22, v38, 16, v22
    v_lshl_or_b32 v23, v39, 16, v23
    buffer_store_dwordx4 v[20:23], v13, s[20:23], s31 offen
    s_add_u32 s31, s31, s34
    s_waitcnt vmcnt(10)
    v_lshl_or_b32 v24, v40, 16, v24
    v_lshl_or_b32 v25, v41, 16, v25
    v_lshl_or_b32 v26, v42, 16, v26
    v_lshl_or_b32 v27, v43, 16, v27
    buffer_store_dwordx4 v[24:27], v13, s[20:23], s31 offen
    s_add_u32 s31, s31, s34
    s_waitcnt vmcnt(3)
    v_lshl_or_b32 v28, v44, 16, v28
    v_lshl_or_b32 v29, v45, 16, v29
    v_lshl_or_b32 v30, v46, 16, v30
    v_lshl_or_b32 v31, v47, 16, v31
    buffer_store_dwordx4 v[28:31], v13, s[20:23], s31 offen
    s_add_u32 s31, s31, s34
    s_endpgm
k0_pqkv:
    s_sub_u32 s28, s28, 98
    s_mov_b32 s52, s6
    s_mov_b32 s53, s7
    s_mov_b32 s54, 0x180000
    s_mov_b32 s55, 0x20000
    s_lshr_b32 s33, s28, 5
    s_bfe_u32 s34, s28, 0x40001
    s_and_b32 s35, s28, 1
    s_lshl_b32 s35, s35, 4
    s_add_u32 s35, s35, s30
    s_mul_i32 s32, s35, 49152
    s_lshl_b32 s36, s33, 10
    s_add_u32 s32, s32, s36
    s_lshl_b32 s37, s34, 6
    s_add_u32 s32, s32, s37
    s_mul_i32 s31, s34, 98304
    s_lshl_b32 s37, s35, 11
    s_add_u32 s37, s37, s36
    s_sub_u32 s37, s37, 1024
    s_lshl_b32 s38, s35, 10
    s_add_u32 s38, s38, 65536
    s_cmp_eq_u32 s33, 0
    s_cselect_b32 s37, s38, s37
    s_movk_i32 s34, 2048
    s_cselect_b32 s34, 1024, s34
    s_add_u32 s31, s31, s37
    s_add_u32 s31, s31, 0xb00000
    v_and_b32 v3, 31, v2
    v_lshrrev_b32 v4, 5, v2
    v_mul_u32_u24 v4, 24576, v4
    v_lshl_add_u32 v4, v3, 1, v4
    v_add_u32 v5, 6144, v4
    v_add_u32 v6, 12288, v4
    v_add_u32 v7, 18432, v4
    buffer_load_ushort v16, v4, s[52:55], s32 offen offset:0
    buffer_load_ushort v32, v4, s[52:55], s32 offen offset:3072
    buffer_load_ushort v17, v5, s[52:55], s32 offen offset:0
    buffer_load_ushort v33, v5, s[52:55], s32 offen offset:3072
    buffer_load_ushort v18, v6, s[52:55], s32 offen offset:0
    buffer_load_ushort v34, v6, s[52:55], s32 offen offset:3072
    buffer_load_ushort v19, v7, s[52:55], s32 offen offset:0
    buffer_load_ushort v35, v7, s[52:55], s32 offen offset:3072
    s_add_u32 s32, s32, 49152
    buffer_load_ushort v20, v4, s[52:55], s32 offen offset:0
    buffer_load_ushort v36, v4, s[52:55], s32 offen offset:3072
    buffer_load_ushort v21, v5, s[52:55], s32 offen offset:0
    buffer_load_ushort v37, v5, s[52:55], s32 offen offset:3072
    buffer_load_ushort v22, v6, s[52:55], s32 offen offset:0
    buffer_load_ushort v38, v6, s[52:55], s32 offen offset:3072
    buffer_load_ushort v23, v7, s[52:55], s32 offen offset:0
    buffer_load_ushort v39, v7, s[52:55], s32 offen offset:3072
    s_add_u32 s32, s32, 49152
    buffer_load_ushort v24, v4, s[52:55], s32 offen offset:0
    buffer_load_ushort v40, v4, s[52:55], s32 offen offset:3072
    buffer_load_ushort v25, v5, s[52:55], s32 offen offset:0
    buffer_load_ushort v41, v5, s[52:55], s32 offen offset:3072
    buffer_load_ushort v26, v6, s[52:55], s32 offen offset:0
    buffer_load_ushort v42, v6, s[52:55], s32 offen offset:3072
    buffer_load_ushort v27, v7, s[52:55], s32 offen offset:0
    buffer_load_ushort v43, v7, s[52:55], s32 offen offset:3072
    s_add_u32 s32, s32, 49152
    buffer_load_ushort v28, v4, s[52:55], s32 offen offset:0
    buffer_load_ushort v44, v4, s[52:55], s32 offen offset:3072
    buffer_load_ushort v29, v5, s[52:55], s32 offen offset:0
    buffer_load_ushort v45, v5, s[52:55], s32 offen offset:3072
    buffer_load_ushort v30, v6, s[52:55], s32 offen offset:0
    buffer_load_ushort v46, v6, s[52:55], s32 offen offset:3072
    buffer_load_ushort v31, v7, s[52:55], s32 offen offset:0
    buffer_load_ushort v47, v7, s[52:55], s32 offen offset:3072
    s_branch k0_pst2
k0_zero:
    v_mov_b32 v16, 0
    v_mov_b32 v17, 0
    v_mov_b32 v18, 0
    v_mov_b32 v19, 0
    s_lshl_b32 s31, s28, 10
    s_add_u32 s31, s31, 0x950000
    buffer_store_dwordx4 v[16:19], v13, s[20:23], s31 offen
k0_end:
    s_endpgm
.globl k4a_kernel
.p2align 8
.type k4a_kernel,@function
k4a_kernel:
    s_cmp_ge_u32 s2, 256
    s_cbranch_scc1 k1a_end
    s_load_dwordx2 s[4:5], s[0:1], 64
    s_load_dwordx2 s[6:7], s[0:1], 0
    s_load_dwordx2 s[10:11], s[0:1], 80
    s_load_dwordx2 s[60:61], s[0:1], 16
    s_load_dwordx8 s[76:83], s[0:1], 32
    v_lshrrev_b32 v1, 6, v0
    v_and_b32 v2, 63, v0
    v_readfirstlane_b32 s3, v1
    v_lshlrev_b32 v5, 4, v2
    s_and_b32 s28, s2, 7
    s_lshl_b32 s28, s28, 1
    s_bfe_u32 s29, s2, 0x10003
    s_add_u32 s28, s28, s29
    s_lshr_b32 s29, s2, 4
    s_lshl_b32 s34, s28, 2
    s_add_u32 s34, s34, s3
    s_lshl_b32 s30, s34, 15
    s_add_u32 s30, s30, 0xd00000
    s_mov_b32 s41, s30
    s_lshl_b32 s32, s3, 11
    s_mul_i32 s31, s29, 98304
    s_add_u32 s31, s31, s32
    s_add_u32 s31, s31, 0xb00000
    s_waitcnt lgkmcnt(0)
    s_mov_b32 s20, s10
    s_mov_b32 s21, s11
    s_mov_b32 s22, 0x1300000
    s_mov_b32 s23, 0x20000
    s_cmp_ge_u32 s3, 4
    s_cbranch_scc1 k1a_help
    s_mov_b32 m0, s32
    s_nop 0
    buffer_load_dwordx4 v5, s[20:23], s31 offen offset:0 lds
    buffer_load_dwordx4 v5, s[20:23], s31 offen offset:1024 lds
    buffer_load_dwordx4 v[16:19], v5, s[20:23], s30 offen offset:0
    buffer_load_dwordx4 v[20:23], v5, s[20:23], s30 offen offset:1024
    buffer_load_dwordx4 v[24:27], v5, s[20:23], s30 offen offset:2048
    buffer_load_dwordx4 v[28:31], v5, s[20:23], s30 offen offset:3072
    s_add_u32 s30, s30, 4096
    s_add_u32 s31, s31, 8192
    s_add_u32 s32, s32, 8192
    s_mov_b32 m0, s32
    s_nop 0
    buffer_load_dwordx4 v5, s[20:23], s31 offen offset:0 lds
    buffer_load_dwordx4 v5, s[20:23], s31 offen offset:1024 lds
    buffer_load_dwordx4 v[32:35], v5, s[20:23], s30 offen offset:0
    buffer_load_dwordx4 v[36:39], v5, s[20:23], s30 offen offset:1024
    buffer_load_dwordx4 v[40:43], v5, s[20:23], s30 offen offset:2048
    buffer_load_dwordx4 v[44:47], v5, s[20:23], s30 offen offset:3072
    s_add_u32 s30, s30, 4096
    s_add_u32 s31, s31, 8192
    s_add_u32 s32, s32, 8192
    s_mov_b32 m0, s32
    s_nop 0
    buffer_load_dwordx4 v5, s[20:23], s31 offen offset:0 lds
    buffer_load_dwordx4 v5, s[20:23], s31 offen offset:1024 lds
    buffer_load_dwordx4 v[48:51], v5, s[20:23], s30 offen offset:0
    buffer_load_dwordx4 v[52:55], v5, s[20:23], s30 offen offset:1024
    buffer_load_dwordx4 v[56:59], v5, s[20:23], s30 offen offset:2048
    buffer_load_dwordx4 v[60:63], v5, s[20:23], s30 offen offset:3072
    s_add_u32 s30, s30, 4096
    s_add_u32 s31, s31, 8192
    s_add_u32 s32, s32, 8192
    v_add_u32 v6, 49152, v5
    v_add_u32 v8, 122880, v5
    s_mov_b32 s70, 0
    v_mov_b32 v208, 0x3f803f80
    v_mov_b32 v209, 0x3f803f80
    v_mov_b32 v210, 0x3f803f80
    v_mov_b32 v211, 0x3f803f80
    s_mov_b32 s36, 0x3fb8aa3b
    s_mov_b32 s37, 0x358637bd
    v_lshrrev_b32 v4, 5, v2
    s_mul_i32 s38, s3, 2176
    s_add_u32 s38, s38, 98304
    v_add_u32 v12, s38, v5
    v_and_b32 v15, 19, v2
    v_bfe_u32 v7, v2, 2, 1
    v_lshl_add_u32 v15, v7, 3, v15
    v_bfe_u32 v7, v2, 3, 1
    v_lshl_add_u32 v15, v7, 2, v15
    v_lshl_add_u32 v15, v15, 2, s38
    s_mov_b32 s42, 0x0000ffff
    s_mov_b32 s43, 0x0000ffff
    s_mov_b32 s44, 1
    s_mov_b32 s45, 1
    v_lshlrev_b32 v13, 2, v0
    v_add_u32 v14, 98304, v13
    s_mul_i32 s38, s29, 2176
    s_add_u32 s38, s38, 0x9b0000
    s_lshl_b32 s39, s34, 15
    s_lshl_b32 s40, s29, 11
    s_add_u32 s39, s39, s40
    v_cmp_gt_u32 s[46:47], 32, v0
    s_waitcnt vmcnt(12)
    s_barrier
    ds_read_b128 v[192:195], v5 offset:0
    ds_read_b128 v[196:199], v5 offset:1024
    s_mov_b32 m0, s32
    s_nop 0
    buffer_load_dwordx4 v5, s[20:23], s31 offen offset:0 lds
    buffer_load_dwordx4 v5, s[20:23], s31 offen offset:1024 lds
    buffer_load_dwordx4 v[64:67], v5, s[20:23], s30 offen offset:0
    buffer_load_dwordx4 v[68:71], v5, s[20:23], s30 offen offset:1024
    buffer_load_dwordx4 v[72:75], v5, s[20:23], s30 offen offset:2048
    buffer_load_dwordx4 v[76:79], v5, s[20:23], s30 offen offset:3072
    s_add_u32 s30, s30, 4096
    s_add_u32 s31, s31, 8192
    s_add_u32 s32, s32, 8192
    ds_read_b128 v[200:203], v5 offset:2048
    ds_read_b128 v[204:207], v5 offset:3072
    s_waitcnt lgkmcnt(2)
    v_mfma_f32_32x32x16_bf16 v[160:175], v[16:19], v[192:195], 0
    v_mfma_f32_32x32x16_bf16 v[176:191], v[16:19], v[196:199], 0
    ds_read_b128 v[192:195], v5 offset:4096
    ds_read_b128 v[196:199], v5 offset:5120
    s_waitcnt lgkmcnt(2)
    v_mfma_f32_32x32x16_bf16 v[160:175], v[20:23], v[200:203], v[160:175]
    v_mfma_f32_32x32x16_bf16 v[176:191], v[20:23], v[204:207], v[176:191]
    ds_read_b128 v[200:203], v5 offset:6144
    ds_read_b128 v[204:207], v5 offset:7168
    s_waitcnt lgkmcnt(2)
    v_mfma_f32_32x32x16_bf16 v[160:175], v[24:27], v[192:195], v[160:175]
    v_mfma_f32_32x32x16_bf16 v[176:191], v[24:27], v[196:199], v[176:191]
    s_waitcnt lgkmcnt(0)
    v_mfma_f32_32x32x16_bf16 v[160:175], v[28:31], v[200:203], v[160:175]
    v_mfma_f32_32x32x16_bf16 v[176:191], v[28:31], v[204:207], v[176:191]
    s_waitcnt vmcnt(12)
    s_barrier
    ds_read_b128 v[192:195], v5 offset:8192
    ds_read_b128 v[196:199], v5 offset:9216
    s_mov_b32 m0, s32
    s_nop 0
    buffer_load_dwordx4 v5, s[20:23], s31 offen offset:0 lds
    buffer_load_dwordx4 v5, s[20:23], s31 offen offset:1024 lds
    buffer_load_dwordx4 v[80:83], v5, s[20:23], s30 offen offset:0
    buffer_load_dwordx4 v[84:87], v5, s[20:23], s30 offen offset:1024
    buffer_load_dwordx4 v[88:91], v5, s[20:23], s30 offen offset:2048
    buffer_load_dwordx4 v[92:95], v5, s[20:23], s30 offen offset:3072
    s_add_u32 s30, s30, 4096
    s_add_u32 s31, s31, 8192
    s_add_u32 s32, s32, 8192
    ds_read_b128 v[200:203], v5 offset:10240
    ds_read_b128 v[204:207], v5 offset:11264
    s_waitcnt lgkmcnt(2)
    v_mfma_f32_32x32x16_bf16 v[160:175], v[32:35], v[192:195], v[160:175]
    v_mfma_f32_32x32x16_bf16 v[176:191], v[32:35], v[196:199], v[176:191]
    ds_read_b128 v[192:195], v5 offset:12288
    ds_read_b128 v[196:199], v5 offset:13312
    s_waitcnt lgkmcnt(2)
    v_mfma_f32_32x32x16_bf16 v[160:175], v[36:39], v[200:203], v[160:175]
    v_mfma_f32_32x32x16_bf16 v[176:191], v[36:39], v[204:207], v[176:191]
    ds_read_b128 v[200:203], v5 offset:14336
    ds_read_b128 v[204:207], v5 offset:15360
    s_waitcnt lgkmcnt(2)
    v_mfma_f32_32x32x16_bf16 v[160:175], v[40:43], v[192:195], v[160:175]
    v_mfma_f32_32x32x16_bf16 v[176:191], v[40:43], v[196:199], v[176:191]
    s_waitcnt lgkmcnt(0)
    v_mfma_f32_32x32x16_bf16 v[160:175], v[44:47], v[200:203], v[160:175]
    v_mfma_f32_32x32x16_bf16 v[176:191], v[44:47], v[204:207], v[176:191]
    s_waitcnt vmcnt(12)
    s_barrier
    ds_read_b128 v[192:195], v5 offset:16384
    ds_read_b128 v[196:199], v5 offset:17408
    s_mov_b32 m0, s32
    s_nop 0
    buffer_load_dwordx4 v5, s[20:23], s31 offen offset:0 lds
    buffer_load_dwordx4 v5, s[20:23], s31 offen offset:1024 lds
    buffer_load_dwordx4 v[96:99], v5, s[20:23], s30 offen offset:0
    buffer_load_dwordx4 v[100:103], v5, s[20:23], s30 offen offset:1024
    buffer_load_dwordx4 v[104:107], v5, s[20:23], s30 offen offset:2048
    buffer_load_dwordx4 v[108:111], v5, s[20:23], s30 offen offset:3072
    s_add_u32 s30, s30, 4096
    s_add_u32 s31, s31, 8192
    s_add_u32 s32, s32, 8192
    ds_read_b128 v[200:203], v5 offset:18432
    ds_read_b128 v[204:207], v5 offset:19456
    s_waitcnt lgkmcnt(2)
    v_mfma_f32_32x32x16_bf16 v[160:175], v[48:51], v[192:195], v[160:175]
    v_mfma_f32_32x32x16_bf16 v[176:191], v[48:51], v[196:199], v[176:191]
    ds_read_b128 v[192:195], v5 offset:20480
    ds_read_b128 v[196:199], v5 offset:21504
    s_waitcnt lgkmcnt(2)
    v_mfma_f32_32x32x16_bf16 v[160:175], v[52:55], v[200:203], v[160:175]
    v_mfma_f32_32x32x16_bf16 v[176:191], v[52:55], v[204:207], v[176:191]
    ds_read_b128 v[200:203], v5 offset:22528
    ds_read_b128 v[204:207], v5 offset:23552
    s_waitcnt lgkmcnt(2)
    v_mfma_f32_32x32x16_bf16 v[160:175], v[56:59], v[192:195], v[160:175]
    v_mfma_f32_32x32x16_bf16 v[176:191], v[56:59], v[196:199], v[176:191]
    s_waitcnt lgkmcnt(0)
    v_mfma_f32_32x32x16_bf16 v[160:175], v[60:63], v[200:203], v[160:175]
    v_mfma_f32_32x32x16_bf16 v[176:191], v[60:63], v[204:207], v[176:191]
    s_waitcnt vmcnt(12)
    s_barrier
    ds_read_b128 v[192:195], v5 offset:24576
    ds_read_b128 v[196:199], v5 offset:25600
    s_mov_b32 m0, s32
    s_nop 0
    buffer_load_dwordx4 v5, s[20:23], s31 offen offset:0 lds
    buffer_load_dwordx4 v5, s[20:23], s31 offen offset:1024 lds
    buffer_load_dwordx4 v[112:115], v5, s[20:23], s30 offen offset:0
    buffer_load_dwordx4 v[116:119], v5, s[20:23], s30 offen offset:1024
    buffer_load_dwordx4 v[120:123], v5, s[20:23], s30 offen offset:2048
    buffer_load_dwordx4 v[124:127], v5, s[20:23], s30 offen offset:3072
    s_add_u32 s30, s30, 4096
    s_add_u32 s31, s31, 8192
    s_add_u32 s32, s32, 8192
    ds_read_b128 v[200:203], v5 offset:26624
    ds_read_b128 v[204:207], v5 offset:27648
    s_waitcnt lgkmcnt(2)
    v_mfma_f32_32x32x16_bf16 v[160:175], v[64:67], v[192:195], v[160:175]
    v_mfma_f32_32x32x16_bf16 v[176:191], v[64:67], v[196:199], v[176:191]
    ds_read_b128 v[192:195], v5 offset:28672
    ds_read_b128 v[196:199], v5 offset:29696
    s_waitcnt lgkmcnt(2)
    v_mfma_f32_32x32x16_bf16 v[160:175], v[68:71], v[200:203], v[160:175]
    v_mfma_f32_32x32x16_bf16 v[176:191], v[68:71], v[204:207], v[176:191]
    ds_read_b128 v[200:203], v5 offset:30720
    ds_read_b128 v[204:207], v5 offset:31744
    s_waitcnt lgkmcnt(2)
    v_mfma_f32_32x32x16_bf16 v[160:175], v[72:75], v[192:195], v[160:175]
    v_mfma_f32_32x32x16_bf16 v[176:191], v[72:75], v[196:199], v[176:191]
    s_waitcnt lgkmcnt(0)
    v_mfma_f32_32x32x16_bf16 v[160:175], v[76:79], v[200:203], v[160:175]
    v_mfma_f32_32x32x16_bf16 v[176:191], v[76:79], v[204:207], v[176:191]
    s_waitcnt vmcnt(12)
    s_barrier
    ds_read_b128 v[192:195], v5 offset:32768
    ds_read_b128 v[196:199], v5 offset:33792
    s_mov_b32 m0, s32
    s_nop 0
    buffer_load_dwordx4 v5, s[20:23], s31 offen offset:0 lds
    buffer_load_dwordx4 v5, s[20:23], s31 offen offset:1024 lds
    buffer_load_dwordx4 v[128:131], v5, s[20:23], s30 offen offset:0
    buffer_load_dwordx4 v[132:135], v5, s[20:23], s30 offen offset:1024
    buffer_load_dwordx4 v[136:139], v5, s[20:23], s30 offen offset:2048
    buffer_load_dwordx4 v[140:143], v5, s[20:23], s30 offen offset:3072
    s_add_u32 s30, s30, 4096
    s_add_u32 s31, s31, 8192
    s_add_u32 s32, s32, 8192
    ds_read_b128 v[200:203], v5 offset:34816
    ds_read_b128 v[204:207], v5 offset:35840
    s_waitcnt lgkmcnt(2)
    v_mfma_f32_32x32x16_bf16 v[160:175], v[80:83], v[192:195], v[160:175]
    v_mfma_f32_32x32x16_bf16 v[176:191], v[80:83], v[196:199], v[176:191]
    ds_read_b128 v[192:195], v5 offset:36864
    ds_read_b128 v[196:199], v5 offset:37888
    s_waitcnt lgkmcnt(2)
    v_mfma_f32_32x32x16_bf16 v[160:175], v[84:87], v[200:203], v[160:175]
    v_mfma_f32_32x32x16_bf16 v[176:191], v[84:87], v[204:207], v[176:191]
    ds_read_b128 v[200:203], v5 offset:38912
    ds_read_b128 v[204:207], v5 offset:39936
    s_waitcnt lgkmcnt(2)
    v_mfma_f32_32x32x16_bf16 v[160:175], v[88:91], v[192:195], v[160:175]
    v_mfma_f32_32x32x16_bf16 v[176:191], v[88:91], v[196:199], v[176:191]
    s_waitcnt lgkmcnt(0)
    v_mfma_f32_32x32x16_bf16 v[160:175], v[92:95], v[200:203], v[160:175]
    v_mfma_f32_32x32x16_bf16 v[176:191], v[92:95], v[204:207], v[176:191]
    s_waitcnt vmcnt(12)
    s_barrier
    ds_read_b128 v[192:195], v5 offset:40960
    ds_read_b128 v[196:199], v5 offset:41984
    s_mov_b32 m0, s32
    s_nop 0
    buffer_load_dwordx4 v5, s[20:23], s31 offen offset:0 lds
    buffer_load_dwordx4 v5, s[20:23], s31 offen offset:1024 lds
    s_add_u32 s31, s31, 8192
    s_add_u32 s32, s32, 8192
    ds_read_b128 v[200:203], v5 offset:43008
    ds_read_b128 v[204:207], v5 offset:44032
    s_waitcnt lgkmcnt(2)
    v_mfma_f32_32x32x16_bf16 v[160:175], v[96:99], v[192:195], v[160:175]
    v_mfma_f32_32x32x16_bf16 v[176:191], v[96:99], v[196:199], v[176:191]
    ds_read_b128 v[192:195], v5 offset:45056
    ds_read_b128 v[196:199], v5 offset:46080
    s_waitcnt lgkmcnt(2)
    v_mfma_f32_32x32x16_bf16 v[160:175], v[100:103], v[200:203], v[160:175]
    v_mfma_f32_32x32x16_bf16 v[176:191], v[100:103], v[204:207], v[176:191]
    ds_read_b128 v[200:203], v5 offset:47104
    ds_read_b128 v[204:207], v5 offset:48128
    s_waitcnt lgkmcnt(2)
    v_mfma_f32_32x32x16_bf16 v[160:175], v[104:107], v[192:195], v[160:175]
    v_mfma_f32_32x32x16_bf16 v[176:191], v[104:107], v[196:199], v[176:191]
    s_waitcnt lgkmcnt(0)
    v_mfma_f32_32x32x16_bf16 v[160:175], v[108:111], v[200:203], v[160:175]
    v_mfma_f32_32x32x16_bf16 v[176:191], v[108:111], v[204:207], v[176:191]
    s_waitcnt vmcnt(8)
    s_barrier
    ds_read_b128 v[192:195], v6 offset:0
    ds_read_b128 v[196:199], v6 offset:1024
    s_mov_b32 m0, s32
    s_nop 0
    buffer_load_dwordx4 v5, s[20:23], s31 offen offset:0 lds
    buffer_load_dwordx4 v5, s[20:23], s31 offen offset:1024 lds
    s_add_u32 s31, s31, 8192
    s_add_u32 s32, s32, 8192
    ds_read_b128 v[200:203], v6 offset:2048
    ds_read_b128 v[204:207], v6 offset:3072
    s_waitcnt lgkmcnt(2)
    v_mfma_f32_32x32x16_bf16 v[160:175], v[112:115], v[192:195], v[160:175]
    v_mfma_f32_32x32x16_bf16 v[176:191], v[112:115], v[196:199], v[176:191]
    ds_read_b128 v[192:195], v6 offset:4096
    ds_read_b128 v[196:199], v6 offset:5120
    s_waitcnt lgkmcnt(2)
    v_mfma_f32_32x32x16_bf16 v[160:175], v[116:119], v[200:203], v[160:175]
    v_mfma_f32_32x32x16_bf16 v[176:191], v[116:119], v[204:207], v[176:191]
    ds_read_b128 v[200:203], v6 offset:6144
    ds_read_b128 v[204:207], v6 offset:7168
    s_waitcnt lgkmcnt(2)
    v_mfma_f32_32x32x16_bf16 v[160:175], v[120:123], v[192:195], v[160:175]
    v_mfma_f32_32x32x16_bf16 v[176:191], v[120:123], v[196:199], v[176:191]
    s_waitcnt lgkmcnt(0)
    v_mfma_f32_32x32x16_bf16 v[160:175], v[124:127], v[200:203], v[160:175]
    v_mfma_f32_32x32x16_bf16 v[176:191], v[124:127], v[204:207], v[176:191]
    s_waitcnt vmcnt(4)
    s_barrier
    ds_read_b128 v[192:195], v6 offset:8192
    ds_read_b128 v[196:199], v6 offset:9216
    s_mov_b32 m0, s32
    s_nop 0
    buffer_load_dwordx4 v5, s[20:23], s31 offen offset:0 lds
    buffer_load_dwordx4 v5, s[20:23], s31 offen offset:1024 lds
    s_add_u32 s31, s31, 8192
    s_add_u32 s32, s32, 8192
    ds_read_b128 v[200:203], v6 offset:10240
    ds_read_b128 v[204:207], v6 offset:11264
    s_waitcnt lgkmcnt(2)
    v_mfma_f32_32x32x16_bf16 v[160:175], v[128:131], v[192:195], v[160:175]
    v_mfma_f32_32x32x16_bf16 v[176:191], v[128:131], v[196:199], v[176:191]
    ds_read_b128 v[192:195], v6 offset:12288
    ds_read_b128 v[196:199], v6 offset:13312
    s_waitcnt lgkmcnt(2)
    v_mfma_f32_32x32x16_bf16 v[160:175], v[132:135], v[200:203], v[160:175]
    v_mfma_f32_32x32x16_bf16 v[176:191], v[132:135], v[204:207], v[176:191]
    ds_read_b128 v[200:203], v6 offset:14336
    ds_read_b128 v[204:207], v6 offset:15360
    s_waitcnt lgkmcnt(2)
    v_mfma_f32_32x32x16_bf16 v[160:175], v[136:139], v[192:195], v[160:175]
    v_mfma_f32_32x32x16_bf16 v[176:191], v[136:139], v[196:199], v[176:191]
    s_waitcnt lgkmcnt(0)
    v_mfma_f32_32x32x16_bf16 v[160:175], v[140:143], v[200:203], v[160:175]
    v_mfma_f32_32x32x16_bf16 v[176:191], v[140:143], v[204:207], v[176:191]
    s_mov_b32 m0, s32
    s_nop 0
    buffer_load_dwordx4 v5, s[20:23], s31 offen offset:0 lds
    buffer_load_dwordx4 v5, s[20:23], s31 offen offset:1024 lds
    s_add_u32 s31, s31, 8192
    s_add_u32 s32, s32, 8192
    s_nop 4
    v_mul_f32 v212, s36, v160
    v_mul_f32 v213, s36, v161
    v_mul_f32 v214, s36, v162
    v_mul_f32 v215, s36, v163
    v_mul_f32 v216, s36, v164
    v_mul_f32 v217, s36, v165
    v_mul_f32 v218, s36, v166
    v_mul_f32 v219, s36, v167
    v_mul_f32 v220, s36, v168
    v_mul_f32 v221, s36, v169
    v_mul_f32 v222, s36, v170
    v_mul_f32 v223, s36, v171
    v_mul_f32 v224, s36, v172
    v_mul_f32 v225, s36, v173
    v_mul_f32 v226, s36, v174
    v_mul_f32 v227, s36, v175
    v_exp_f32 v212, v212 clamp
    v_add_f32 v160, 1.0, v160
    v_exp_f32 v213, v213 clamp
    v_add_f32 v161, 1.0, v161
    v_exp_f32 v214, v214 clamp
    v_add_f32 v162, 1.0, v162
    v_exp_f32 v215, v215 clamp
    v_add_f32 v163, 1.0, v163
    v_exp_f32 v216, v216 clamp
    v_add_f32 v164, 1.0, v164
    v_exp_f32 v217, v217 clamp
    v_add_f32 v165, 1.0, v165
    v_exp_f32 v218, v218 clamp
    v_add_f32 v166, 1.0, v166
    v_exp_f32 v219, v219 clamp
    v_add_f32 v167, 1.0, v167
    v_exp_f32 v220, v220 clamp
    v_add_f32 v168, 1.0, v168
    v_exp_f32 v221, v221 clamp
    v_add_f32 v169, 1.0, v169
    v_exp_f32 v222, v222 clamp
    v_add_f32 v170, 1.0, v170
    v_exp_f32 v223, v223 clamp
    v_add_f32 v171, 1.0, v171
    v_exp_f32 v224, v224 clamp
    v_add_f32 v172, 1.0, v172
    v_exp_f32 v225, v225 clamp
    v_add_f32 v173, 1.0, v173
    v_exp_f32 v226, v226 clamp
    v_add_f32 v174, 1.0, v174
    v_exp_f32 v227, v227 clamp
    v_add_f32 v175, 1.0, v175
    v_cvt_pk_bf16_f32 v236, v176, v177
    v_cvt_pk_bf16_f32 v237, v178, v179
    v_cvt_pk_bf16_f32 v238, v180, v181
    v_cvt_pk_bf16_f32 v239, v182, v183
    v_cvt_pk_bf16_f32 v240, v184, v185
    v_cvt_pk_bf16_f32 v241, v186, v187
    v_cvt_pk_bf16_f32 v242, v188, v189
    v_cvt_pk_bf16_f32 v243, v190, v191
    v_max_f32 v160, v160, v212
    v_max_f32 v161, v161, v213
    v_max_f32 v162, v162, v214
    v_max_f32 v163, v163, v215
    v_max_f32 v164, v164, v216
    v_max_f32 v165, v165, v217
    v_max_f32 v166, v166, v218
    v_max_f32 v167, v167, v219
    v_max_f32 v168, v168, v220
    v_max_f32 v169, v169, v221
    v_max_f32 v170, v170, v222
    v_max_f32 v171, v171, v223
    v_max_f32 v172, v172, v224
    v_max_f32 v173, v173, v225
    v_max_f32 v174, v174, v226
    v_max_f32 v175, v175, v227
    v_add_f32 v160, s37, v160
    v_add_f32 v161, s37, v161
    v_add_f32 v162, s37, v162
    v_add_f32 v163, s37, v163
    v_add_f32 v164, s37, v164
    v_add_f32 v165, s37, v165
    v_add_f32 v166, s37, v166
    v_add_f32 v167, s37, v167
    s_waitcnt vmcnt(0)
    s_barrier
    ds_read_b128 v[192:195], v6 offset:16384
    ds_read_b128 v[196:199], v6 offset:17408
    ds_read_b128 v[200:203], v6 offset:18432
    ds_read_b128 v[204:207], v6 offset:19456
    s_waitcnt lgkmcnt(3)
    v_mfma_f32_32x32x16_bf16 v[144:159], v[192:195], v[16:19], 0
    ds_read_b128 v[192:195], v6 offset:20480
    s_waitcnt lgkmcnt(3)
    v_mfma_f32_32x32x16_bf16 v[144:159], v[196:199], v[20:23], v[144:159]
    ds_read_b128 v[196:199], v6 offset:21504
    s_waitcnt lgkmcnt(3)
    v_mfma_f32_32x32x16_bf16 v[144:159], v[200:203], v[24:27], v[144:159]
    ds_read_b128 v[200:203], v6 offset:22528
    s_waitcnt lgkmcnt(3)
    v_mfma_f32_32x32x16_bf16 v[144:159], v[204:207], v[28:31], v[144:159]
    ds_read_b128 v[204:207], v6 offset:23552
    s_waitcnt lgkmcnt(3)
    v_mfma_f32_32x32x16_bf16 v[144:159], v[192:195], v[32:35], v[144:159]
    v_add_f32 v168, s37, v168
    v_add_f32 v169, s37, v169
    v_add_f32 v170, s37, v170
    v_add_f32 v171, s37, v171
    ds_read_b128 v[192:195], v6 offset:24576
    s_waitcnt lgkmcnt(3)
    v_mfma_f32_32x32x16_bf16 v[16:31], v[196:199], v[36:39], 0
    v_add_f32 v172, s37, v172
    v_add_f32 v173, s37, v173
    v_add_f32 v174, s37, v174
    v_add_f32 v175, s37, v175
    ds_read_b128 v[196:199], v6 offset:25600
    s_waitcnt lgkmcnt(3)
    v_mfma_f32_32x32x16_bf16 v[144:159], v[200:203], v[40:43], v[144:159]
    v_cvt_pk_bf16_f32 v228, v160, v161
    v_cvt_pk_bf16_f32 v229, v162, v163
    v_cvt_pk_bf16_f32 v230, v164, v165
    v_cvt_pk_bf16_f32 v231, v166, v167
    ds_read_b128 v[200:203], v6 offset:26624
    s_waitcnt lgkmcnt(3)
    v_mfma_f32_32x32x16_bf16 v[16:31], v[204:207], v[44:47], v[16:31]
    v_cvt_pk_bf16_f32 v232, v168, v169
    v_cvt_pk_bf16_f32 v233, v170, v171
    v_cvt_pk_bf16_f32 v234, v172, v173
    v_cvt_pk_bf16_f32 v235, v174, v175
    ds_read_b128 v[204:207], v6 offset:27648
    s_waitcnt lgkmcnt(3)
    v_mfma_f32_32x32x16_bf16 v[144:159], v[192:195], v[48:51], v[144:159]
    v_mfma_f32_32x32x16_bf16 v[160:175], v[228:231], v[236:239], 0
    v_mfma_f32_32x32x16_bf16 v[176:191], v[208:211], v[228:231], 0
    ds_read_b128 v[192:195], v6 offset:28672
    s_waitcnt lgkmcnt(3)
    v_mfma_f32_32x32x16_bf16 v[16:31], v[196:199], v[52:55], v[16:31]
    v_mfma_f32_32x32x16_bf16 v[160:175], v[232:235], v[240:243], v[160:175]
    v_mfma_f32_32x32x16_bf16 v[176:191], v[208:211], v[232:235], v[176:191]
    ds_read_b128 v[196:199], v6 offset:29696
    s_waitcnt lgkmcnt(3)
    v_mfma_f32_32x32x16_bf16 v[144:159], v[200:203], v[56:59], v[144:159]
    ds_read_b128 v[200:203], v6 offset:30720
    s_waitcnt lgkmcnt(3)
    v_mfma_f32_32x32x16_bf16 v[16:31], v[204:207], v[60:63], v[16:31]
    ds_read_b128 v[204:207], v6 offset:31744
    s_waitcnt lgkmcnt(3)
    v_mfma_f32_32x32x16_bf16 v[144:159], v[192:195], v[64:67], v[144:159]
    ds_read_b128 v[192:195], v6 offset:32768
    s_waitcnt lgkmcnt(3)
    v_mfma_f32_32x32x16_bf16 v[16:31], v[196:199], v[68:71], v[16:31]
    v_cndmask_b32 v160, v168, v160, s[42:43]
    v_cndmask_b32 v161, v169, v161, s[42:43]
    v_cndmask_b32 v162, v170, v162, s[42:43]
    v_cndmask_b32 v163, v171, v163, s[42:43]
    v_cndmask_b32 v164, v172, v164, s[42:43]
    v_cndmask_b32 v165, v173, v165, s[42:43]
    v_cndmask_b32 v166, v174, v166, s[42:43]
    v_cndmask_b32 v167, v175, v167, s[42:43]
    ds_write_b128 v12, v[160:163]
    ds_write_b128 v12, v[164:167] offset:1024
    ds_write_b32 v15, v176 offset:2048
    ds_read_b128 v[196:199], v6 offset:33792
    s_waitcnt lgkmcnt(6)
    v_mfma_f32_32x32x16_bf16 v[144:159], v[200:203], v[72:75], v[144:159]
    ds_read_b128 v[200:203], v6 offset:34816
    s_waitcnt lgkmcnt(6)
    v_mfma_f32_32x32x16_bf16 v[16:31], v[204:207], v[76:79], v[16:31]
    s_waitcnt lgkmcnt(2)
    s_barrier
    ds_read_b32 v212, v14 offset:0
    ds_read_b32 v213, v14 offset:2176
    ds_read_b32 v214, v14 offset:4352
    ds_read_b32 v215, v14 offset:6528
    ds_read_b32 v216, v14 offset:1024
    ds_read_b32 v217, v14 offset:3200
    ds_read_b32 v218, v14 offset:5376
    ds_read_b32 v219, v14 offset:7552
    ds_read_b32 v220, v14 offset:2048
    ds_read_b32 v221, v14 offset:4224
    ds_read_b32 v222, v14 offset:6400
    ds_read_b32 v223, v14 offset:8576
    ds_read_b128 v[204:207], v6 offset:35840
    s_waitcnt lgkmcnt(15)
    v_mfma_f32_32x32x16_bf16 v[144:159], v[192:195], v[80:83], v[144:159]
    ds_read_b128 v[192:195], v6 offset:36864
    s_waitcnt lgkmcnt(15)
    v_mfma_f32_32x32x16_bf16 v[16:31], v[196:199], v[84:87], v[16:31]
    ds_read_b128 v[196:199], v6 offset:37888
    s_waitcnt lgkmcnt(15)
    v_mfma_f32_32x32x16_bf16 v[144:159], v[200:203], v[88:91], v[144:159]
    s_waitcnt lgkmcnt(3)
    v_add_f32 v212, v212, v213
    v_add_f32 v214, v214, v215
    v_add_f32 v216, v216, v217
    v_add_f32 v218, v218, v219
    v_add_f32 v220, v220, v221
    v_add_f32 v222, v222, v223
    v_add_f32 v212, v212, v214
    v_add_f32 v216, v216, v218
    v_add_f32 v220, v220, v222
    buffer_atomic_add_f32 v212, v13, s[20:23], s38 offen
    buffer_atomic_add_f32 v216, v13, s[20:23], s38 offen offset:1024
    s_cmp_lg_u32 s3, 0
    s_cbranch_scc1 k1a_noat
    s_mov_b64 exec, s[46:47]
    buffer_atomic_add_f32 v220, v13, s[20:23], s38 offen offset:2048
    s_mov_b64 exec, -1
k1a_noat:
    ds_read_b128 v[200:203], v6 offset:38912
    s_waitcnt lgkmcnt(3)
    v_mfma_f32_32x32x16_bf16 v[16:31], v[204:207], v[92:95], v[16:31]
    ds_read_b128 v[204:207], v6 offset:39936
    s_waitcnt lgkmcnt(3)
    v_mfma_f32_32x32x16_bf16 v[144:159], v[192:195], v[96:99], v[144:159]
    ds_read_b128 v[192:195], v6 offset:40960
    s_waitcnt lgkmcnt(3)
    v_mfma_f32_32x32x16_bf16 v[16:31], v[196:199], v[100:103], v[16:31]
    ds_read_b128 v[196:199], v6 offset:41984
    s_waitcnt lgkmcnt(3)
    v_mfma_f32_32x32x16_bf16 v[144:159], v[200:203], v[104:107], v[144:159]
    ds_read_b128 v[200:203], v6 offset:43008
    s_waitcnt lgkmcnt(3)
    v_mfma_f32_32x32x16_bf16 v[16:31], v[204:207], v[108:111], v[16:31]
    ds_read_b128 v[204:207], v6 offset:44032
    s_waitcnt lgkmcnt(3)
    v_mfma_f32_32x32x16_bf16 v[144:159], v[192:195], v[112:115], v[144:159]
    ds_read_b128 v[192:195], v6 offset:45056
    s_waitcnt lgkmcnt(3)
    v_mfma_f32_32x32x16_bf16 v[16:31], v[196:199], v[116:119], v[16:31]
    ds_read_b128 v[196:199], v6 offset:46080
    s_waitcnt lgkmcnt(3)
    v_mfma_f32_32x32x16_bf16 v[144:159], v[200:203], v[120:123], v[144:159]
    ds_read_b128 v[200:203], v6 offset:47104
    s_waitcnt lgkmcnt(3)
    v_mfma_f32_32x32x16_bf16 v[16:31], v[204:207], v[124:127], v[16:31]
    ds_read_b128 v[204:207], v6 offset:48128
    s_waitcnt lgkmcnt(3)
    v_mfma_f32_32x32x16_bf16 v[144:159], v[192:195], v[128:131], v[144:159]
    s_waitcnt lgkmcnt(2)
    v_mfma_f32_32x32x16_bf16 v[16:31], v[196:199], v[132:135], v[16:31]
    s_waitcnt lgkmcnt(1)
    v_mfma_f32_32x32x16_bf16 v[144:159], v[200:203], v[136:139], v[144:159]
    s_waitcnt lgkmcnt(0)
    v_mfma_f32_32x32x16_bf16 v[16:31], v[204:207], v[140:143], v[16:31]
    s_nop 11
    v_pk_add_f32 v[144:145], v[144:145], v[16:17]
    v_pk_add_f32 v[146:147], v[146:147], v[18:19]
    v_pk_add_f32 v[148:149], v[148:149], v[20:21]
    v_pk_add_f32 v[150:151], v[150:151], v[22:23]
    v_pk_add_f32 v[152:153], v[152:153], v[24:25]
    v_pk_add_f32 v[154:155], v[154:155], v[26:27]
    v_pk_add_f32 v[156:157], v[156:157], v[28:29]
    v_pk_add_f32 v[158:159], v[158:159], v[30:31]
    v_mul_f32 v32, s36, v144
    v_mul_f32 v33, s36, v145
    v_mul_f32 v34, s36, v146
    v_mul_f32 v35, s36, v147
    v_mul_f32 v36, s36, v148
    v_mul_f32 v37, s36, v149
    v_mul_f32 v38, s36, v150
    v_mul_f32 v39, s36, v151
    v_mul_f32 v40, s36, v152
    v_mul_f32 v41, s36, v153
    v_mul_f32 v42, s36, v154
    v_mul_f32 v43, s36, v155
    v_mul_f32 v44, s36, v156
    v_mul_f32 v45, s36, v157
    v_mul_f32 v46, s36, v158
    v_mul_f32 v47, s36, v159
    v_exp_f32 v32, v32 clamp
    v_add_f32 v144, 1.0, v144
    v_exp_f32 v33, v33 clamp
    v_add_f32 v145, 1.0, v145
    v_exp_f32 v34, v34 clamp
    v_add_f32 v146, 1.0, v146
    v_exp_f32 v35, v35 clamp
    v_add_f32 v147, 1.0, v147
    v_exp_f32 v36, v36 clamp
    v_add_f32 v148, 1.0, v148
    v_exp_f32 v37, v37 clamp
    v_add_f32 v149, 1.0, v149
    v_exp_f32 v38, v38 clamp
    v_add_f32 v150, 1.0, v150
    v_exp_f32 v39, v39 clamp
    v_add_f32 v151, 1.0, v151
    v_exp_f32 v40, v40 clamp
    v_add_f32 v152, 1.0, v152
    v_exp_f32 v41, v41 clamp
    v_add_f32 v153, 1.0, v153
    v_exp_f32 v42, v42 clamp
    v_add_f32 v154, 1.0, v154
    v_exp_f32 v43, v43 clamp
    v_add_f32 v155, 1.0, v155
    v_exp_f32 v44, v44 clamp
    v_add_f32 v156, 1.0, v156
    v_exp_f32 v45, v45 clamp
    v_add_f32 v157, 1.0, v157
    v_exp_f32 v46, v46 clamp
    v_add_f32 v158, 1.0, v158
    v_exp_f32 v47, v47 clamp
    v_add_f32 v159, 1.0, v159
    v_max_f32 v144, v144, v32
    v_max_f32 v145, v145, v33
    v_max_f32 v146, v146, v34
    v_max_f32 v147, v147, v35
    v_max_f32 v148, v148, v36
    v_max_f32 v149, v149, v37
    v_max_f32 v150, v150, v38
    v_max_f32 v151, v151, v39
    v_add_f32 v144, s37, v144
    v_add_f32 v145, s37, v145
    v_add_f32 v146, s37, v146
    v_add_f32 v147, s37, v147
    v_add_f32 v148, s37, v148
    v_add_f32 v149, s37, v149
    v_add_f32 v150, s37, v150
    v_add_f32 v151, s37, v151
    v_cvt_pk_bf16_f32 v228, v144, v145
    v_cvt_pk_bf16_f32 v229, v146, v147
    v_cvt_pk_bf16_f32 v230, v148, v149
    v_cvt_pk_bf16_f32 v231, v150, v151
    buffer_store_dwordx4 v[228:231], v5, s[20:23], s39 offen offset:0 sc1
    v_max_f32 v152, v152, v40
    v_max_f32 v153, v153, v41
    v_max_f32 v154, v154, v42
    v_max_f32 v155, v155, v43
    v_max_f32 v156, v156, v44
    v_max_f32 v157, v157, v45
    v_max_f32 v158, v158, v46
    v_max_f32 v159, v159, v47
    v_add_f32 v152, s37, v152
    v_add_f32 v153, s37, v153
    v_add_f32 v154, s37, v154
    v_add_f32 v155, s37, v155
    v_add_f32 v156, s37, v156
    v_add_f32 v157, s37, v157
    v_add_f32 v158, s37, v158
    v_add_f32 v159, s37, v159
    v_cvt_pk_bf16_f32 v232, v152, v153
    v_cvt_pk_bf16_f32 v233, v154, v155
    v_cvt_pk_bf16_f32 v234, v156, v157
    v_cvt_pk_bf16_f32 v235, v158, v159
    buffer_store_dwordx4 v[232:235], v5, s[20:23], s39 offen offset:1024 sc1
    s_waitcnt vmcnt(0)
    s_branch k4a_entry
k1a_help:
    s_lshl_b32 s62, s2, 2
    s_add_u32 s62, s62, s3
    s_add_u32 s62, s62, 124
    s_and_b32 s64, s62, 511
    s_cmp_lt_u32 s62, 512
    s_cselect_b32 s84, s76, s82
    s_cselect_b32 s85, s77, s83
    s_mov_b32 s87, 0x20000
    s_cmp_lt_u32 s62, 1024
    s_cselect_b32 s86, 0x80000, 0
    v_and_b32 v9, 15, v2
    v_lshrrev_b32 v10, 4, v2
    v_lshlrev_b32 v10, 13, v10
    v_lshl_add_u32 v9, v9, 1, v10
    v_add_u32 v10, 4096, v9
    s_and_b32 s67, s64, 15
    s_lshl_b32 s67, s67, 15
    s_lshr_b32 s68, s64, 4
    s_lshl_b32 s68, s68, 5
    s_add_u32 s67, s67, s68
    buffer_load_ushort v16, v9, s[84:87], s67 offen offset:0
    buffer_load_ushort v20, v9, s[84:87], s67 offen offset:1024
    buffer_load_ushort v17, v9, s[84:87], s67 offen offset:2048
    buffer_load_ushort v21, v9, s[84:87], s67 offen offset:3072
    buffer_load_ushort v18, v10, s[84:87], s67 offen offset:0
    buffer_load_ushort v22, v10, s[84:87], s67 offen offset:1024
    buffer_load_ushort v19, v10, s[84:87], s67 offen offset:2048
    buffer_load_ushort v23, v10, s[84:87], s67 offen offset:3072
    v_mov_b32 v24, -1
    v_mov_b32 v25, -1
    v_mov_b32 v26, -1
    v_mov_b32 v27, -1
    s_lshl_b32 s67, s64, 10
    s_lshr_b32 s68, s64, 6
    s_lshl_b32 s68, s68, 6
    s_bfe_u32 s65, s64, 0x20002
    s_lshl_b32 s65, s65, 4
    s_add_u32 s68, s68, s65
    s_bfe_u32 s65, s64, 0x20004
    s_lshl_b32 s65, s65, 2
    s_add_u32 s68, s68, s65
    s_and_b32 s65, s64, 3
    s_add_u32 s68, s68, s65
    s_lshl_b32 s68, s68, 10
    s_add_u32 s68, s68, 0x80000
    s_cmp_lt_u32 s62, 512
    s_cselect_b32 s67, s67, s68
    s_add_u32 s67, s67, 0x880000
    s_sub_u32 s63, s3, 4
    s_lshl_b32 s65, s2, 13
    s_lshl_b32 s66, s63, 11
    s_add_u32 s69, s65, s66
    s_barrier
    s_barrier
    s_barrier
    s_barrier
    s_cmp_ge_u32 s62, 1024
    s_cbranch_scc1 k1a_h1
    s_waitcnt vmcnt(0)
    v_lshl_or_b32 v16, v20, 16, v16
    v_lshl_or_b32 v17, v21, 16, v17
    v_lshl_or_b32 v18, v22, 16, v18
    v_lshl_or_b32 v19, v23, 16, v19
    buffer_store_dwordx4 v[16:19], v5, s[20:23], s67 offen sc1
k1a_h1:
    s_barrier
    s_add_u32 s65, s69, 0x200000
    buffer_store_dwordx4 v[24:27], v5, s[20:23], s65 offen offset:0 sc1
    buffer_store_dwordx4 v[24:27], v5, s[20:23], s65 offen offset:1024 sc1
    s_barrier
    s_add_u32 s65, s69, 0x600000
    buffer_store_dwordx4 v[24:27], v5, s[20:23], s65 offen offset:0 sc1
    buffer_store_dwordx4 v[24:27], v5, s[20:23], s65 offen offset:1024 sc1
    s_barrier
    s_add_u32 s65, s69, 0xf00000
    buffer_store_dwordx4 v[24:27], v5, s[20:23], s65 offen offset:0 sc1
    buffer_store_dwordx4 v[24:27], v5, s[20:23], s65 offen offset:1024 sc1
    s_barrier
    s_lshl_b32 s65, s2, 10
    s_lshl_b32 s66, s63, 8
    s_add_u32 s65, s65, s66
    s_cmp_ge_u32 s2, 128
    s_cselect_b32 s66, 0x20000, 0
    s_add_u32 s65, s65, s66
    s_add_u32 s65, s65, 0x990000
    s_mov_b64 exec, 0xffff
    buffer_store_dwordx4 v[24:27], v5, s[20:23], s65 offen sc1
    s_mov_b64 exec, -1
    s_barrier
    s_barrier
    s_waitcnt vmcnt(0)
    s_branch k4a_entry
k1a_end:
    s_endpgm
k4a_entry:
    v_lshlrev_b32 v3, 4, v2
    s_and_b32 s28, s2, 7
    s_lshl_b32 s28, s28, 3
    s_bfe_u32 s29, s2, 0x30003
    s_add_u32 s28, s28, s29
    s_lshr_b32 s29, s2, 6
    s_lshl_b32 s30, s28, 15
    s_lshl_b32 s31, s3, 12
    s_add_u32 s30, s30, s31
    s_mul_i32 s32, s3, 4352
    s_add_u32 s32, s32, 0x9b0000
    s_and_b32 s33, s3, 3
    s_lshl_b32 s34, s29, 2
    s_add_u32 s34, s34, s33
    s_lshl_b32 s34, s34, 15
    s_lshr_b32 s35, s3, 2
    s_lshl_b32 s37, s35, 14
    s_add_u32 s34, s34, s37
    s_add_u32 s34, s34, 0x800000
    v_bfe_u32 v10, v2, 3, 1
    v_and_b32 v11, 7, v2
    v_mul_u32_u24 v12, 2176, v10
    v_lshl_add_u32 v12, v11, 4, v12
    s_lshl_b32 s78, s3, 14
    s_add_u32 s67, s78, 0x880000
    s_and_b32 s68, s3, 1
    s_lshl_b32 s68, s68, 14
    s_lshr_b32 s79, s3, 1
    s_lshl_b32 s69, s79, 11
    s_lshl_b32 s79, s79, 12
    s_add_u32 s68, s68, s79
    s_add_u32 s68, s68, 0x980000
    s_cmp_lt_u32 s3, 4
    s_cbranch_scc1 k4a_e1
    buffer_load_dwordx4 v[48:51], v3, s[20:23], s34 offen offset:0
    buffer_load_dwordx4 v[52:55], v3, s[20:23], s34 offen offset:1024
    buffer_load_dwordx4 v[56:59], v3, s[20:23], s34 offen offset:2048
    buffer_load_dwordx4 v[60:63], v3, s[20:23], s34 offen offset:3072
    s_add_u32 s34, s34, 4096
    buffer_load_dwordx4 v[64:67], v3, s[20:23], s34 offen offset:0
    buffer_load_dwordx4 v[68:71], v3, s[20:23], s34 offen offset:1024
    buffer_load_dwordx4 v[72:75], v3, s[20:23], s34 offen offset:2048
    buffer_load_dwordx4 v[76:79], v3, s[20:23], s34 offen offset:3072
    s_add_u32 s34, s34, 4096
    buffer_load_dwordx4 v[80:83], v3, s[20:23], s34 offen offset:0
    buffer_load_dwordx4 v[84:87], v3, s[20:23], s34 offen offset:1024
    buffer_load_dwordx4 v[88:91], v3, s[20:23], s34 offen offset:2048
    buffer_load_dwordx4 v[92:95], v3, s[20:23], s34 offen offset:3072
    s_add_u32 s34, s34, 4096
    buffer_load_dwordx4 v[96:99], v3, s[20:23], s34 offen offset:0
    buffer_load_dwordx4 v[100:103], v3, s[20:23], s34 offen offset:1024
    buffer_load_dwordx4 v[104:107], v3, s[20:23], s34 offen offset:2048
    buffer_load_dwordx4 v[108:111], v3, s[20:23], s34 offen offset:3072
    s_add_u32 s34, s34, 4096
    buffer_load_dwordx4 v[16:19], v3, s[20:23], s68 offen offset:0
    buffer_load_dwordx4 v[20:23], v3, s[20:23], s68 offen offset:1024
    buffer_load_dwordx4 v[24:27], v3, s[20:23], s68 offen offset:2048
    buffer_load_dwordx4 v[28:31], v3, s[20:23], s68 offen offset:3072
    s_add_u32 s68, s68, 4096
    buffer_load_dwordx4 v[144:147], v3, s[20:23], s67 offen offset:0
    buffer_load_dwordx4 v[148:151], v3, s[20:23], s67 offen offset:1024
    buffer_load_dwordx4 v[152:155], v3, s[20:23], s67 offen offset:2048
    buffer_load_dwordx4 v[156:159], v3, s[20:23], s67 offen offset:3072
    s_add_u32 s67, s67, 4096
    buffer_load_dwordx4 v[160:163], v3, s[20:23], s67 offen offset:0
    buffer_load_dwordx4 v[164:167], v3, s[20:23], s67 offen offset:1024
    buffer_load_dwordx4 v[168:171], v3, s[20:23], s67 offen offset:2048
    buffer_load_dwordx4 v[172:175], v3, s[20:23], s67 offen offset:3072
    s_add_u32 s67, s67, 4096
    buffer_load_dwordx4 v[180:183], v3, s[20:23], s67 offen offset:0
    buffer_load_dwordx4 v[184:187], v3, s[20:23], s67 offen offset:1024
    buffer_load_dwordx4 v[188:191], v3, s[20:23], s67 offen offset:2048
    buffer_load_dwordx4 v[192:195], v3, s[20:23], s67 offen offset:3072
    s_add_u32 s67, s67, 4096
    buffer_load_dwordx4 v[196:199], v3, s[20:23], s67 offen offset:0
    buffer_load_dwordx4 v[200:203], v3, s[20:23], s67 offen offset:1024
    buffer_load_dwordx4 v[204:207], v3, s[20:23], s67 offen offset:2048
    buffer_load_dwordx4 v[208:211], v3, s[20:23], s67 offen offset:3072
    s_add_u32 s67, s67, 4096
    s_barrier
    s_branch k4a_e2
k4a_e1:
    s_barrier
    s_cmp_lg_u32 s3, 0
    s_cbranch_scc1 k4a_e15
    v_lshlrev_b32 v4, 10, v2
    v_mov_b32 v5, 1
    s_lshl_b32 s36, s2, 2
    s_add_u32 s36, s36, 0x9c2000
    s_mov_b64 exec, 0xff
    buffer_store_dword v5, v4, s[20:23], s36 offen sc1
    s_mov_b64 exec, -1
k4a_e15:
    buffer_load_dwordx4 v[48:51], v3, s[20:23], s34 offen offset:0
    buffer_load_dwordx4 v[52:55], v3, s[20:23], s34 offen offset:1024
    buffer_load_dwordx4 v[56:59], v3, s[20:23], s34 offen offset:2048
    buffer_load_dwordx4 v[60:63], v3, s[20:23], s34 offen offset:3072
    s_add_u32 s34, s34, 4096
    buffer_load_dwordx4 v[64:67], v3, s[20:23], s34 offen offset:0
    buffer_load_dwordx4 v[68:71], v3, s[20:23], s34 offen offset:1024
    buffer_load_dwordx4 v[72:75], v3, s[20:23], s34 offen offset:2048
    buffer_load_dwordx4 v[76:79], v3, s[20:23], s34 offen offset:3072
    s_add_u32 s34, s34, 4096
    buffer_load_dwordx4 v[80:83], v3, s[20:23], s34 offen offset:0
    buffer_load_dwordx4 v[84:87], v3, s[20:23], s34 offen offset:1024
    buffer_load_dwordx4 v[88:91], v3, s[20:23], s34 offen offset:2048
    buffer_load_dwordx4 v[92:95], v3, s[20:23], s34 offen offset:3072
    s_add_u32 s34, s34, 4096
    buffer_load_dwordx4 v[96:99], v3, s[20:23], s34 offen offset:0
    buffer_load_dwordx4 v[100:103], v3, s[20:23], s34 offen offset:1024
    buffer_load_dwordx4 v[104:107], v3, s[20:23], s34 offen offset:2048
    buffer_load_dwordx4 v[108:111], v3, s[20:23], s34 offen offset:3072
    s_add_u32 s34, s34, 4096
    buffer_load_dwordx4 v[16:19], v3, s[20:23], s68 offen offset:0
    buffer_load_dwordx4 v[20:23], v3, s[20:23], s68 offen offset:1024
    buffer_load_dwordx4 v[24:27], v3, s[20:23], s68 offen offset:2048
    buffer_load_dwordx4 v[28:31], v3, s[20:23], s68 offen offset:3072
    s_add_u32 s68, s68, 4096
    buffer_load_dwordx4 v[144:147], v3, s[20:23], s67 offen offset:0
    buffer_load_dwordx4 v[148:151], v3, s[20:23], s67 offen offset:1024
    buffer_load_dwordx4 v[152:155], v3, s[20:23], s67 offen offset:2048
    buffer_load_dwordx4 v[156:159], v3, s[20:23], s67 offen offset:3072
    s_add_u32 s67, s67, 4096
    buffer_load_dwordx4 v[160:163], v3, s[20:23], s67 offen offset:0
    buffer_load_dwordx4 v[164:167], v3, s[20:23], s67 offen offset:1024
    buffer_load_dwordx4 v[168:171], v3, s[20:23], s67 offen offset:2048
    buffer_load_dwordx4 v[172:175], v3, s[20:23], s67 offen offset:3072
    s_add_u32 s67, s67, 4096
    buffer_load_dwordx4 v[180:183], v3, s[20:23], s67 offen offset:0
    buffer_load_dwordx4 v[184:187], v3, s[20:23], s67 offen offset:1024
    buffer_load_dwordx4 v[188:191], v3, s[20:23], s67 offen offset:2048
    buffer_load_dwordx4 v[192:195], v3, s[20:23], s67 offen offset:3072
    s_add_u32 s67, s67, 4096
    buffer_load_dwordx4 v[196:199], v3, s[20:23], s67 offen offset:0
    buffer_load_dwordx4 v[200:203], v3, s[20:23], s67 offen offset:1024
    buffer_load_dwordx4 v[204:207], v3, s[20:23], s67 offen offset:2048
    buffer_load_dwordx4 v[208:211], v3, s[20:23], s67 offen offset:3072
    s_add_u32 s67, s67, 4096
k4a_e2:
    s_cmp_lg_u32 s3, 7
    s_cbranch_scc1 k4a_e3
    s_and_b32 s36, s2, 7
    s_lshl_b32 s36, s36, 10
    s_add_u32 s36, s36, 0x9c2000
    s_mov_b32 s70, 0
k4a_ep:
    buffer_load_dwordx4 v[244:247], v3, s[20:23], s36 offen sc1
    s_add_u32 s70, s70, 1
    s_waitcnt vmcnt(0)
    v_min3_u32 v4, v244, v245, v246
    v_min_u32 v4, v4, v247
    v_cmp_eq_u32 s[50:51], 0, v4
    s_cmp_eq_u64 s[50:51], 0
    s_cbranch_scc1 k4a_e3
    s_sleep 1
    s_cmp_lt_u32 s70, 0x40000
    s_cbranch_scc1 k4a_ep
k4a_e3:
    s_barrier
    buffer_load_dwordx4 v[32:35], v12, s[20:23], s32 offen offset:2048
    buffer_load_dwordx4 v[128:131], v3, s[20:23], s32 offen offset:0
    buffer_load_dwordx4 v[132:135], v3, s[20:23], s32 offen offset:1024
    buffer_load_dwordx4 v[136:139], v3, s[20:23], s32 offen offset:2176
    buffer_load_dwordx4 v[140:143], v3, s[20:23], s32 offen offset:3200
    buffer_load_dwordx4 v[112:115], v3, s[20:23], s30 offen offset:0
    buffer_load_dwordx4 v[116:119], v3, s[20:23], s30 offen offset:1024
    buffer_load_dwordx4 v[120:123], v3, s[20:23], s30 offen offset:2048
    buffer_load_dwordx4 v[124:127], v3, s[20:23], s30 offen offset:3072
    s_mov_b32 s12, s6
    s_mov_b32 s13, s7
    s_mov_b32 s14, 0x200000
    s_mov_b32 s15, 0x20000
    v_and_b32 v4, 31, v2
    v_lshrrev_b32 v5, 5, v2
    s_mul_i32 s36, s3, 2304
    s_add_u32 s36, s36, 24576
    v_min_u32 v6, 16, v4
    v_lshlrev_b32 v6, 5, v6
    v_lshl_add_u32 v6, v5, 4, v6
    v_add_u32 v6, s36, v6
    v_bfe_u32 v9, v2, 4, 1
    v_mul_u32_u24 v9, 544, v9
    v_and_b32 v13, 15, v2
    v_lshl_add_u32 v9, v13, 5, v9
    v_lshl_add_u32 v9, v5, 4, v9
    v_add_u32 v9, s36, v9
    v_lshrrev_b32 v14, 2, v11
    v_lshl_add_u32 v14, v10, 1, v14
    v_mul_u32_u24 v14, 544, v14
    v_and_b32 v11, 3, v11
    v_lshl_add_u32 v14, v11, 3, v14
    v_add_u32 v14, s36, v14
    s_add_u32 s36, s31, 57344
    v_add_u32 v8, s36, v3
    s_add_u32 s36, s37, 57344
    v_add_u32 v15, s36, v3
    v_lshrrev_b32 v10, 4, v2
    v_lshlrev_b32 v7, 10, v10
    v_lshl_add_u32 v7, v13, 4, v7
    s_lshl_b32 s38, s28, 15
    s_add_u32 s38, s38, s31
    s_lshl_b32 s39, s29, 8
    s_add_u32 s38, s38, s39
    s_mul_i32 s39, s3, 2112
    s_add_u32 s39, s39, 90112
    v_mul_u32_u24 v10, 528, v10
    v_lshl_add_u32 v10, v13, 5, v10
    v_add_u32 v10, s39, v10
    s_mul_i32 s39, s35, 16896
    s_lshl_b32 s40, s33, 7
    s_add_u32 s39, s39, s40
    s_add_u32 s39, s39, 90112
    v_mul_u32_u24 v11, 528, v4
    v_lshl_add_u32 v11, v5, 4, v11
    v_add_u32 v11, s39, v11
    s_mov_b32 s40, 0x358637bd
    s_waitcnt vmcnt(8)
    v_cvt_pk_bf16_f32 v32, v32, v33
    v_cvt_pk_bf16_f32 v33, v34, v35
    ds_write_b64 v14, v[32:33] offset:512
    s_waitcnt vmcnt(7)
    v_cvt_pk_bf16_f32 v128, v128, v129
    v_cvt_pk_bf16_f32 v129, v130, v131
    ds_write_b64 v9, v[128:129] offset:0
    s_waitcnt vmcnt(6)
    v_cvt_pk_bf16_f32 v132, v132, v133
    v_cvt_pk_bf16_f32 v133, v134, v135
    ds_write_b64 v9, v[132:133] offset:8
    s_waitcnt vmcnt(5)
    v_cvt_pk_bf16_f32 v136, v136, v137
    v_cvt_pk_bf16_f32 v137, v138, v139
    ds_write_b64 v9, v[136:137] offset:1088
    s_waitcnt vmcnt(4)
    v_cvt_pk_bf16_f32 v140, v140, v141
    v_cvt_pk_bf16_f32 v141, v142, v143
    ds_write_b64 v9, v[140:141] offset:1096
    ds_read_b128 v[128:131], v6 offset:0
    ds_read_b128 v[132:135], v6 offset:544
    ds_read_b128 v[136:139], v6 offset:1088
    ds_read_b128 v[140:143], v6 offset:1632
    s_waitcnt vmcnt(3) lgkmcnt(3)
    v_mfma_f32_32x32x16_bf16 v[212:227], v[128:131], v[112:115], 0
    s_waitcnt vmcnt(2) lgkmcnt(2)
    v_mfma_f32_32x32x16_bf16 v[228:243], v[132:135], v[116:119], 0
    s_nop 9
    v_add_f32 v12, s40, v220
    v_rcp_f32 v12, v12
    s_nop 0
    v_mov_b32 v13, v12
    v_pk_mul_f32 v[212:213], v[212:213], v[12:13]
    v_pk_mul_f32 v[214:215], v[214:215], v[12:13]
    v_pk_mul_f32 v[216:217], v[216:217], v[12:13]
    v_pk_mul_f32 v[218:219], v[218:219], v[12:13]
    v_cvt_pk_bf16_f32 v112, v212, v213
    v_cvt_pk_bf16_f32 v113, v214, v215
    v_cvt_pk_bf16_f32 v114, v216, v217
    v_cvt_pk_bf16_f32 v115, v218, v219
    ds_write_b128 v8, v[112:115] offset:0
    s_waitcnt vmcnt(1) lgkmcnt(2)
    v_mfma_f32_32x32x16_bf16 v[212:227], v[136:139], v[120:123], 0
    v_add_f32 v12, s40, v236
    v_rcp_f32 v12, v12
    s_nop 0
    v_mov_b32 v13, v12
    v_pk_mul_f32 v[228:229], v[228:229], v[12:13]
    v_pk_mul_f32 v[230:231], v[230:231], v[12:13]
    v_pk_mul_f32 v[232:233], v[232:233], v[12:13]
    v_pk_mul_f32 v[234:235], v[234:235], v[12:13]
    v_cvt_pk_bf16_f32 v116, v228, v229
    v_cvt_pk_bf16_f32 v117, v230, v231
    v_cvt_pk_bf16_f32 v118, v232, v233
    v_cvt_pk_bf16_f32 v119, v234, v235
    ds_write_b128 v8, v[116:119] offset:1024
    s_waitcnt vmcnt(0) lgkmcnt(2)
    v_mfma_f32_32x32x16_bf16 v[228:243], v[140:143], v[124:127], 0
    v_add_f32 v12, s40, v220
    v_rcp_f32 v12, v12
    s_nop 0
    v_mov_b32 v13, v12
    v_pk_mul_f32 v[212:213], v[212:213], v[12:13]
    v_pk_mul_f32 v[214:215], v[214:215], v[12:13]
    v_pk_mul_f32 v[216:217], v[216:217], v[12:13]
    v_pk_mul_f32 v[218:219], v[218:219], v[12:13]
    v_cvt_pk_bf16_f32 v120, v212, v213
    v_cvt_pk_bf16_f32 v121, v214, v215
    v_cvt_pk_bf16_f32 v122, v216, v217
    v_cvt_pk_bf16_f32 v123, v218, v219
    ds_write_b128 v8, v[120:123] offset:2048
    v_add_f32 v12, s40, v236
    v_rcp_f32 v12, v12
    s_nop 0
    v_mov_b32 v13, v12
    v_pk_mul_f32 v[228:229], v[228:229], v[12:13]
    v_pk_mul_f32 v[230:231], v[230:231], v[12:13]
    v_pk_mul_f32 v[232:233], v[232:233], v[12:13]
    v_pk_mul_f32 v[234:235], v[234:235], v[12:13]
    v_cvt_pk_bf16_f32 v124, v228, v229
    v_cvt_pk_bf16_f32 v125, v230, v231
    v_cvt_pk_bf16_f32 v126, v232, v233
    v_cvt_pk_bf16_f32 v127, v234, v235
    ds_write_b128 v8, v[124:127] offset:3072
    s_and_b32 s29, s2, 7
    s_lshl_b32 s29, s29, 5
    s_lshr_b32 s30, s2, 3
    s_add_u32 s29, s29, s30
    s_lshl_b32 s36, s3, 14
    s_waitcnt lgkmcnt(0)
    s_barrier
    ds_read_b128 v[112:115], v15 offset:0
    ds_read_b128 v[116:119], v15 offset:1024
    ds_read_b128 v[120:123], v15 offset:2048
    ds_read_b128 v[124:127], v15 offset:3072
    ds_read_b128 v[128:131], v15 offset:4096
    ds_read_b128 v[132:135], v15 offset:5120
    ds_read_b128 v[136:139], v15 offset:6144
    s_waitcnt vmcnt(24) lgkmcnt(6)
    v_mfma_f32_32x32x16_bf16 v[212:227], v[48:51], v[112:115], 0
    ds_read_b128 v[140:143], v15 offset:7168
    s_waitcnt vmcnt(23) lgkmcnt(6)
    v_mfma_f32_32x32x16_bf16 v[228:243], v[52:55], v[116:119], 0
    ds_read_b128 v[112:115], v15 offset:8192
    s_waitcnt vmcnt(22) lgkmcnt(6)
    v_mfma_f32_32x32x16_bf16 v[212:227], v[56:59], v[120:123], v[212:227]
    ds_read_b128 v[116:119], v15 offset:9216
    s_waitcnt vmcnt(21) lgkmcnt(6)
    v_mfma_f32_32x32x16_bf16 v[228:243], v[60:63], v[124:127], v[228:243]
    ds_read_b128 v[120:123], v15 offset:10240
    s_waitcnt vmcnt(20) lgkmcnt(6)
    v_mfma_f32_32x32x16_bf16 v[212:227], v[64:67], v[128:131], v[212:227]
    ds_read_b128 v[124:127], v15 offset:11264
    s_waitcnt vmcnt(19) lgkmcnt(6)
    v_mfma_f32_32x32x16_bf16 v[228:243], v[68:71], v[132:135], v[228:243]
    ds_read_b128 v[128:131], v15 offset:12288
    buffer_load_dwordx4 v[244:247], v7, s[12:15], s38 offen
    s_waitcnt vmcnt(19) lgkmcnt(6)
    v_mfma_f32_32x32x16_bf16 v[212:227], v[72:75], v[136:139], v[212:227]
    ds_read_b128 v[132:135], v15 offset:13312
    s_waitcnt vmcnt(18) lgkmcnt(6)
    v_mfma_f32_32x32x16_bf16 v[228:243], v[76:79], v[140:143], v[228:243]
    ds_read_b128 v[136:139], v15 offset:14336
    s_waitcnt vmcnt(17) lgkmcnt(6)
    v_mfma_f32_32x32x16_bf16 v[212:227], v[80:83], v[112:115], v[212:227]
    ds_read_b128 v[140:143], v15 offset:15360
    s_waitcnt vmcnt(16) lgkmcnt(6)
    v_mfma_f32_32x32x16_bf16 v[228:243], v[84:87], v[116:119], v[228:243]
    s_waitcnt vmcnt(15) lgkmcnt(5)
    v_mfma_f32_32x32x16_bf16 v[212:227], v[88:91], v[120:123], v[212:227]
    s_waitcnt vmcnt(14) lgkmcnt(4)
    v_mfma_f32_32x32x16_bf16 v[228:243], v[92:95], v[124:127], v[228:243]
    s_waitcnt vmcnt(13) lgkmcnt(3)
    v_mfma_f32_32x32x16_bf16 v[212:227], v[96:99], v[128:131], v[212:227]
    s_waitcnt vmcnt(12) lgkmcnt(2)
    v_mfma_f32_32x32x16_bf16 v[228:243], v[100:103], v[132:135], v[228:243]
    s_waitcnt vmcnt(11) lgkmcnt(1)
    v_mfma_f32_32x32x16_bf16 v[212:227], v[104:107], v[136:139], v[212:227]
    s_waitcnt vmcnt(10) lgkmcnt(0)
    v_mfma_f32_32x32x16_bf16 v[228:243], v[108:111], v[140:143], v[228:243]
    s_add_u32 s38, s38, 0x200000
    s_nop 10
    v_pk_add_f32 v[212:213], v[212:213], v[228:229]
    v_pk_add_f32 v[214:215], v[214:215], v[230:231]
    v_pk_add_f32 v[216:217], v[216:217], v[232:233]
    v_pk_add_f32 v[218:219], v[218:219], v[234:235]
    v_pk_add_f32 v[220:221], v[220:221], v[236:237]
    v_pk_add_f32 v[222:223], v[222:223], v[238:239]
    v_pk_add_f32 v[224:225], v[224:225], v[240:241]
    v_pk_add_f32 v[226:227], v[226:227], v[242:243]
    ds_write_b128 v11, v[212:215] offset:0
    ds_write_b128 v11, v[216:219] offset:32
    ds_write_b128 v11, v[220:223] offset:64
    ds_write_b128 v11, v[224:227] offset:96
    s_waitcnt vmcnt(0)
    v_lshlrev_b32 v112, 16, v244
    v_and_b32 v113, 0xffff0000, v244
    v_lshlrev_b32 v114, 16, v245
    v_and_b32 v115, 0xffff0000, v245
    v_lshlrev_b32 v116, 16, v246
    v_and_b32 v117, 0xffff0000, v246
    v_lshlrev_b32 v118, 16, v247
    v_and_b32 v119, 0xffff0000, v247
    s_waitcnt lgkmcnt(0)
    s_barrier
    ds_read_b128 v[212:215], v10 offset:0
    ds_read_b128 v[216:219], v10 offset:16
    ds_read_b128 v[220:223], v10 offset:16896
    ds_read_b128 v[224:227], v10 offset:16912
    s_waitcnt lgkmcnt(2)
    v_pk_add_f32 v[112:113], v[112:113], v[212:213]
    v_pk_add_f32 v[114:115], v[114:115], v[214:215]
    v_pk_add_f32 v[116:117], v[116:117], v[216:217]
    v_pk_add_f32 v[118:119], v[118:119], v[218:219]
    s_waitcnt lgkmcnt(0)
    v_pk_add_f32 v[112:113], v[112:113], v[220:221]
    v_pk_add_f32 v[114:115], v[114:115], v[222:223]
    v_pk_add_f32 v[116:117], v[116:117], v[224:225]
    v_pk_add_f32 v[118:119], v[118:119], v[226:227]
    v_cvt_pk_bf16_f32 v244, v112, v113
    v_cvt_pk_bf16_f32 v245, v114, v115
    v_cvt_pk_bf16_f32 v246, v116, v117
    v_cvt_pk_bf16_f32 v247, v118, v119
    buffer_store_dwordx4 v[244:247], v7, s[20:23], s38 offen sc1
    s_lshl_b32 s77, s29, 3
    s_add_u32 s77, s77, s3
    s_lshl_b32 s77, s77, 10
    s_add_u32 s77, s77, 0x200000
    s_mov_b32 s32, s10
    s_mov_b32 s33, s11
    s_mov_b32 s34, 0x1300000
    s_mov_b32 s35, 0x20000
    s_add_u32 s24, s10, 0x400000
    s_addc_u32 s25, s11, 0
    s_mov_b32 s26, 0x200000
    s_mov_b32 s27, 0x20000
    v_and_b32 v13, 31, v2
    v_lshrrev_b32 v14, 5, v2
    v_lshlrev_b32 v4, 5, v13
    v_lshl_add_u32 v4, v14, 4, v4
    v_add_u32 v4, 8192, v4
    s_mul_i32 s30, s3, 2080
    s_add_u32 s30, s30, 57344
    v_add_u32 v5, s30, v3
    s_lshl_b32 s30, s3, 8
    s_add_u32 s30, s30, 123904
    v_lshl_add_u32 v6, v2, 2, s30
    s_lshr_b32 s30, s3, 2
    s_bfe_u32 s31, s3, 0x10001
    s_and_b32 s37, s3, 1
    s_mul_i32 s38, s30, 16640
    s_lshl_b32 s39, s31, 10
    s_add_u32 s38, s38, s39
    s_lshl_b32 s39, s37, 9
    s_add_u32 s38, s38, s39
    s_add_u32 s38, s38, 57344
    v_lshrrev_b32 v13, 1, v2
    v_and_b32 v14, 1, v2
    v_mul_u32_u24 v7, 8320, v14
    v_lshl_add_u32 v7, v13, 4, v7
    v_add_u32 v7, s38, v7
    s_lshl_b32 s38, s30, 11
    s_add_u32 s38, s38, 123904
    v_lshlrev_b32 v8, 10, v14
    v_lshl_add_u32 v8, v13, 2, v8
    v_add_u32 v8, s38, v8
    s_lshl_b32 s38, s30, 10
    s_lshl_b32 s39, s31, 7
    s_add_u32 s38, s38, s39
    s_lshl_b32 s39, s37, 3
    s_add_u32 s38, s38, s39
    s_add_u32 s38, s38, 24576
    v_lshrrev_b32 v14, 4, v13
    v_lshlrev_b32 v9, 9, v14
    v_bfe_u32 v14, v13, 3, 1
    v_lshl_add_u32 v9, v14, 8, v9
    v_and_b32 v13, 7, v13
    v_lshl_add_u32 v9, v13, 4, v9
    v_add_u32 v9, s38, v9
    v_lshrrev_b32 v13, 4, v2
    v_and_b32 v14, 7, v2
    v_lshlrev_b32 v10, 7, v13
    v_lshl_add_u32 v10, v14, 4, v10
    s_lshl_b32 s38, s3, 8
    s_add_u32 s38, s38, 8192
    v_lshl_add_u32 v11, v14, 5, s38
    v_and_b32 v14, 1, v13
    v_lshl_add_u32 v11, v14, 4, v11
    v_lshrrev_b32 v14, 1, v13
    v_lshl_add_u32 v11, v14, 3, v11
    v_mov_b32 v12, 0
    v_mov_b32 v13, 132096
    ds_write_b32 v13, v12
    ds_write_b32 v13, v12 offset:16
    s_mov_b32 s42, 0x3b000000
    s_mov_b32 s43, 0x3727c5ac
    s_mov_b32 s44, 0x3eb8aa3b
    s_mov_b32 s45, 0x17800000
    s_mov_b32 s46, 0x71800000
    s_mov_b32 s47, 0x7e800000
    s_mov_b32 s40, 0x0000ffff
    s_mov_b32 s41, 0x0000ffff
    s_lshl_b32 s30, s3, 13
    s_add_u32 s60, s30, 0x990000
    s_add_u32 s61, s60, 4096
    s_add_u32 s62, s30, 0x9a0000
    s_add_u32 s63, s62, 4096
    s_add_u32 s58, s36, 0x8a0000
    s_lshl_b32 s59, s3, 16
    s_add_u32 s59, s59, 0x900000
    s_mov_b32 s70, 0
k4a_xp:
    buffer_load_dwordx4 v[212:215], v3, s[20:23], s77 offen sc1
    s_add_u32 s70, s70, 1
    s_waitcnt vmcnt(0)
    v_max3_u32 v13, v212, v213, v214
    v_max_u32 v13, v13, v215
    v_cmp_eq_u32 s[50:51], -1, v13
    s_cmp_eq_u64 s[50:51], 0
    s_cbranch_scc1 k4a_xok
    s_cmp_lt_u32 s70, 0x40000
    s_cbranch_scc1 k4a_xp
k4a_xok:
    s_lshl_b32 s30, s3, 10
    v_add_u32 v15, s30, v3
    ds_write_b128 v15, v[212:215] offset:16384
    v_lshlrev_b32 v220, 16, v212
    v_and_b32 v221, 0xffff0000, v212
    v_lshlrev_b32 v222, 16, v213
    v_and_b32 v223, 0xffff0000, v213
    v_lshlrev_b32 v224, 16, v214
    v_and_b32 v225, 0xffff0000, v214
    v_lshlrev_b32 v226, 16, v215
    v_and_b32 v227, 0xffff0000, v215
    v_add_f32 v13, v220, v221
    v_add_f32 v13, v13, v222
    v_add_f32 v13, v13, v223
    v_add_f32 v13, v13, v224
    v_add_f32 v13, v13, v225
    v_add_f32 v13, v13, v226
    v_add_f32 v13, v13, v227
    s_nop 1
    v_add_f32_dpp v13, v13, v13 quad_perm:[1,0,3,2] row_mask:0xf bank_mask:0xf
    s_nop 1
    v_add_f32_dpp v13, v13, v13 quad_perm:[2,3,0,1] row_mask:0xf bank_mask:0xf
    s_nop 1
    v_add_f32_dpp v13, v13, v13 row_half_mirror row_mask:0xf bank_mask:0xf
    s_nop 1
    v_add_f32_dpp v13, v13, v13 row_mirror row_mask:0xf bank_mask:0xf
    v_mov_b32 v14, v13
    s_nop 1
    v_permlane16_swap_b32 v13, v14
    v_add_f32 v13, v13, v14
    v_mov_b32 v14, v13
    s_nop 1
    v_permlane32_swap_b32 v13, v14
    v_add_f32 v13, v13, v14
    v_mul_f32 v13, s42, v13
    v_sub_f32 v220, v220, v13
    v_sub_f32 v221, v221, v13
    v_sub_f32 v222, v222, v13
    v_sub_f32 v223, v223, v13
    v_sub_f32 v224, v224, v13
    v_sub_f32 v225, v225, v13
    v_sub_f32 v226, v226, v13
    v_sub_f32 v227, v227, v13
    v_mul_f32 v13, v220, v220
    v_fmac_f32 v13, v221, v221
    v_fmac_f32 v13, v222, v222
    v_fmac_f32 v13, v223, v223
    v_fmac_f32 v13, v224, v224
    v_fmac_f32 v13, v225, v225
    v_fmac_f32 v13, v226, v226
    v_fmac_f32 v13, v227, v227
    s_nop 1
    v_add_f32_dpp v13, v13, v13 quad_perm:[1,0,3,2] row_mask:0xf bank_mask:0xf
    s_nop 1
    v_add_f32_dpp v13, v13, v13 quad_perm:[2,3,0,1] row_mask:0xf bank_mask:0xf
    s_nop 1
    v_add_f32_dpp v13, v13, v13 row_half_mirror row_mask:0xf bank_mask:0xf
    s_nop 1
    v_add_f32_dpp v13, v13, v13 row_mirror row_mask:0xf bank_mask:0xf
    v_mov_b32 v14, v13
    s_nop 1
    v_permlane16_swap_b32 v13, v14
    v_add_f32 v13, v13, v14
    v_mov_b32 v14, v13
    s_nop 1
    v_permlane32_swap_b32 v13, v14
    v_add_f32 v13, v13, v14
    v_mov_b32 v14, s43
    v_fmac_f32 v14, s42, v13
    v_rsq_f32 v14, v14
    s_nop 0
    v_mul_f32 v220, v220, v14
    v_mul_f32 v221, v221, v14
    v_mul_f32 v222, v222, v14
    v_mul_f32 v223, v223, v14
    v_mul_f32 v224, v224, v14
    v_mul_f32 v225, v225, v14
    v_mul_f32 v226, v226, v14
    v_mul_f32 v227, v227, v14
    v_cvt_pk_bf16_f32 v216, v220, v221
    v_cvt_pk_bf16_f32 v217, v222, v223
    v_cvt_pk_bf16_f32 v218, v224, v225
    v_cvt_pk_bf16_f32 v219, v226, v227
    s_lshl_b32 s30, s3, 4
    v_lshl_add_u32 v15, v2, 7, s30
    ds_write_b128 v15, v[216:219] offset:0
    v_add_u32 v15, s69, v10
    s_lshl_b32 s30, s3, 10
    s_add_u32 s30, s30, 57344
    v_add_u32 v13, s30, v3
    s_waitcnt lgkmcnt(0)
    s_barrier
    ds_read_b128 v[220:223], v15 offset:0
    ds_read_b128 v[224:227], v15 offset:512
    ds_read_b128 v[228:231], v15 offset:1024
    ds_read_b128 v[232:235], v15 offset:1536
    s_bitcmp1_b32 s3, 0
    s_cbranch_scc1 k4a_mv
    s_waitcnt lgkmcnt(3)
    v_mfma_f32_16x16x32_bf16 v[176:179], v[16:19], v[220:223], 0
    s_waitcnt lgkmcnt(2)
    v_mfma_f32_16x16x32_bf16 v[212:215], v[20:23], v[224:227], 0
    s_waitcnt lgkmcnt(1)
    v_mfma_f32_16x16x32_bf16 v[176:179], v[24:27], v[228:231], v[176:179]
    s_waitcnt lgkmcnt(0)
    v_mfma_f32_16x16x32_bf16 v[212:215], v[28:31], v[232:235], v[212:215]
    s_branch k4a_mj
k4a_mv:
    s_waitcnt lgkmcnt(3)
    v_mfma_f32_16x16x32_bf16 v[176:179], v[220:223], v[16:19], 0
    s_waitcnt lgkmcnt(2)
    v_mfma_f32_16x16x32_bf16 v[212:215], v[224:227], v[20:23], 0
    s_waitcnt lgkmcnt(1)
    v_mfma_f32_16x16x32_bf16 v[176:179], v[228:231], v[24:27], v[176:179]
    s_waitcnt lgkmcnt(0)
    v_mfma_f32_16x16x32_bf16 v[212:215], v[232:235], v[28:31], v[212:215]
k4a_mj:
    s_nop 7
    v_pk_add_f32 v[176:177], v[176:177], v[212:213]
    v_pk_add_f32 v[178:179], v[178:179], v[214:215]
    ds_write_b128 v13, v[176:179]
    s_waitcnt lgkmcnt(0)
    s_barrier
    s_cmp_lt_u32 s3, 2
    s_cbranch_scc1 k4a_kv
    s_branch k4a_q0
k4a_kv:
    ds_read_b128 v[212:215], v13 offset:2048
    ds_read_b128 v[216:219], v13 offset:4096
    ds_read_b128 v[236:239], v13 offset:6144
    v_and_b32 v13, 15, v2
    v_lshlrev_b32 v13, 4, v13
    v_bfe_u32 v14, v2, 4, 1
    s_lshr_b32 s30, s29, 2
    s_lshl_b32 s30, s30, 10
    s_cmp_eq_u32 s3, 1
    s_cbranch_scc1 k4a_pv
    v_lshl_add_u32 v13, v14, 9, v13
    v_lshrrev_b32 v14, 5, v2
    v_lshl_add_u32 v13, v14, 3, v13
    s_and_b32 s31, s29, 3
    s_lshl_b32 s31, s31, 7
    s_add_u32 s30, s30, s31
    s_add_u32 s30, s30, 0x990000
    s_mov_b32 s50, 0x00ff00ff
    s_mov_b32 s51, 0x00ff00ff
    s_branch k4a_pj
k4a_pv:
    v_lshl_add_u32 v13, v14, 8, v13
    s_bfe_u32 s31, s29, 0x10001
    s_lshl_b32 s31, s31, 9
    s_add_u32 s30, s30, s31
    s_and_b32 s31, s29, 1
    s_lshl_b32 s31, s31, 3
    s_add_u32 s30, s30, s31
    s_add_u32 s30, s30, 0x9a0000
    s_mov_b32 s50, -1
    s_mov_b32 s51, 0
k4a_pj:
    s_waitcnt lgkmcnt(0)
    v_pk_add_f32 v[176:177], v[176:177], v[212:213]
    v_pk_add_f32 v[216:217], v[216:217], v[236:237]
    v_pk_add_f32 v[178:179], v[178:179], v[214:215]
    v_pk_add_f32 v[218:219], v[218:219], v[238:239]
    v_pk_add_f32 v[176:177], v[176:177], v[216:217]
    v_pk_add_f32 v[178:179], v[178:179], v[218:219]
    v_cvt_pk_bf16_f32 v176, v176, v177
    v_cvt_pk_bf16_f32 v177, v178, v179
    s_mov_b64 exec, s[50:51]
    buffer_store_dwordx2 v[176:177], v13, s[20:23], s30 offen sc1
    s_mov_b64 exec, -1
k4a_q0:
    buffer_load_dwordx4 v[112:115], v3, s[20:23], s58 offen offset:0
    buffer_load_dwordx4 v[116:119], v3, s[20:23], s58 offen offset:1024
    buffer_load_dwordx4 v[120:123], v3, s[20:23], s58 offen offset:2048
    buffer_load_dwordx4 v[124:127], v3, s[20:23], s58 offen offset:3072
    s_add_u32 s58, s58, 4096
    buffer_load_dwordx4 v[128:131], v3, s[20:23], s58 offen offset:0
    buffer_load_dwordx4 v[132:135], v3, s[20:23], s58 offen offset:1024
    buffer_load_dwordx4 v[136:139], v3, s[20:23], s58 offen offset:2048
    buffer_load_dwordx4 v[140:143], v3, s[20:23], s58 offen offset:3072
    s_add_u32 s58, s58, 4096
    v_and_b32 v13, 15, v2
    v_lshrrev_b32 v14, 5, v2
    v_lshlrev_b32 v13, 4, v13
    v_lshl_add_u32 v0, v14, 8, v13
    v_and_b32 v13, 31, v2
    v_cmp_eq_u32 s[50:51], 16, v13
    v_mov_b32 v14, 0x3f803f80
    s_nop 0
    v_cndmask_b32 v48, 0, v14, s[50:51]
    v_mov_b32 v49, v48
    v_mov_b64 v[50:51], v[48:49]
    v_mov_b64 v[52:53], v[48:49]
    v_mov_b64 v[54:55], v[48:49]
    v_mov_b64 v[56:57], v[48:49]
    v_mov_b64 v[58:59], v[48:49]
    v_mov_b64 v[60:61], v[48:49]
    v_mov_b64 v[62:63], v[48:49]
    v_mov_b64 v[64:65], v[48:49]
    v_mov_b64 v[66:67], v[48:49]
    v_mov_b64 v[68:69], v[48:49]
    v_mov_b64 v[70:71], v[48:49]
    v_mov_b64 v[72:73], v[48:49]
    v_mov_b64 v[74:75], v[48:49]
    v_mov_b64 v[76:77], v[48:49]
    v_mov_b64 v[78:79], v[48:49]
    v_mov_b64 v[80:81], v[48:49]
    v_mov_b64 v[82:83], v[48:49]
    v_mov_b64 v[84:85], v[48:49]
    v_mov_b64 v[86:87], v[48:49]
    v_mov_b64 v[88:89], v[48:49]
    v_mov_b64 v[90:91], v[48:49]
    v_mov_b64 v[92:93], v[48:49]
    v_mov_b64 v[94:95], v[48:49]
    v_mov_b64 v[96:97], v[48:49]
    v_mov_b64 v[98:99], v[48:49]
    v_mov_b64 v[100:101], v[48:49]
    v_mov_b64 v[102:103], v[48:49]
    v_mov_b64 v[104:105], v[48:49]
    v_mov_b64 v[106:107], v[48:49]
    v_mov_b64 v[108:109], v[48:49]
    v_mov_b64 v[110:111], v[48:49]
    ds_read_b128 v[220:223], v10 offset:0
    ds_read_b128 v[224:227], v10 offset:512
    ds_read_b128 v[228:231], v10 offset:1024
    ds_read_b128 v[232:235], v10 offset:1536
    ds_read_b128 v[240:243], v10 offset:2048
    ds_read_b128 v[244:247], v10 offset:2560
    ds_read_b128 v[248:251], v10 offset:3072
    ds_read_b128 v[252:255], v10 offset:3584
    s_waitcnt vmcnt(23) lgkmcnt(7)
    v_mfma_f32_16x16x32_bf16 v[176:179], v[144:147], v[220:223], 0
    ds_read_b128 v[220:223], v10 offset:4096
    s_waitcnt vmcnt(22) lgkmcnt(7)
    v_mfma_f32_16x16x32_bf16 v[212:215], v[148:151], v[224:227], 0
    ds_read_b128 v[224:227], v10 offset:4608
    s_waitcnt vmcnt(21) lgkmcnt(7)
    v_mfma_f32_16x16x32_bf16 v[216:219], v[152:155], v[228:231], 0
    ds_read_b128 v[228:231], v10 offset:5120
    s_waitcnt vmcnt(20) lgkmcnt(7)
    v_mfma_f32_16x16x32_bf16 v[236:239], v[156:159], v[232:235], 0
    ds_read_b128 v[232:235], v10 offset:5632
    s_waitcnt vmcnt(19) lgkmcnt(7)
    v_mfma_f32_16x16x32_bf16 v[176:179], v[160:163], v[240:243], v[176:179]
    ds_read_b128 v[240:243], v10 offset:6144
    s_waitcnt vmcnt(18) lgkmcnt(7)
    v_mfma_f32_16x16x32_bf16 v[212:215], v[164:167], v[244:247], v[212:215]
    ds_read_b128 v[244:247], v10 offset:6656
    s_waitcnt vmcnt(17) lgkmcnt(7)
    v_mfma_f32_16x16x32_bf16 v[216:219], v[168:171], v[248:251], v[216:219]
    ds_read_b128 v[248:251], v10 offset:7168
    s_waitcnt vmcnt(16) lgkmcnt(7)
    v_mfma_f32_16x16x32_bf16 v[236:239], v[172:175], v[252:255], v[236:239]
    ds_read_b128 v[252:255], v10 offset:7680
    s_waitcnt vmcnt(15) lgkmcnt(7)
    v_mfma_f32_16x16x32_bf16 v[176:179], v[180:183], v[220:223], v[176:179]
    s_waitcnt vmcnt(14) lgkmcnt(6)
    v_mfma_f32_16x16x32_bf16 v[212:215], v[184:187], v[224:227], v[212:215]
    s_waitcnt vmcnt(13) lgkmcnt(5)
    v_mfma_f32_16x16x32_bf16 v[216:219], v[188:191], v[228:231], v[216:219]
    s_waitcnt vmcnt(12) lgkmcnt(4)
    v_mfma_f32_16x16x32_bf16 v[236:239], v[192:195], v[232:235], v[236:239]
    s_waitcnt vmcnt(11) lgkmcnt(3)
    v_mfma_f32_16x16x32_bf16 v[176:179], v[196:199], v[240:243], v[176:179]
    s_waitcnt vmcnt(10) lgkmcnt(2)
    v_mfma_f32_16x16x32_bf16 v[212:215], v[200:203], v[244:247], v[212:215]
    s_waitcnt vmcnt(9) lgkmcnt(1)
    v_mfma_f32_16x16x32_bf16 v[216:219], v[204:207], v[248:251], v[216:219]
    s_waitcnt vmcnt(8) lgkmcnt(0)
    v_mfma_f32_16x16x32_bf16 v[236:239], v[208:211], v[252:255], v[236:239]
    s_nop 3
    v_pk_add_f32 v[176:177], v[176:177], v[212:213]
    s_nop 2
    v_pk_add_f32 v[216:217], v[216:217], v[236:237]
    v_pk_add_f32 v[178:179], v[178:179], v[214:215]
    v_pk_add_f32 v[218:219], v[218:219], v[238:239]
    v_pk_add_f32 v[176:177], v[176:177], v[216:217]
    v_pk_add_f32 v[178:179], v[178:179], v[218:219]
    v_mul_f32 v176, s44, v176
    v_mul_f32 v177, s44, v177
    v_mul_f32 v178, s44, v178
    v_mul_f32 v179, s44, v179
    v_cvt_pk_bf16_f32 v176, v176, v177
    v_cvt_pk_bf16_f32 v177, v178, v179
    ds_write_b64 v11, v[176:177]
    v_add_u32 v11, 2048, v11
    s_waitcnt vmcnt(0)
    buffer_load_dwordx4 v[16:19], v3, s[20:23], s60 offen offset:0
    buffer_load_dwordx4 v[20:23], v3, s[20:23], s60 offen offset:1024
    s_mov_b64 exec, s[40:41]
    buffer_load_dwordx4 v[48:51], v0, s[20:23], s62 offen offset:0
    buffer_load_dwordx4 v[52:55], v0, s[20:23], s62 offen offset:512
    s_mov_b64 exec, -1
    buffer_load_dwordx4 v[24:27], v3, s[20:23], s60 offen offset:2048
    s_mov_b64 exec, s[40:41]
    buffer_load_dwordx4 v[56:59], v0, s[20:23], s62 offen offset:1024
    buffer_load_dwordx4 v[60:63], v0, s[20:23], s62 offen offset:1536
    s_mov_b64 exec, -1
    v_mov_b64 v[240:241], 0
    v_mov_b64 v[242:243], 0
    v_mov_b64 v[244:245], 0
    v_mov_b64 v[246:247], 0
    v_mov_b64 v[248:249], 0
    v_mov_b64 v[250:251], 0
    v_mov_b64 v[252:253], 0
    v_mov_b64 v[254:255], 0
    s_mov_b32 s49, 1
    s_mov_b32 s64, 24576
    v_mov_b32 v15, v10
    s_waitcnt lgkmcnt(0)
    s_barrier
    ds_read_b128 v[236:239], v4
    v_add_u32 v4, 1024, v4
    s_mov_b32 s70, 0
    s_waitcnt vmcnt(6) lgkmcnt(0)
k4a_cks:
    v_max3_u32 v13, v16, v17, v18
    v_max_u32 v13, v13, v19
    v_cmp_eq_u32 s[50:51], -1, v13
    s_cmp_lg_u64 s[50:51], 0
    s_cbranch_scc1 k4a_rts
k4a_oks:
    v_mfma_f32_32x32x16_bf16 v[180:195], v[16:19], v[236:239], 0
    s_lshr_b32 s71, s2, 4
    s_mul_i32 s71, s71, 98304
    s_lshl_b32 s75, s3, 12
    s_add_u32 s71, s71, s75
    s_add_u32 s71, s71, 0xb00000
    s_add_u32 s72, s75, 138752
    s_sub_u32 s73, s75, 24576
    s_cmp_ge_u32 s3, 6
    s_cselect_b32 s72, s73, s72
    s_add_u32 s73, s75, 57344
    s_add_u32 s74, s75, 24576
    s_add_u32 s75, s75, 20480
    s_cmp_ge_u32 s3, 5
    s_cselect_b32 s74, s75, s74
    s_cmp_eq_u32 s3, 4
    s_cselect_b32 s74, 123904, s74
    s_cmp_eq_u32 s3, 7
    s_cselect_b32 s74, 16384, s74
    s_waitcnt vmcnt(3)
k4a_ck0:
    v_max3_u32 v13, v20, v21, v22
    v_max3_u32 v13, v13, v23, v48
    v_max3_u32 v13, v13, v49, v50
    v_max3_u32 v13, v13, v51, v52
    v_max3_u32 v13, v13, v53, v54
    v_max_u32 v13, v13, v55
    v_cmp_eq_u32 s[50:51], -1, v13
    s_cmp_lg_u64 s[50:51], 0
    s_cbranch_scc1 k4a_rt0
k4a_ok0:
    v_mfma_f32_32x32x16_bf16 v[196:211], v[20:23], v[236:239], 0
    buffer_load_dwordx4 v[28:31], v3, s[20:23], s60 offen offset:3072
    s_mov_b64 exec, s[40:41]
    buffer_load_dwordx4 v[64:67], v0, s[20:23], s62 offen offset:2048
    buffer_load_dwordx4 v[68:71], v0, s[20:23], s62 offen offset:2560
    s_mov_b64 exec, -1
    v_exp_f32 v180, v180
    v_exp_f32 v181, v181
    v_exp_f32 v182, v182
    v_exp_f32 v183, v183
    v_exp_f32 v184, v184
    v_exp_f32 v185, v185
    v_exp_f32 v186, v186
    v_exp_f32 v187, v187
    v_cvt_pk_bf16_f32 v212, v180, v181
    v_cvt_pk_bf16_f32 v213, v182, v183
    v_exp_f32 v188, v188
    v_exp_f32 v189, v189
    v_cvt_pk_bf16_f32 v214, v184, v185
    v_cvt_pk_bf16_f32 v215, v186, v187
    v_exp_f32 v190, v190
    v_exp_f32 v191, v191
    v_mfma_f32_32x32x16_bf16 v[220:235], v[48:51], v[212:215], 0
    v_exp_f32 v192, v192
    v_exp_f32 v193, v193
    v_exp_f32 v194, v194
    v_exp_f32 v195, v195
    v_cvt_pk_bf16_f32 v216, v188, v189
    v_cvt_pk_bf16_f32 v217, v190, v191
    v_cvt_pk_bf16_f32 v218, v192, v193
    v_cvt_pk_bf16_f32 v219, v194, v195
    s_setprio 0
    s_waitcnt vmcnt(3)
k4a_ck1:
    v_max3_u32 v13, v24, v25, v26
    v_max3_u32 v13, v13, v27, v56
    v_max3_u32 v13, v13, v57, v58
    v_max3_u32 v13, v13, v59, v60
    v_max3_u32 v13, v13, v61, v62
    v_max_u32 v13, v13, v63
    v_cmp_eq_u32 s[50:51], -1, v13
    s_cmp_lg_u64 s[50:51], 0
    s_cbranch_scc1 k4a_rt1
k4a_ok1:
    v_mfma_f32_32x32x16_bf16 v[180:195], v[24:27], v[236:239], 0
    buffer_load_dwordx4 v[32:35], v3, s[20:23], s61 offen offset:0
    s_mov_b64 exec, s[40:41]
    buffer_load_dwordx4 v[72:75], v0, s[20:23], s62 offen offset:3072
    buffer_load_dwordx4 v[76:79], v0, s[20:23], s62 offen offset:3584
    s_mov_b64 exec, -1
    v_exp_f32 v196, v196
    v_exp_f32 v197, v197
    v_exp_f32 v198, v198
    v_exp_f32 v199, v199
    v_mfma_f32_32x32x16_bf16 v[220:235], v[52:55], v[216:219], v[220:235]
    v_exp_f32 v200, v200
    v_exp_f32 v201, v201
    v_exp_f32 v202, v202
    v_exp_f32 v203, v203
    v_cvt_pk_bf16_f32 v212, v196, v197
    v_cvt_pk_bf16_f32 v213, v198, v199
    v_exp_f32 v204, v204
    v_exp_f32 v205, v205
    v_cvt_pk_bf16_f32 v214, v200, v201
    v_cvt_pk_bf16_f32 v215, v202, v203
    v_exp_f32 v206, v206
    v_exp_f32 v207, v207
    v_mfma_f32_32x32x16_bf16 v[220:235], v[56:59], v[212:215], v[220:235]
    v_exp_f32 v208, v208
    v_exp_f32 v209, v209
    v_exp_f32 v210, v210
    v_exp_f32 v211, v211
    v_cvt_pk_bf16_f32 v216, v204, v205
    v_cvt_pk_bf16_f32 v217, v206, v207
    v_cvt_pk_bf16_f32 v218, v208, v209
    v_cvt_pk_bf16_f32 v219, v210, v211
    s_waitcnt vmcnt(3)
k4a_ck2:
    v_max3_u32 v13, v28, v29, v30
    v_max3_u32 v13, v13, v31, v64
    v_max3_u32 v13, v13, v65, v66
    v_max3_u32 v13, v13, v67, v68
    v_max3_u32 v13, v13, v69, v70
    v_max_u32 v13, v13, v71
    v_cmp_eq_u32 s[50:51], -1, v13
    s_cmp_lg_u64 s[50:51], 0
    s_cbranch_scc1 k4a_rt2
k4a_ok2:
    v_mfma_f32_32x32x16_bf16 v[196:211], v[28:31], v[236:239], 0
    buffer_load_dwordx4 v[36:39], v3, s[20:23], s61 offen offset:1024
    s_mov_b64 exec, s[40:41]
    buffer_load_dwordx4 v[80:83], v0, s[20:23], s63 offen offset:0
    buffer_load_dwordx4 v[84:87], v0, s[20:23], s63 offen offset:512
    s_mov_b64 exec, -1
    v_exp_f32 v180, v180
    v_exp_f32 v181, v181
    v_exp_f32 v182, v182
    v_exp_f32 v183, v183
    v_mfma_f32_32x32x16_bf16 v[220:235], v[60:63], v[216:219], v[220:235]
    v_exp_f32 v184, v184
    v_exp_f32 v185, v185
    v_exp_f32 v186, v186
    v_exp_f32 v187, v187
    v_cvt_pk_bf16_f32 v212, v180, v181
    v_cvt_pk_bf16_f32 v213, v182, v183
    v_exp_f32 v188, v188
    v_exp_f32 v189, v189
    v_cvt_pk_bf16_f32 v214, v184, v185
    v_cvt_pk_bf16_f32 v215, v186, v187
    v_exp_f32 v190, v190
    v_exp_f32 v191, v191
    v_mfma_f32_32x32x16_bf16 v[220:235], v[64:67], v[212:215], v[220:235]
    v_exp_f32 v192, v192
    v_exp_f32 v193, v193
    v_exp_f32 v194, v194
    v_exp_f32 v195, v195
    v_cvt_pk_bf16_f32 v216, v188, v189
    v_cvt_pk_bf16_f32 v217, v190, v191
    v_cvt_pk_bf16_f32 v218, v192, v193
    v_cvt_pk_bf16_f32 v219, v194, v195
    s_waitcnt vmcnt(3)
k4a_ck3:
    v_max3_u32 v13, v32, v33, v34
    v_max3_u32 v13, v13, v35, v72
    v_max3_u32 v13, v13, v73, v74
    v_max3_u32 v13, v13, v75, v76
    v_max3_u32 v13, v13, v77, v78
    v_max_u32 v13, v13, v79
    v_cmp_eq_u32 s[50:51], -1, v13
    s_cmp_lg_u64 s[50:51], 0
    s_cbranch_scc1 k4a_rt3
k4a_ok3:
    v_mfma_f32_32x32x16_bf16 v[180:195], v[32:35], v[236:239], 0
    buffer_load_dwordx4 v[40:43], v3, s[20:23], s61 offen offset:2048
    s_mov_b64 exec, s[40:41]
    buffer_load_dwordx4 v[88:91], v0, s[20:23], s63 offen offset:1024
    buffer_load_dwordx4 v[92:95], v0, s[20:23], s63 offen offset:1536
    s_mov_b64 exec, -1
    v_exp_f32 v196, v196
    v_exp_f32 v197, v197
    v_exp_f32 v198, v198
    v_exp_f32 v199, v199
    v_mfma_f32_32x32x16_bf16 v[220:235], v[68:71], v[216:219], v[220:235]
    v_exp_f32 v200, v200
    v_exp_f32 v201, v201
    v_exp_f32 v202, v202
    v_exp_f32 v203, v203
    v_cvt_pk_bf16_f32 v212, v196, v197
    v_cvt_pk_bf16_f32 v213, v198, v199
    s_setprio 3
    v_exp_f32 v204, v204
    v_exp_f32 v205, v205
    v_cvt_pk_bf16_f32 v214, v200, v201
    v_cvt_pk_bf16_f32 v215, v202, v203
    v_exp_f32 v206, v206
    v_exp_f32 v207, v207
    v_mfma_f32_32x32x16_bf16 v[220:235], v[72:75], v[212:215], v[220:235]
    v_exp_f32 v208, v208
    v_exp_f32 v209, v209
    v_exp_f32 v210, v210
    v_exp_f32 v211, v211
    v_cvt_pk_bf16_f32 v216, v204, v205
    v_cvt_pk_bf16_f32 v217, v206, v207
    v_cvt_pk_bf16_f32 v218, v208, v209
    v_cvt_pk_bf16_f32 v219, v210, v211
    s_waitcnt vmcnt(3)
k4a_ck4:
    v_max3_u32 v13, v36, v37, v38
    v_max3_u32 v13, v13, v39, v80
    v_max3_u32 v13, v13, v81, v82
    v_max3_u32 v13, v13, v83, v84
    v_max3_u32 v13, v13, v85, v86
    v_max_u32 v13, v13, v87
    v_cmp_eq_u32 s[50:51], -1, v13
    s_cmp_lg_u64 s[50:51], 0
    s_cbranch_scc1 k4a_rt4
k4a_ok4:
    v_mfma_f32_32x32x16_bf16 v[196:211], v[36:39], v[236:239], 0
    buffer_load_dwordx4 v[44:47], v3, s[20:23], s61 offen offset:3072
    s_mov_b64 exec, s[40:41]
    buffer_load_dwordx4 v[96:99], v0, s[20:23], s63 offen offset:2048
    buffer_load_dwordx4 v[100:103], v0, s[20:23], s63 offen offset:2560
    s_mov_b64 exec, -1
    v_exp_f32 v180, v180
    v_exp_f32 v181, v181
    v_exp_f32 v182, v182
    v_exp_f32 v183, v183
    v_mfma_f32_32x32x16_bf16 v[220:235], v[76:79], v[216:219], v[220:235]
    v_exp_f32 v184, v184
    v_exp_f32 v185, v185
    v_exp_f32 v186, v186
    v_exp_f32 v187, v187
    v_cvt_pk_bf16_f32 v212, v180, v181
    v_cvt_pk_bf16_f32 v213, v182, v183
    v_exp_f32 v188, v188
    v_exp_f32 v189, v189
    v_cvt_pk_bf16_f32 v214, v184, v185
    v_cvt_pk_bf16_f32 v215, v186, v187
    v_exp_f32 v190, v190
    v_exp_f32 v191, v191
    v_mfma_f32_32x32x16_bf16 v[220:235], v[80:83], v[212:215], v[220:235]
    v_exp_f32 v192, v192
    v_exp_f32 v193, v193
    v_exp_f32 v194, v194
    v_exp_f32 v195, v195
    v_cvt_pk_bf16_f32 v216, v188, v189
    v_cvt_pk_bf16_f32 v217, v190, v191
    v_cvt_pk_bf16_f32 v218, v192, v193
    v_cvt_pk_bf16_f32 v219, v194, v195
    s_setprio 2
    s_waitcnt vmcnt(3)
k4a_ck5:
    v_max3_u32 v13, v40, v41, v42
    v_max3_u32 v13, v13, v43, v88
    v_max3_u32 v13, v13, v89, v90
    v_max3_u32 v13, v13, v91, v92
    v_max3_u32 v13, v13, v93, v94
    v_max_u32 v13, v13, v95
    v_cmp_eq_u32 s[50:51], -1, v13
    s_cmp_lg_u64 s[50:51], 0
    s_cbranch_scc1 k4a_rt5
k4a_ok5:
    v_mfma_f32_32x32x16_bf16 v[180:195], v[40:43], v[236:239], 0
    s_mov_b64 exec, s[40:41]
    buffer_load_dwordx4 v[104:107], v0, s[20:23], s63 offen offset:3072
    buffer_load_dwordx4 v[108:111], v0, s[20:23], s63 offen offset:3584
    s_mov_b64 exec, -1
    v_exp_f32 v196, v196
    v_exp_f32 v197, v197
    v_exp_f32 v198, v198
    v_exp_f32 v199, v199
    v_mfma_f32_32x32x16_bf16 v[220:235], v[84:87], v[216:219], v[220:235]
    v_exp_f32 v200, v200
    v_exp_f32 v201, v201
    v_exp_f32 v202, v202
    v_exp_f32 v203, v203
    v_cvt_pk_bf16_f32 v212, v196, v197
    v_cvt_pk_bf16_f32 v213, v198, v199
    v_exp_f32 v204, v204
    v_exp_f32 v205, v205
    v_cvt_pk_bf16_f32 v214, v200, v201
    v_cvt_pk_bf16_f32 v215, v202, v203
    v_exp_f32 v206, v206
    v_exp_f32 v207, v207
    v_mfma_f32_32x32x16_bf16 v[220:235], v[88:91], v[212:215], v[220:235]
    v_exp_f32 v208, v208
    v_exp_f32 v209, v209
    v_exp_f32 v210, v210
    v_exp_f32 v211, v211
    v_cvt_pk_bf16_f32 v216, v204, v205
    v_cvt_pk_bf16_f32 v217, v206, v207
    v_cvt_pk_bf16_f32 v218, v208, v209
    v_cvt_pk_bf16_f32 v219, v210, v211
    s_waitcnt vmcnt(2)
k4a_ck6:
    v_max3_u32 v13, v44, v45, v46
    v_max3_u32 v13, v13, v47, v96
    v_max3_u32 v13, v13, v97, v98
    v_max3_u32 v13, v13, v99, v100
    v_max3_u32 v13, v13, v101, v102
    v_max_u32 v13, v13, v103
    v_cmp_eq_u32 s[50:51], -1, v13
    s_cmp_lg_u64 s[50:51], 0
    s_cbranch_scc1 k4a_rt6
k4a_ok6:
    v_mfma_f32_32x32x16_bf16 v[196:211], v[44:47], v[236:239], 0
    ds_read_b128 v[236:239], v4
    v_add_u32 v4, 1024, v4
    v_exp_f32 v180, v180
    v_exp_f32 v181, v181
    v_exp_f32 v182, v182
    v_exp_f32 v183, v183
    v_mfma_f32_32x32x16_bf16 v[220:235], v[92:95], v[216:219], v[220:235]
    v_exp_f32 v184, v184
    v_exp_f32 v185, v185
    v_exp_f32 v186, v186
    v_exp_f32 v187, v187
    v_cvt_pk_bf16_f32 v212, v180, v181
    v_cvt_pk_bf16_f32 v213, v182, v183
    v_exp_f32 v188, v188
    v_exp_f32 v189, v189
    v_cvt_pk_bf16_f32 v214, v184, v185
    v_cvt_pk_bf16_f32 v215, v186, v187
    v_exp_f32 v190, v190
    v_exp_f32 v191, v191
    v_mfma_f32_32x32x16_bf16 v[220:235], v[96:99], v[212:215], v[220:235]
    v_exp_f32 v192, v192
    v_exp_f32 v193, v193
    v_exp_f32 v194, v194
    v_exp_f32 v195, v195
    v_cvt_pk_bf16_f32 v216, v188, v189
    v_cvt_pk_bf16_f32 v217, v190, v191
    v_cvt_pk_bf16_f32 v218, v192, v193
    v_cvt_pk_bf16_f32 v219, v194, v195
    s_setprio 1
    s_waitcnt vmcnt(0)
k4a_ck7:
    v_max3_u32 v13, v104, v105, v106
    v_max3_u32 v13, v13, v107, v108
    v_max3_u32 v13, v13, v109, v110
    v_max_u32 v13, v13, v111
    v_cmp_eq_u32 s[50:51], -1, v13
    s_cmp_lg_u64 s[50:51], 0
    s_cbranch_scc1 k4a_rt7
k4a_ok7:
    s_waitcnt lgkmcnt(0)
    v_mfma_f32_32x32x16_bf16 v[180:195], v[16:19], v[236:239], 0
    v_exp_f32 v196, v196
    v_exp_f32 v197, v197
    v_exp_f32 v198, v198
    v_exp_f32 v199, v199
    v_mfma_f32_32x32x16_bf16 v[220:235], v[100:103], v[216:219], v[220:235]
    v_exp_f32 v200, v200
    v_exp_f32 v201, v201
    v_exp_f32 v202, v202
    v_exp_f32 v203, v203
    v_cvt_pk_bf16_f32 v212, v196, v197
    v_cvt_pk_bf16_f32 v213, v198, v199
    v_exp_f32 v204, v204
    v_exp_f32 v205, v205
    v_cvt_pk_bf16_f32 v214, v200, v201
    v_cvt_pk_bf16_f32 v215, v202, v203
    v_exp_f32 v206, v206
    v_exp_f32 v207, v207
    v_mfma_f32_32x32x16_bf16 v[220:235], v[104:107], v[212:215], v[220:235]
    v_exp_f32 v208, v208
    v_exp_f32 v209, v209
    v_exp_f32 v210, v210
    v_exp_f32 v211, v211
    v_cvt_pk_bf16_f32 v216, v204, v205
    v_cvt_pk_bf16_f32 v217, v206, v207
    v_cvt_pk_bf16_f32 v218, v208, v209
    v_cvt_pk_bf16_f32 v219, v210, v211
    s_mov_b32 s30, s58
    s_add_u32 s58, s58, 122880
    ds_read_b128 v[144:147], v15 offset:0
    ds_read_b128 v[148:151], v15 offset:512
    v_mov_b32 v0, 132112
    s_mov_b32 s76, 8
    v_mfma_f32_32x32x16_bf16 v[196:211], v[20:23], v[236:239], 0
    v_exp_f32 v180, v180
    v_exp_f32 v181, v181
    v_exp_f32 v182, v182
    v_exp_f32 v183, v183
    v_mfma_f32_32x32x16_bf16 v[220:235], v[108:111], v[216:219], v[220:235]
    v_exp_f32 v184, v184
    v_exp_f32 v185, v185
    v_exp_f32 v186, v186
    v_exp_f32 v187, v187
    v_cvt_pk_bf16_f32 v212, v180, v181
    v_cvt_pk_bf16_f32 v213, v182, v183
    s_waitcnt vmcnt(31) lgkmcnt(1)
    v_mfma_f32_16x16x32_bf16 v[240:243], v[112:115], v[144:147], v[240:243]
    buffer_load_dwordx4 v[112:115], v3, s[32:35], s30 offen offset:0
    ds_read_b128 v[152:155], v15 offset:1024
    v_exp_f32 v188, v188
    v_exp_f32 v189, v189
    v_cvt_pk_bf16_f32 v214, v184, v185
    v_cvt_pk_bf16_f32 v215, v186, v187
    s_waitcnt vmcnt(31) lgkmcnt(1)
    v_mfma_f32_16x16x32_bf16 v[240:243], v[116:119], v[148:151], v[240:243]
    buffer_load_dwordx4 v[116:119], v3, s[32:35], s30 offen offset:1024
    ds_read_b128 v[156:159], v15 offset:1536
    v_exp_f32 v190, v190
    v_exp_f32 v191, v191
    ds_write_b128 v5, v[220:223]
    ds_write_b128 v5, v[224:227] offset:1024
    ds_write_b32 v6, v228
    v_mfma_f32_32x32x16_bf16 v[220:235], v[48:51], v[212:215], 0
    v_exp_f32 v192, v192
    v_exp_f32 v193, v193
    v_exp_f32 v194, v194
    v_exp_f32 v195, v195
    v_cvt_pk_bf16_f32 v216, v188, v189
    v_cvt_pk_bf16_f32 v217, v190, v191
    s_waitcnt vmcnt(31) lgkmcnt(1)
    v_mfma_f32_16x16x32_bf16 v[240:243], v[120:123], v[152:155], v[240:243]
    buffer_load_dwordx4 v[120:123], v3, s[32:35], s30 offen offset:2048
    ds_read_b128 v[144:147], v15 offset:2048
    v_cvt_pk_bf16_f32 v218, v192, v193
    v_cvt_pk_bf16_f32 v219, v194, v195
    v_add_u32 v5, 16640, v5
    v_add_u32 v6, 2048, v6
    s_setprio 0
    v_mfma_f32_32x32x16_bf16 v[180:195], v[24:27], v[236:239], 0
    v_exp_f32 v196, v196
    v_exp_f32 v197, v197
    v_exp_f32 v198, v198
    v_exp_f32 v199, v199
    v_mfma_f32_32x32x16_bf16 v[220:235], v[52:55], v[216:219], v[220:235]
    v_exp_f32 v200, v200
    v_exp_f32 v201, v201
    v_exp_f32 v202, v202
    v_exp_f32 v203, v203
    v_cvt_pk_bf16_f32 v212, v196, v197
    v_cvt_pk_bf16_f32 v213, v198, v199
    s_waitcnt vmcnt(31) lgkmcnt(1)
    v_mfma_f32_16x16x32_bf16 v[240:243], v[124:127], v[156:159], v[240:243]
    buffer_load_dwordx4 v[124:127], v3, s[32:35], s30 offen offset:3072
    s_add_u32 s30, s30, 4096
    ds_read_b128 v[148:151], v15 offset:2560
    v_exp_f32 v204, v204
    v_exp_f32 v205, v205
    v_cvt_pk_bf16_f32 v214, v200, v201
    v_cvt_pk_bf16_f32 v215, v202, v203
    s_waitcnt vmcnt(31) lgkmcnt(1)
    v_mfma_f32_16x16x32_bf16 v[244:247], v[128:131], v[144:147], v[244:247]
    buffer_load_dwordx4 v[128:131], v3, s[32:35], s30 offen offset:0
    ds_read_b128 v[152:155], v15 offset:3072
    v_exp_f32 v206, v206
    v_exp_f32 v207, v207
    v_mfma_f32_32x32x16_bf16 v[220:235], v[56:59], v[212:215], v[220:235]
    v_exp_f32 v208, v208
    v_exp_f32 v209, v209
    v_exp_f32 v210, v210
    v_exp_f32 v211, v211
    v_cvt_pk_bf16_f32 v216, v204, v205
    v_cvt_pk_bf16_f32 v217, v206, v207
    s_waitcnt vmcnt(31) lgkmcnt(1)
    v_mfma_f32_16x16x32_bf16 v[244:247], v[132:135], v[148:151], v[244:247]
    buffer_load_dwordx4 v[132:135], v3, s[32:35], s30 offen offset:1024
    ds_read_b128 v[156:159], v15 offset:3584
    v_cvt_pk_bf16_f32 v218, v208, v209
    v_cvt_pk_bf16_f32 v219, v210, v211
    v_mfma_f32_32x32x16_bf16 v[196:211], v[28:31], v[236:239], 0
    v_exp_f32 v180, v180
    v_exp_f32 v181, v181
    v_exp_f32 v182, v182
    v_exp_f32 v183, v183
    v_mfma_f32_32x32x16_bf16 v[220:235], v[60:63], v[216:219], v[220:235]
    v_exp_f32 v184, v184
    v_exp_f32 v185, v185
    v_exp_f32 v186, v186
    v_exp_f32 v187, v187
    v_cvt_pk_bf16_f32 v212, v180, v181
    v_cvt_pk_bf16_f32 v213, v182, v183
    s_waitcnt vmcnt(31) lgkmcnt(1)
    v_mfma_f32_16x16x32_bf16 v[244:247], v[136:139], v[152:155], v[244:247]
    buffer_load_dwordx4 v[136:139], v3, s[32:35], s30 offen offset:2048
    ds_read_b128 v[144:147], v15 offset:4096
    v_exp_f32 v188, v188
    v_exp_f32 v189, v189
    v_cvt_pk_bf16_f32 v214, v184, v185
    v_cvt_pk_bf16_f32 v215, v186, v187
    s_waitcnt vmcnt(31) lgkmcnt(1)
    v_mfma_f32_16x16x32_bf16 v[244:247], v[140:143], v[156:159], v[244:247]
    buffer_load_dwordx4 v[140:143], v3, s[32:35], s30 offen offset:3072
    ds_read_b128 v[148:151], v15 offset:4608
    v_exp_f32 v190, v190
    v_exp_f32 v191, v191
    v_mfma_f32_32x32x16_bf16 v[220:235], v[64:67], v[212:215], v[220:235]
    v_exp_f32 v192, v192
    v_exp_f32 v193, v193
    v_exp_f32 v194, v194
    v_exp_f32 v195, v195
    v_cvt_pk_bf16_f32 v216, v188, v189
    v_cvt_pk_bf16_f32 v217, v190, v191
    s_mov_b32 s30, s58
    s_add_u32 s58, s58, 0x20000
    s_waitcnt vmcnt(7) lgkmcnt(1)
    v_mfma_f32_16x16x32_bf16 v[248:251], v[112:115], v[144:147], v[248:251]
    buffer_load_dwordx4 v[112:115], v3, s[32:35], s30 offen offset:0
    ds_read_b128 v[152:155], v15 offset:5120
    v_cvt_pk_bf16_f32 v218, v192, v193
    v_cvt_pk_bf16_f32 v219, v194, v195
    v_mfma_f32_32x32x16_bf16 v[180:195], v[32:35], v[236:239], 0
    v_exp_f32 v196, v196
    v_exp_f32 v197, v197
    v_exp_f32 v198, v198
    v_exp_f32 v199, v199
    v_mfma_f32_32x32x16_bf16 v[220:235], v[68:71], v[216:219], v[220:235]
    v_exp_f32 v200, v200
    v_exp_f32 v201, v201
    v_exp_f32 v202, v202
    v_exp_f32 v203, v203
    v_cvt_pk_bf16_f32 v212, v196, v197
    v_cvt_pk_bf16_f32 v213, v198, v199
    s_waitcnt vmcnt(7) lgkmcnt(1)
    v_mfma_f32_16x16x32_bf16 v[248:251], v[116:119], v[148:151], v[248:251]
    buffer_load_dwordx4 v[116:119], v3, s[32:35], s30 offen offset:1024
    ds_read_b128 v[156:159], v15 offset:5632
    s_setprio 3
    v_exp_f32 v204, v204
    v_exp_f32 v205, v205
    v_cvt_pk_bf16_f32 v214, v200, v201
    v_cvt_pk_bf16_f32 v215, v202, v203
    s_waitcnt vmcnt(7) lgkmcnt(1)
    v_mfma_f32_16x16x32_bf16 v[248:251], v[120:123], v[152:155], v[248:251]
    buffer_load_dwordx4 v[120:123], v3, s[32:35], s30 offen offset:2048
    ds_read_b128 v[144:147], v15 offset:6144
    v_exp_f32 v206, v206
    v_exp_f32 v207, v207
    v_mfma_f32_32x32x16_bf16 v[220:235], v[72:75], v[212:215], v[220:235]
    v_exp_f32 v208, v208
    v_exp_f32 v209, v209
    v_exp_f32 v210, v210
    v_exp_f32 v211, v211
    v_cvt_pk_bf16_f32 v216, v204, v205
    v_cvt_pk_bf16_f32 v217, v206, v207
    s_waitcnt vmcnt(7) lgkmcnt(1)
    v_mfma_f32_16x16x32_bf16 v[248:251], v[124:127], v[156:159], v[248:251]
    buffer_load_dwordx4 v[124:127], v3, s[32:35], s30 offen offset:3072
    s_add_u32 s30, s30, 4096
    ds_read_b128 v[148:151], v15 offset:6656
    v_cvt_pk_bf16_f32 v218, v208, v209
    v_cvt_pk_bf16_f32 v219, v210, v211
    v_mfma_f32_32x32x16_bf16 v[196:211], v[36:39], v[236:239], 0
    v_exp_f32 v180, v180
    v_exp_f32 v181, v181
    v_exp_f32 v182, v182
    v_exp_f32 v183, v183
    v_mfma_f32_32x32x16_bf16 v[220:235], v[76:79], v[216:219], v[220:235]
    v_exp_f32 v184, v184
    v_exp_f32 v185, v185
    v_exp_f32 v186, v186
    v_exp_f32 v187, v187
    v_cvt_pk_bf16_f32 v212, v180, v181
    v_cvt_pk_bf16_f32 v213, v182, v183
    s_waitcnt vmcnt(7) lgkmcnt(1)
    v_mfma_f32_16x16x32_bf16 v[252:255], v[128:131], v[144:147], v[252:255]
    buffer_load_dwordx4 v[128:131], v3, s[32:35], s30 offen offset:0
    ds_read_b128 v[152:155], v15 offset:7168
    v_exp_f32 v188, v188
    v_exp_f32 v189, v189
    v_cvt_pk_bf16_f32 v214, v184, v185
    v_cvt_pk_bf16_f32 v215, v186, v187
    s_waitcnt vmcnt(7) lgkmcnt(1)
    v_mfma_f32_16x16x32_bf16 v[252:255], v[132:135], v[148:151], v[252:255]
    buffer_load_dwordx4 v[132:135], v3, s[32:35], s30 offen offset:1024
    ds_read_b128 v[156:159], v15 offset:7680
    v_exp_f32 v190, v190
    v_exp_f32 v191, v191
    v_mfma_f32_32x32x16_bf16 v[220:235], v[80:83], v[212:215], v[220:235]
    v_exp_f32 v192, v192
    v_exp_f32 v193, v193
    s_waitcnt vmcnt(7) lgkmcnt(1)
    v_mfma_f32_16x16x32_bf16 v[252:255], v[136:139], v[152:155], v[252:255]
    buffer_load_dwordx4 v[136:139], v3, s[32:35], s30 offen offset:2048
    v_exp_f32 v194, v194
    v_exp_f32 v195, v195
    v_cvt_pk_bf16_f32 v216, v188, v189
    v_cvt_pk_bf16_f32 v217, v190, v191
    s_waitcnt vmcnt(7) lgkmcnt(0)
    v_mfma_f32_16x16x32_bf16 v[252:255], v[140:143], v[156:159], v[252:255]
    buffer_load_dwordx4 v[140:143], v3, s[32:35], s30 offen offset:3072
    s_add_u32 s30, s30, 4096
    v_cvt_pk_bf16_f32 v218, v192, v193
    v_cvt_pk_bf16_f32 v219, v194, v195
    s_setprio 2
    v_mfma_f32_32x32x16_bf16 v[180:195], v[40:43], v[236:239], 0
    v_exp_f32 v196, v196
    v_exp_f32 v197, v197
    v_exp_f32 v198, v198
    v_exp_f32 v199, v199
    v_mfma_f32_32x32x16_bf16 v[220:235], v[84:87], v[216:219], v[220:235]
    v_exp_f32 v200, v200
    v_exp_f32 v201, v201
    v_exp_f32 v202, v202
    v_exp_f32 v203, v203
    v_cvt_pk_bf16_f32 v212, v196, v197
    v_cvt_pk_bf16_f32 v213, v198, v199
    v_exp_f32 v204, v204
    v_exp_f32 v205, v205
    v_cvt_pk_bf16_f32 v214, v200, v201
    v_cvt_pk_bf16_f32 v215, v202, v203
    v_exp_f32 v206, v206
    v_exp_f32 v207, v207
    v_mfma_f32_32x32x16_bf16 v[220:235], v[88:91], v[212:215], v[220:235]
    v_exp_f32 v208, v208
    v_exp_f32 v209, v209
    v_exp_f32 v210, v210
    v_exp_f32 v211, v211
    v_cvt_pk_bf16_f32 v216, v204, v205
    v_cvt_pk_bf16_f32 v217, v206, v207
    v_cvt_pk_bf16_f32 v218, v208, v209
    v_cvt_pk_bf16_f32 v219, v210, v211
    v_pk_add_f32 v[240:241], v[240:241], v[244:245]
    v_pk_add_f32 v[242:243], v[242:243], v[246:247]
    v_pk_add_f32 v[248:249], v[248:249], v[252:253]
    v_pk_add_f32 v[250:251], v[250:251], v[254:255]
    v_pk_add_f32 v[240:241], v[240:241], v[248:249]
    v_pk_add_f32 v[242:243], v[242:243], v[250:251]
    v_mul_f32 v240, s44, v240
    v_mul_f32 v241, s44, v241
    v_mul_f32 v242, s44, v242
    v_mul_f32 v243, s44, v243
    v_cvt_pk_bf16_f32 v144, v240, v241
    v_cvt_pk_bf16_f32 v145, v242, v243
    ds_write_b64 v11, v[144:145]
    v_add_u32 v11, 2048, v11
    v_mov_b64 v[240:241], 0
    v_mov_b64 v[242:243], 0
    v_mov_b64 v[244:245], 0
    v_mov_b64 v[246:247], 0
    v_mov_b64 v[248:249], 0
    v_mov_b64 v[250:251], 0
    v_mov_b64 v[252:253], 0
    v_mov_b64 v[254:255], 0
    s_waitcnt lgkmcnt(0)
    s_barrier
    v_mfma_f32_32x32x16_bf16 v[196:211], v[44:47], v[236:239], 0
    ds_read_b128 v[236:239], v4
    v_add_u32 v4, 1024, v4
    v_exp_f32 v180, v180
    v_exp_f32 v181, v181
    v_exp_f32 v182, v182
    v_exp_f32 v183, v183
    v_mfma_f32_32x32x16_bf16 v[220:235], v[92:95], v[216:219], v[220:235]
    v_exp_f32 v184, v184
    v_exp_f32 v185, v185
    v_exp_f32 v186, v186
    v_exp_f32 v187, v187
    v_cvt_pk_bf16_f32 v212, v180, v181
    v_cvt_pk_bf16_f32 v213, v182, v183
    v_exp_f32 v188, v188
    v_exp_f32 v189, v189
    v_cvt_pk_bf16_f32 v214, v184, v185
    v_cvt_pk_bf16_f32 v215, v186, v187
    v_exp_f32 v190, v190
    v_exp_f32 v191, v191
    v_mfma_f32_32x32x16_bf16 v[220:235], v[96:99], v[212:215], v[220:235]
    v_exp_f32 v192, v192
    v_exp_f32 v193, v193
    v_exp_f32 v194, v194
    v_exp_f32 v195, v195
    v_cvt_pk_bf16_f32 v216, v188, v189
    v_cvt_pk_bf16_f32 v217, v190, v191
    v_cvt_pk_bf16_f32 v218, v192, v193
    v_cvt_pk_bf16_f32 v219, v194, v195
    s_setprio 1
    s_waitcnt lgkmcnt(0)
    v_mfma_f32_32x32x16_bf16 v[180:195], v[16:19], v[236:239], 0
    v_exp_f32 v196, v196
    v_exp_f32 v197, v197
    v_exp_f32 v198, v198
    v_exp_f32 v199, v199
    v_mfma_f32_32x32x16_bf16 v[220:235], v[100:103], v[216:219], v[220:235]
    v_exp_f32 v200, v200
    v_exp_f32 v201, v201
    v_exp_f32 v202, v202
    v_exp_f32 v203, v203
    v_cvt_pk_bf16_f32 v212, v196, v197
    v_cvt_pk_bf16_f32 v213, v198, v199
    v_exp_f32 v204, v204
    v_exp_f32 v205, v205
    v_cvt_pk_bf16_f32 v214, v200, v201
    v_cvt_pk_bf16_f32 v215, v202, v203
    v_exp_f32 v206, v206
    v_exp_f32 v207, v207
    v_mfma_f32_32x32x16_bf16 v[220:235], v[104:107], v[212:215], v[220:235]
    v_exp_f32 v208, v208
    v_exp_f32 v209, v209
    v_exp_f32 v210, v210
    v_exp_f32 v211, v211
    v_cvt_pk_bf16_f32 v216, v204, v205
    v_cvt_pk_bf16_f32 v217, v206, v207
    v_cvt_pk_bf16_f32 v218, v208, v209
    v_cvt_pk_bf16_f32 v219, v210, v211
    s_mov_b32 s28, 2
k4a_slot:
    v_mfma_f32_32x32x16_bf16 v[196:211], v[20:23], v[236:239], 0
    v_exp_f32 v180, v180
    v_exp_f32 v181, v181
    v_exp_f32 v182, v182
    v_exp_f32 v183, v183
    v_mfma_f32_32x32x16_bf16 v[220:235], v[108:111], v[216:219], v[220:235]
    v_exp_f32 v184, v184
    v_exp_f32 v185, v185
    v_exp_f32 v186, v186
    v_exp_f32 v187, v187
    v_cvt_pk_bf16_f32 v212, v180, v181
    v_cvt_pk_bf16_f32 v213, v182, v183
    v_exp_f32 v188, v188
    v_exp_f32 v189, v189
    v_cvt_pk_bf16_f32 v214, v184, v185
    v_cvt_pk_bf16_f32 v215, v186, v187
    v_exp_f32 v190, v190
    v_exp_f32 v191, v191
    ds_write_b128 v5, v[220:223]
    ds_write_b128 v5, v[224:227] offset:1024
    ds_write_b32 v6, v228
    v_mfma_f32_32x32x16_bf16 v[220:235], v[48:51], v[212:215], 0
    v_exp_f32 v192, v192
    v_exp_f32 v193, v193
    v_exp_f32 v194, v194
    v_exp_f32 v195, v195
    v_cvt_pk_bf16_f32 v216, v188, v189
    v_cvt_pk_bf16_f32 v217, v190, v191
    v_cvt_pk_bf16_f32 v218, v192, v193
    v_cvt_pk_bf16_f32 v219, v194, v195
    s_and_b32 s37, s28, 3
    s_mov_b32 s37, -49920
    s_cselect_b32 s37, 16640, s37
    v_add_u32 v5, s37, v5
    s_mov_b32 s37, -6144
    s_cselect_b32 s37, 2048, s37
    v_add_u32 v6, s37, v6
    s_bitcmp0_b32 0x18, s28
    s_cbranch_scc1 k4a_noq
    v_pk_add_f32 v[240:241], v[240:241], v[244:245]
    v_pk_add_f32 v[242:243], v[242:243], v[246:247]
    v_pk_add_f32 v[248:249], v[248:249], v[252:253]
    v_pk_add_f32 v[250:251], v[250:251], v[254:255]
    v_pk_add_f32 v[240:241], v[240:241], v[248:249]
    v_pk_add_f32 v[242:243], v[242:243], v[250:251]
    v_mul_f32 v240, s44, v240
    v_mul_f32 v241, s44, v241
    v_mul_f32 v242, s44, v242
    v_mul_f32 v243, s44, v243
    v_cvt_pk_bf16_f32 v144, v240, v241
    v_cvt_pk_bf16_f32 v145, v242, v243
    ds_write_b64 v11, v[144:145]
    v_add_u32 v11, 2048, v11
    v_mov_b64 v[240:241], 0
    v_mov_b64 v[242:243], 0
    v_mov_b64 v[244:245], 0
    v_mov_b64 v[246:247], 0
    v_mov_b64 v[248:249], 0
    v_mov_b64 v[250:251], 0
    v_mov_b64 v[252:253], 0
    v_mov_b64 v[254:255], 0
k4a_noq:
    s_cmp_eq_u32 s28, 5
    s_cselect_b32 s37, 8192, 0
    s_bitcmp1_b32 0xd0, s28
    s_cselect_b32 s37, s64, s37
    s_cselect_b32 s38, 8192, 0
    s_add_u32 s64, s64, s38
    v_add_u32 v15, s37, v10
    s_cmp_ge_u32 s28, 4
    s_cselect_b64 vcc, -1, 0
    s_bitcmp0_b32 0x5c, s28
    s_cbranch_scc1 k4a_na0
    s_mov_b64 exec, 1
    ds_inc_u32 v0, v0
    s_mov_b64 exec, -1
k4a_na0:
    ds_read_b128 v[144:147], v15 offset:0
    ds_read_b128 v[148:151], v15 offset:512
    s_setprio 0
    v_mfma_f32_32x32x16_bf16 v[180:195], v[24:27], v[236:239], 0
    v_exp_f32 v196, v196
    v_exp_f32 v197, v197
    v_exp_f32 v198, v198
    v_exp_f32 v199, v199
    v_mfma_f32_32x32x16_bf16 v[220:235], v[52:55], v[216:219], v[220:235]
    v_exp_f32 v200, v200
    v_exp_f32 v201, v201
    v_exp_f32 v202, v202
    v_exp_f32 v203, v203
    v_cvt_pk_bf16_f32 v212, v196, v197
    v_cvt_pk_bf16_f32 v213, v198, v199
    s_waitcnt vmcnt(7) lgkmcnt(1)
    v_mfma_f32_16x16x32_bf16 v[240:243], v[112:115], v[144:147], v[240:243]
    buffer_load_dwordx4 v[112:115], v3, s[32:35], s30 offen offset:0
    ds_read_b128 v[152:155], v15 offset:1024
    v_exp_f32 v204, v204
    v_exp_f32 v205, v205
    v_cvt_pk_bf16_f32 v214, v200, v201
    v_cvt_pk_bf16_f32 v215, v202, v203
    v_exp_f32 v206, v206
    v_exp_f32 v207, v207
    v_mfma_f32_32x32x16_bf16 v[220:235], v[56:59], v[212:215], v[220:235]
    v_exp_f32 v208, v208
    v_exp_f32 v209, v209
    v_exp_f32 v210, v210
    v_exp_f32 v211, v211
    v_cvt_pk_bf16_f32 v216, v204, v205
    v_cvt_pk_bf16_f32 v217, v206, v207
    s_waitcnt vmcnt(7) lgkmcnt(1)
    v_mfma_f32_16x16x32_bf16 v[240:243], v[116:119], v[148:151], v[240:243]
    buffer_load_dwordx4 v[116:119], v3, s[32:35], s30 offen offset:1024
    ds_read_b128 v[156:159], v15 offset:1536
    v_cvt_pk_bf16_f32 v218, v208, v209
    v_cvt_pk_bf16_f32 v219, v210, v211
    v_mfma_f32_32x32x16_bf16 v[196:211], v[28:31], v[236:239], 0
    v_exp_f32 v180, v180
    v_exp_f32 v181, v181
    v_exp_f32 v182, v182
    v_exp_f32 v183, v183
    v_mfma_f32_32x32x16_bf16 v[220:235], v[60:63], v[216:219], v[220:235]
    v_exp_f32 v184, v184
    v_exp_f32 v185, v185
    v_exp_f32 v186, v186
    v_exp_f32 v187, v187
    v_cvt_pk_bf16_f32 v212, v180, v181
    v_cvt_pk_bf16_f32 v213, v182, v183
    s_waitcnt vmcnt(7) lgkmcnt(1)
    v_mfma_f32_16x16x32_bf16 v[240:243], v[120:123], v[152:155], v[240:243]
    buffer_load_dwordx4 v[120:123], v3, s[32:35], s30 offen offset:2048
    s_cbranch_vccnz k4a_nb2
    ds_read_b128 v[144:147], v15 offset:2048
k4a_nb2:
    v_exp_f32 v188, v188
    v_exp_f32 v189, v189
    v_cvt_pk_bf16_f32 v214, v184, v185
    v_cvt_pk_bf16_f32 v215, v186, v187
    v_exp_f32 v190, v190
    v_exp_f32 v191, v191
    v_mfma_f32_32x32x16_bf16 v[220:235], v[64:67], v[212:215], v[220:235]
    v_exp_f32 v192, v192
    v_exp_f32 v193, v193
    v_exp_f32 v194, v194
    v_exp_f32 v195, v195
    v_cvt_pk_bf16_f32 v216, v188, v189
    v_cvt_pk_bf16_f32 v217, v190, v191
    s_waitcnt vmcnt(7) lgkmcnt(0)
    v_mfma_f32_16x16x32_bf16 v[240:243], v[124:127], v[156:159], v[240:243]
    buffer_load_dwordx4 v[124:127], v3, s[32:35], s30 offen offset:3072
    s_add_u32 s30, s30, 4096
    s_cbranch_vccnz k4a_nb3
    ds_read_b128 v[148:151], v15 offset:2560
k4a_nb3:
    ds_read_b32 v14, v0
    v_cvt_pk_bf16_f32 v218, v192, v193
    v_cvt_pk_bf16_f32 v219, v194, v195
    v_mfma_f32_32x32x16_bf16 v[180:195], v[32:35], v[236:239], 0
    v_exp_f32 v196, v196
    v_exp_f32 v197, v197
    v_exp_f32 v198, v198
    v_exp_f32 v199, v199
    v_mfma_f32_32x32x16_bf16 v[220:235], v[68:71], v[216:219], v[220:235]
    v_exp_f32 v200, v200
    v_exp_f32 v201, v201
    v_exp_f32 v202, v202
    v_exp_f32 v203, v203
    v_cvt_pk_bf16_f32 v212, v196, v197
    v_cvt_pk_bf16_f32 v213, v198, v199
    s_waitcnt vmcnt(7) lgkmcnt(1)
    v_mfma_f32_16x16x32_bf16 v[244:247], v[128:131], v[144:147], v[244:247]
    buffer_load_dwordx4 v[128:131], v3, s[32:35], s30 offen offset:0
    s_bitcmp0_b32 0x5c, s28
    s_cbranch_scc1 k4a_nw0
    s_waitcnt lgkmcnt(0)
    v_readfirstlane_b32 s37, v14
    s_cmp_ge_u32 s37, s76
    s_cbranch_scc0 k4a_wsa
k4a_woa:
    s_add_u32 s76, s76, 8
k4a_nw0:
    s_cbranch_vccnz k4a_nb4
    ds_read_b128 v[152:155], v15 offset:3072
k4a_nb4:
    s_setprio 3
    s_bitcmp1_b32 s28, 0
    s_cbranch_scc1 k4a_nrr
    ds_read_b128 v[160:163], v7 offset:0
    ds_read_b32 v176, v8 offset:0
    ds_read_b128 v[164:167], v7 offset:2080
    ds_read_b32 v177, v8 offset:256
    ds_read_b128 v[168:171], v7 offset:4160
    ds_read_b32 v178, v8 offset:512
    ds_read_b128 v[172:175], v7 offset:6240
    ds_read_b32 v179, v8 offset:768
k4a_nrr:
    v_exp_f32 v204, v204
    v_exp_f32 v205, v205
    v_cvt_pk_bf16_f32 v214, v200, v201
    v_cvt_pk_bf16_f32 v215, v202, v203
    v_exp_f32 v206, v206
    v_exp_f32 v207, v207
    v_mfma_f32_32x32x16_bf16 v[220:235], v[72:75], v[212:215], v[220:235]
    v_exp_f32 v208, v208
    v_exp_f32 v209, v209
    v_exp_f32 v210, v210
    v_exp_f32 v211, v211
    v_cvt_pk_bf16_f32 v216, v204, v205
    v_cvt_pk_bf16_f32 v217, v206, v207
    s_waitcnt vmcnt(7) lgkmcnt(1)
    v_mfma_f32_16x16x32_bf16 v[244:247], v[132:135], v[148:151], v[244:247]
    buffer_load_dwordx4 v[132:135], v3, s[32:35], s30 offen offset:1024
    s_cbranch_vccnz k4a_nb5
    ds_read_b128 v[156:159], v15 offset:3584
k4a_nb5:
    v_cvt_pk_bf16_f32 v218, v208, v209
    v_cvt_pk_bf16_f32 v219, v210, v211
    s_bitcmp0_b32 0xa0, s28
    s_cbranch_scc1 k4a_nodma
    s_mov_b32 m0, s72
    s_nop 0
    buffer_load_dwordx4 v3, s[20:23], s71 offen offset:0 lds
    buffer_load_dwordx4 v3, s[20:23], s71 offen offset:1024 lds
    buffer_load_dwordx4 v3, s[20:23], s71 offen offset:2048 lds
    buffer_load_dwordx4 v3, s[20:23], s71 offen offset:3072 lds
    s_mov_b32 s72, s73
    s_add_u32 s71, s71, 32768
k4a_nodma:
    v_mfma_f32_32x32x16_bf16 v[196:211], v[36:39], v[236:239], 0
    v_exp_f32 v180, v180
    v_exp_f32 v181, v181
    v_exp_f32 v182, v182
    v_exp_f32 v183, v183
    v_mfma_f32_32x32x16_bf16 v[220:235], v[76:79], v[216:219], v[220:235]
    v_exp_f32 v184, v184
    v_exp_f32 v185, v185
    v_exp_f32 v186, v186
    v_exp_f32 v187, v187
    v_cvt_pk_bf16_f32 v212, v180, v181
    v_cvt_pk_bf16_f32 v213, v182, v183
    s_waitcnt vmcnt(7) lgkmcnt(1)
    v_mfma_f32_16x16x32_bf16 v[244:247], v[136:139], v[152:155], v[244:247]
    buffer_load_dwordx4 v[136:139], v3, s[32:35], s30 offen offset:2048
    s_cbranch_vccnz k4a_nb6
    ds_read_b128 v[144:147], v15 offset:4096
k4a_nb6:
    v_exp_f32 v188, v188
    v_exp_f32 v189, v189
    v_cvt_pk_bf16_f32 v214, v184, v185
    v_cvt_pk_bf16_f32 v215, v186, v187
    v_exp_f32 v190, v190
    v_exp_f32 v191, v191
    v_mfma_f32_32x32x16_bf16 v[220:235], v[80:83], v[212:215], v[220:235]
    v_exp_f32 v192, v192
    v_exp_f32 v193, v193
    v_exp_f32 v194, v194
    v_exp_f32 v195, v195
    v_cvt_pk_bf16_f32 v216, v188, v189
    v_cvt_pk_bf16_f32 v217, v190, v191
    s_waitcnt vmcnt(7) lgkmcnt(1)
    v_mfma_f32_16x16x32_bf16 v[244:247], v[140:143], v[156:159], v[244:247]
    buffer_load_dwordx4 v[140:143], v3, s[32:35], s30 offen offset:3072
    s_cbranch_vccnz k4a_nb7
    ds_read_b128 v[148:151], v15 offset:4608
k4a_nb7:
    v_cvt_pk_bf16_f32 v218, v192, v193
    v_cvt_pk_bf16_f32 v219, v194, v195
    s_bitcmp1_b32 s28, 0
    s_cbranch_scc1 k4a_nored
    s_waitcnt lgkmcnt(0)
    v_pk_add_f32 v[160:161], v[160:161], v[164:165]
    v_pk_add_f32 v[162:163], v[162:163], v[166:167]
    v_add_f32 v176, v176, v177
    v_pk_add_f32 v[168:169], v[168:169], v[172:173]
    v_pk_add_f32 v[170:171], v[170:171], v[174:175]
    v_add_f32 v178, v178, v179
    v_pk_add_f32 v[160:161], v[160:161], v[168:169]
    v_add_f32 v176, v176, v178
    v_pk_add_f32 v[162:163], v[162:163], v[170:171]
    v_add_f32_dpp v160, v160, v160 quad_perm:[1,0,3,2] row_mask:0xf bank_mask:0xf
    v_add_f32_dpp v176, v176, v176 quad_perm:[1,0,3,2] row_mask:0xf bank_mask:0xf
    v_add_f32_dpp v161, v161, v161 quad_perm:[1,0,3,2] row_mask:0xf bank_mask:0xf
    v_add_f32_dpp v162, v162, v162 quad_perm:[1,0,3,2] row_mask:0xf bank_mask:0xf
    v_add_f32_dpp v163, v163, v163 quad_perm:[1,0,3,2] row_mask:0xf bank_mask:0xf
    v_rcp_f32 v177, v176
    v_max3_f32 v178, |v160|, |v161|, |v162|
    v_max_f32 v178, |v163|, v178
    v_cmp_le_f32 s[50:51], s45, v176
    v_cmp_ge_f32 s[52:53], s46, v176
    v_cmp_gt_f32 s[54:55], s47, v178
    v_add_f32 v179, v160, v161
    v_add_f32 v178, v162, v163
    v_cmp_o_f32 s[56:57], v179, v178
    s_and_b64 s[50:51], s[50:51], s[52:53]
    s_and_b64 s[54:55], s[54:55], s[56:57]
    s_and_b64 s[50:51], s[50:51], s[54:55]
    v_pk_mul_f32 v[160:161], v[160:161], v[176:177] op_sel:[0,1] op_sel_hi:[1,1]
    v_pk_mul_f32 v[162:163], v[162:163], v[176:177] op_sel:[0,1] op_sel_hi:[1,1]
    v_cvt_pk_bf16_f32 v160, v160, v161
    v_cvt_pk_bf16_f32 v161, v162, v163
    v_cndmask_b32 v160, 0, v160, s[50:51]
    v_cndmask_b32 v161, 0, v161, s[50:51]
    ds_write_b64 v9, v[160:161] offset:0
    s_cmp_eq_u64 s[50:51], exec
    s_cbranch_scc1 k4a_rokl
    v_mov_b32 v13, s49
    v_cndmask_b32 v13, v13, 0, s[50:51]
    v_or_b32 v12, v12, v13
    v_mov_b32 v14, 132096
    ds_or_b32 v14, v13
k4a_rokl:
    v_add_u32 v9, 8192, v9
    s_and_b32 s37, s49, 5
    s_mov_b32 s37, -33280
    s_cselect_b32 s37, 33280, s37
    v_add_u32 v7, s37, v7
    s_mov_b32 s37, -4096
    s_cselect_b32 s37, 4096, s37
    v_add_u32 v8, s37, v8
    s_lshl_b32 s49, s49, 1
k4a_nored:
    s_setprio 2
    v_mfma_f32_32x32x16_bf16 v[180:195], v[40:43], v[236:239], 0
    v_exp_f32 v196, v196
    v_exp_f32 v197, v197
    v_exp_f32 v198, v198
    v_exp_f32 v199, v199
    v_mfma_f32_32x32x16_bf16 v[220:235], v[84:87], v[216:219], v[220:235]
    v_exp_f32 v200, v200
    v_exp_f32 v201, v201
    v_exp_f32 v202, v202
    v_exp_f32 v203, v203
    v_cvt_pk_bf16_f32 v212, v196, v197
    v_cvt_pk_bf16_f32 v213, v198, v199
    s_add_u32 s37, s28, 1
    s_cmp_eq_u32 s37, 3
    s_cselect_b32 s30, s58, s59
    s_bitcmp1_b32 0x1d0, s37
    s_cselect_b32 s38, 16384, 0
    s_add_u32 s59, s59, s38
    s_cmp_eq_u32 s37, 5
    s_cselect_b32 s34, 0, 0x1300000
    s_waitcnt vmcnt(7) lgkmcnt(1)
    v_mfma_f32_16x16x32_bf16 v[248:251], v[112:115], v[144:147], v[248:251]
    buffer_load_dwordx4 v[112:115], v3, s[32:35], s30 offen offset:0
    s_cbranch_vccnz k4a_nb8
    ds_read_b128 v[152:155], v15 offset:5120
k4a_nb8:
    v_exp_f32 v204, v204
    v_exp_f32 v205, v205
    v_cvt_pk_bf16_f32 v214, v200, v201
    v_cvt_pk_bf16_f32 v215, v202, v203
    v_exp_f32 v206, v206
    v_exp_f32 v207, v207
    v_mfma_f32_32x32x16_bf16 v[220:235], v[88:91], v[212:215], v[220:235]
    v_exp_f32 v208, v208
    v_exp_f32 v209, v209
    v_exp_f32 v210, v210
    v_exp_f32 v211, v211
    v_cvt_pk_bf16_f32 v216, v204, v205
    v_cvt_pk_bf16_f32 v217, v206, v207
    s_waitcnt vmcnt(7) lgkmcnt(1)
    v_mfma_f32_16x16x32_bf16 v[248:251], v[116:119], v[148:151], v[248:251]
    buffer_load_dwordx4 v[116:119], v3, s[32:35], s30 offen offset:1024
    s_cbranch_vccnz k4a_nb9
    ds_read_b128 v[156:159], v15 offset:5632
k4a_nb9:
    v_cvt_pk_bf16_f32 v218, v208, v209
    v_cvt_pk_bf16_f32 v219, v210, v211
    s_bitcmp0_b32 0x50, s28
    s_cbranch_scc1 k4a_na1
    s_mov_b64 exec, 1
    ds_inc_u32 v0, v0
    s_mov_b64 exec, -1
k4a_na1:
    v_mfma_f32_32x32x16_bf16 v[196:211], v[44:47], v[236:239], 0
    ds_read_b128 v[236:239], v4
    v_add_u32 v4, 1024, v4
    v_exp_f32 v180, v180
    v_exp_f32 v181, v181
    v_exp_f32 v182, v182
    v_exp_f32 v183, v183
    v_mfma_f32_32x32x16_bf16 v[220:235], v[92:95], v[216:219], v[220:235]
    v_exp_f32 v184, v184
    v_exp_f32 v185, v185
    v_exp_f32 v186, v186
    v_exp_f32 v187, v187
    v_cvt_pk_bf16_f32 v212, v180, v181
    v_cvt_pk_bf16_f32 v213, v182, v183
    s_waitcnt vmcnt(7) lgkmcnt(1)
    v_mfma_f32_16x16x32_bf16 v[248:251], v[120:123], v[152:155], v[248:251]
    buffer_load_dwordx4 v[120:123], v3, s[32:35], s30 offen offset:2048
    s_cbranch_vccnz k4a_nb10
    ds_read_b128 v[144:147], v15 offset:6144
k4a_nb10:
    v_exp_f32 v188, v188
    v_exp_f32 v189, v189
    v_cvt_pk_bf16_f32 v214, v184, v185
    v_cvt_pk_bf16_f32 v215, v186, v187
    s_waitcnt vmcnt(7) lgkmcnt(1)
    v_mfma_f32_16x16x32_bf16 v[248:251], v[124:127], v[156:159], v[248:251]
    buffer_load_dwordx4 v[124:127], v3, s[32:35], s30 offen offset:3072
    s_add_u32 s30, s30, 4096
    s_cbranch_vccnz k4a_nb11
    ds_read_b128 v[148:151], v15 offset:6656
k4a_nb11:
    v_exp_f32 v190, v190
    v_exp_f32 v191, v191
    v_mfma_f32_32x32x16_bf16 v[220:235], v[96:99], v[212:215], v[220:235]
    v_exp_f32 v192, v192
    v_exp_f32 v193, v193
    v_exp_f32 v194, v194
    v_exp_f32 v195, v195
    v_cvt_pk_bf16_f32 v216, v188, v189
    v_cvt_pk_bf16_f32 v217, v190, v191
    s_waitcnt vmcnt(7) lgkmcnt(1)
    v_mfma_f32_16x16x32_bf16 v[252:255], v[128:131], v[144:147], v[252:255]
    buffer_load_dwordx4 v[128:131], v3, s[32:35], s30 offen offset:0
    s_cbranch_vccnz k4a_nb12
    ds_read_b128 v[152:155], v15 offset:7168
k4a_nb12:
    v_cvt_pk_bf16_f32 v218, v192, v193
    v_cvt_pk_bf16_f32 v219, v194, v195
    s_setprio 1
    s_waitcnt lgkmcnt(0)
    v_mfma_f32_32x32x16_bf16 v[180:195], v[16:19], v[236:239], 0
    v_exp_f32 v196, v196
    v_exp_f32 v197, v197
    v_exp_f32 v198, v198
    v_exp_f32 v199, v199
    v_mfma_f32_32x32x16_bf16 v[220:235], v[100:103], v[216:219], v[220:235]
    v_exp_f32 v200, v200
    v_exp_f32 v201, v201
    v_exp_f32 v202, v202
    v_exp_f32 v203, v203
    v_cvt_pk_bf16_f32 v212, v196, v197
    v_cvt_pk_bf16_f32 v213, v198, v199
    s_waitcnt vmcnt(7) lgkmcnt(1)
    v_mfma_f32_16x16x32_bf16 v[252:255], v[132:135], v[148:151], v[252:255]
    buffer_load_dwordx4 v[132:135], v3, s[32:35], s30 offen offset:1024
    s_cbranch_vccnz k4a_nb13
    ds_read_b128 v[156:159], v15 offset:7680
k4a_nb13:
    v_exp_f32 v204, v204
    v_exp_f32 v205, v205
    v_cvt_pk_bf16_f32 v214, v200, v201
    v_cvt_pk_bf16_f32 v215, v202, v203
    s_waitcnt vmcnt(7) lgkmcnt(1)
    v_mfma_f32_16x16x32_bf16 v[252:255], v[136:139], v[152:155], v[252:255]
    buffer_load_dwordx4 v[136:139], v3, s[32:35], s30 offen offset:2048
    ds_read_b32 v14, v0
    v_exp_f32 v206, v206
    v_exp_f32 v207, v207
    v_mfma_f32_32x32x16_bf16 v[220:235], v[104:107], v[212:215], v[220:235]
    v_exp_f32 v208, v208
    v_exp_f32 v209, v209
    v_exp_f32 v210, v210
    v_exp_f32 v211, v211
    v_cvt_pk_bf16_f32 v216, v204, v205
    v_cvt_pk_bf16_f32 v217, v206, v207
    s_waitcnt vmcnt(7) lgkmcnt(0)
    v_mfma_f32_16x16x32_bf16 v[252:255], v[140:143], v[156:159], v[252:255]
    buffer_load_dwordx4 v[140:143], v3, s[32:35], s30 offen offset:3072
    s_add_u32 s30, s30, 4096
    v_cvt_pk_bf16_f32 v218, v208, v209
    v_cvt_pk_bf16_f32 v219, v210, v211
    s_bitcmp0_b32 0x60, s28
    s_cbranch_scc1 k4a_nw1
    v_readfirstlane_b32 s37, v14
    s_cmp_ge_u32 s37, s76
    s_cbranch_scc0 k4a_wsb
k4a_wob:
    s_add_u32 s76, s76, 8
k4a_nw1:
    s_add_u32 s28, s28, 1
    s_cmp_lt_u32 s28, 8
    s_cbranch_scc1 k4a_slot
    v_mfma_f32_32x32x16_bf16 v[220:235], v[108:111], v[216:219], v[220:235]
    v_and_b32 v204, 7, v2
    v_lshrrev_b32 v205, 4, v2
    v_lshlrev_b32 v204, 10, v204
    v_lshl_add_u32 v204, v205, 3, v204
    s_lshl_b32 s31, s3, 7
    v_add_u32 v11, s31, v204
    v_add_u32 v15, s64, v10
    buffer_load_dwordx4 v[16:19], v3, s[20:23], s30 offen offset:0
    buffer_load_dwordx4 v[20:23], v3, s[20:23], s30 offen offset:1024
    buffer_load_dwordx4 v[24:27], v3, s[20:23], s30 offen offset:2048
    buffer_load_dwordx4 v[28:31], v3, s[20:23], s30 offen offset:3072
    s_add_u32 s30, s30, 4096
    ds_write_b128 v5, v[220:223]
    ds_write_b128 v5, v[224:227] offset:1024
    ds_write_b32 v6, v228
    buffer_load_dwordx4 v[32:35], v3, s[20:23], s30 offen offset:0
    buffer_load_dwordx4 v[36:39], v3, s[20:23], s30 offen offset:1024
    buffer_load_dwordx4 v[40:43], v3, s[20:23], s30 offen offset:2048
    buffer_load_dwordx4 v[44:47], v3, s[20:23], s30 offen offset:3072
    v_add_u32 v5, -49920, v5
    v_add_u32 v6, -6144, v6
    s_cmp_gt_u32 s3, 4
    s_cbranch_scc1 k4a_d1
    s_mov_b32 m0, s74
    s_nop 0
    buffer_load_dwordx4 v3, s[20:23], s71 offen offset:0 lds
    buffer_load_dwordx4 v3, s[20:23], s71 offen offset:1024 lds
    buffer_load_dwordx4 v3, s[20:23], s71 offen offset:2048 lds
    buffer_load_dwordx4 v3, s[20:23], s71 offen offset:3072 lds
k4a_d1:
    s_waitcnt lgkmcnt(0)
    s_barrier
    ds_read_b128 v[160:163], v7 offset:0
    ds_read_b32 v176, v8 offset:0
    ds_read_b128 v[164:167], v7 offset:2080
    ds_read_b32 v177, v8 offset:256
    ds_read_b128 v[168:171], v7 offset:4160
    ds_read_b32 v178, v8 offset:512
    ds_read_b128 v[172:175], v7 offset:6240
    ds_read_b32 v179, v8 offset:768
    ds_read_b64 v[196:197], v11 offset:16384
    ds_read_b64 v[198:199], v11 offset:16416
    ds_read_b64 v[200:201], v11 offset:16448
    ds_read_b64 v[202:203], v11 offset:16480
    s_waitcnt lgkmcnt(4)
    v_pk_add_f32 v[160:161], v[160:161], v[164:165]
    v_pk_add_f32 v[162:163], v[162:163], v[166:167]
    v_add_f32 v176, v176, v177
    v_pk_add_f32 v[168:169], v[168:169], v[172:173]
    v_pk_add_f32 v[170:171], v[170:171], v[174:175]
    v_add_f32 v178, v178, v179
    v_pk_add_f32 v[160:161], v[160:161], v[168:169]
    v_add_f32 v176, v176, v178
    v_pk_add_f32 v[162:163], v[162:163], v[170:171]
    v_add_f32_dpp v160, v160, v160 quad_perm:[1,0,3,2] row_mask:0xf bank_mask:0xf
    v_add_f32_dpp v176, v176, v176 quad_perm:[1,0,3,2] row_mask:0xf bank_mask:0xf
    v_add_f32_dpp v161, v161, v161 quad_perm:[1,0,3,2] row_mask:0xf bank_mask:0xf
    v_add_f32_dpp v162, v162, v162 quad_perm:[1,0,3,2] row_mask:0xf bank_mask:0xf
    v_add_f32_dpp v163, v163, v163 quad_perm:[1,0,3,2] row_mask:0xf bank_mask:0xf
    v_rcp_f32 v177, v176
    v_max3_f32 v178, |v160|, |v161|, |v162|
    v_max_f32 v178, |v163|, v178
    v_cmp_le_f32 s[50:51], s45, v176
    v_cmp_ge_f32 s[52:53], s46, v176
    v_cmp_gt_f32 s[54:55], s47, v178
    v_add_f32 v179, v160, v161
    v_add_f32 v178, v162, v163
    v_cmp_o_f32 s[56:57], v179, v178
    s_and_b64 s[50:51], s[50:51], s[52:53]
    s_and_b64 s[54:55], s[54:55], s[56:57]
    s_and_b64 s[50:51], s[50:51], s[54:55]
    v_pk_mul_f32 v[160:161], v[160:161], v[176:177] op_sel:[0,1] op_sel_hi:[1,1]
    v_pk_mul_f32 v[162:163], v[162:163], v[176:177] op_sel:[0,1] op_sel_hi:[1,1]
    v_cvt_pk_bf16_f32 v160, v160, v161
    v_cvt_pk_bf16_f32 v161, v162, v163
    v_cndmask_b32 v160, 0, v160, s[50:51]
    v_cndmask_b32 v161, 0, v161, s[50:51]
    ds_write_b64 v9, v[160:161] offset:0
    s_cmp_eq_u64 s[50:51], exec
    s_cbranch_scc1 k4a_rokf
    v_mov_b32 v13, s49
    v_cndmask_b32 v13, v13, 0, s[50:51]
    v_or_b32 v12, v12, v13
    v_mov_b32 v14, 132096
    ds_or_b32 v14, v13
k4a_rokf:
    v_add_u32 v9, 8192, v9
    s_and_b32 s37, s49, 5
    s_mov_b32 s37, -33280
    s_cselect_b32 s37, 33280, s37
    v_add_u32 v7, s37, v7
    s_mov_b32 s37, -4096
    s_cselect_b32 s37, 4096, s37
    v_add_u32 v8, s37, v8
    s_lshl_b32 s49, s49, 1
    s_waitcnt lgkmcnt(0)
    s_barrier
    v_mov_b32 v14, 132096
    ds_read_b32 v13, v14
    ds_read_b128 v[144:147], v15 offset:0
    ds_read_b128 v[148:151], v15 offset:512
    ds_read_b128 v[152:155], v15 offset:1024
    ds_read_b128 v[156:159], v15 offset:1536
    s_waitcnt vmcnt(8)
    s_waitcnt lgkmcnt(3)
    v_mfma_f32_16x16x32_bf16 v[240:243], v[112:115], v[144:147], v[240:243]
    v_mfma_f32_16x16x32_bf16 v[244:247], v[128:131], v[144:147], v[244:247]
    s_waitcnt lgkmcnt(2)
    v_mfma_f32_16x16x32_bf16 v[240:243], v[116:119], v[148:151], v[240:243]
    v_mfma_f32_16x16x32_bf16 v[244:247], v[132:135], v[148:151], v[244:247]
    s_waitcnt lgkmcnt(1)
    v_mfma_f32_16x16x32_bf16 v[240:243], v[120:123], v[152:155], v[240:243]
    v_mfma_f32_16x16x32_bf16 v[244:247], v[136:139], v[152:155], v[244:247]
    s_waitcnt lgkmcnt(0)
    v_mfma_f32_16x16x32_bf16 v[240:243], v[124:127], v[156:159], v[240:243]
    v_mfma_f32_16x16x32_bf16 v[244:247], v[140:143], v[156:159], v[244:247]
    s_cmp_gt_u32 s3, 4
    s_cbranch_scc1 k4a_o0
    s_waitcnt vmcnt(4)
    s_branch k4a_o1
k4a_o0:
    s_waitcnt vmcnt(0)
k4a_o1:
    v_mfma_f32_16x16x32_bf16 v[248:251], v[16:19], v[144:147], v[248:251]
    v_mfma_f32_16x16x32_bf16 v[252:255], v[32:35], v[144:147], v[252:255]
    v_mfma_f32_16x16x32_bf16 v[248:251], v[20:23], v[148:151], v[248:251]
    v_mfma_f32_16x16x32_bf16 v[252:255], v[36:39], v[148:151], v[252:255]
    v_mfma_f32_16x16x32_bf16 v[248:251], v[24:27], v[152:155], v[248:251]
    v_mfma_f32_16x16x32_bf16 v[252:255], v[40:43], v[152:155], v[252:255]
    v_mfma_f32_16x16x32_bf16 v[248:251], v[28:31], v[156:159], v[248:251]
    v_mfma_f32_16x16x32_bf16 v[252:255], v[44:47], v[156:159], v[252:255]
    s_cmp_le_u32 s3, 4
    s_cbranch_scc1 k4a_d2
    s_mov_b32 m0, s74
    s_nop 0
    buffer_load_dwordx4 v3, s[20:23], s71 offen offset:0 lds
    buffer_load_dwordx4 v3, s[20:23], s71 offen offset:1024 lds
    buffer_load_dwordx4 v3, s[20:23], s71 offen offset:2048 lds
    buffer_load_dwordx4 v3, s[20:23], s71 offen offset:3072 lds
k4a_d2:
    v_readfirstlane_b32 s48, v13
    s_lshl_b32 s30, s29, 13
    s_mov_b32 s40, 0x00ff00ff
    s_mov_b32 s41, 0x00ff00ff
    s_cmp_lg_u32 s48, 0
    s_cbranch_scc1 k4a_fb
k4a_epi:
    v_lshlrev_b32 v180, 16, v196
    v_and_b32 v181, 0xffff0000, v196
    v_lshlrev_b32 v182, 16, v197
    v_and_b32 v183, 0xffff0000, v197
    v_lshlrev_b32 v184, 16, v198
    v_and_b32 v185, 0xffff0000, v198
    v_lshlrev_b32 v186, 16, v199
    v_and_b32 v187, 0xffff0000, v199
    v_lshlrev_b32 v188, 16, v200
    v_and_b32 v189, 0xffff0000, v200
    v_lshlrev_b32 v190, 16, v201
    v_and_b32 v191, 0xffff0000, v201
    v_lshlrev_b32 v192, 16, v202
    v_and_b32 v193, 0xffff0000, v202
    v_lshlrev_b32 v194, 16, v203
    v_and_b32 v195, 0xffff0000, v203
    v_pk_add_f32 v[180:181], v[180:181], v[240:241]
    v_pk_add_f32 v[182:183], v[182:183], v[242:243]
    v_pk_add_f32 v[184:185], v[184:185], v[244:245]
    v_pk_add_f32 v[186:187], v[186:187], v[246:247]
    v_pk_add_f32 v[188:189], v[188:189], v[248:249]
    v_pk_add_f32 v[190:191], v[190:191], v[250:251]
    v_pk_add_f32 v[192:193], v[192:193], v[252:253]
    v_pk_add_f32 v[194:195], v[194:195], v[254:255]
    v_pk_add_f32 v[160:161], v[180:181], v[182:183]
    v_pk_mul_f32 v[162:163], v[180:181], v[180:181]
    v_pk_fma_f32 v[162:163], v[182:183], v[182:183], v[162:163]
    v_pk_add_f32 v[160:161], v[160:161], v[184:185]
    v_pk_fma_f32 v[162:163], v[184:185], v[184:185], v[162:163]
    v_pk_add_f32 v[160:161], v[160:161], v[186:187]
    v_pk_fma_f32 v[162:163], v[186:187], v[186:187], v[162:163]
    v_pk_add_f32 v[160:161], v[160:161], v[188:189]
    v_pk_fma_f32 v[162:163], v[188:189], v[188:189], v[162:163]
    v_pk_add_f32 v[160:161], v[160:161], v[190:191]
    v_pk_fma_f32 v[162:163], v[190:191], v[190:191], v[162:163]
    v_pk_add_f32 v[160:161], v[160:161], v[192:193]
    v_pk_fma_f32 v[162:163], v[192:193], v[192:193], v[162:163]
    v_pk_add_f32 v[160:161], v[160:161], v[194:195]
    v_pk_fma_f32 v[162:163], v[194:195], v[194:195], v[162:163]
    v_add_f32 v160, v160, v161
    v_add_f32 v161, v162, v163
    v_and_b32 v13, 7, v2
    v_lshlrev_b32 v13, 8, v13
    v_add_u32 v13, 136256, v13
    v_lshrrev_b32 v15, 4, v2
    s_lshl_b32 s37, s3, 5
    v_lshl_add_u32 v14, v15, 3, v13
    v_add_u32 v14, s37, v14
    ds_write_b64 v14, v[160:161]
    v_lshl_add_u32 v13, v15, 6, v13
    s_lshr_b32 s37, s29, 2
    s_lshl_b32 s37, s37, 15
    s_and_b32 s38, s29, 3
    s_lshl_b32 s38, s38, 7
    s_add_u32 s37, s37, s38
    s_lshl_b32 s38, s3, 12
    s_add_u32 s37, s37, s38
    s_add_u32 s37, s37, 0xf00000
    v_and_b32 v15, 7, v2
    v_lshlrev_b32 v15, 4, v15
    v_lshrrev_b32 v14, 5, v2
    v_lshl_add_u32 v15, v14, 9, v15
    v_bfe_u32 v14, v2, 3, 2
    v_lshl_add_u32 v15, v14, 10, v15
    s_waitcnt lgkmcnt(0)
    s_barrier
    ds_read_b128 v[160:163], v13 offset:0
    ds_read_b128 v[164:167], v13 offset:16
    ds_read_b128 v[168:171], v13 offset:32
    ds_read_b128 v[172:175], v13 offset:48
    v_cvt_pk_bf16_f32 v196, v180, v181
    v_cvt_pk_bf16_f32 v197, v182, v183
    v_cvt_pk_bf16_f32 v198, v184, v185
    v_cvt_pk_bf16_f32 v199, v186, v187
    v_cvt_pk_bf16_f32 v200, v188, v189
    v_cvt_pk_bf16_f32 v201, v190, v191
    v_cvt_pk_bf16_f32 v202, v192, v193
    v_cvt_pk_bf16_f32 v203, v194, v195
    v_and_b32 v208, 7, v2
    v_lshlrev_b32 v208, 10, v208
    v_bfe_u32 v209, v2, 3, 2
    v_lshl_add_u32 v208, v209, 5, v208
    v_lshrrev_b32 v209, 5, v2
    v_lshl_add_u32 v208, v209, 4, v208
    s_lshl_b32 s31, s3, 7
    s_add_u32 s31, s31, s30
    v_permlane16_swap_b32 v196, v200
    v_permlane16_swap_b32 v197, v201
    v_permlane16_swap_b32 v198, v202
    v_permlane16_swap_b32 v199, v203
    v_cndmask_b32 v204, v198, v196, s[40:41]
    v_cndmask_b32 v205, v199, v197, s[40:41]
    v_cndmask_b32 v206, v202, v200, s[40:41]
    v_cndmask_b32 v207, v203, v201, s[40:41]
    buffer_store_dwordx4 v[204:207], v208, s[24:27], s31 offen sc1
    s_waitcnt lgkmcnt(0)
    v_pk_add_f32 v[160:161], v[160:161], v[162:163]
    v_pk_add_f32 v[164:165], v[164:165], v[166:167]
    v_pk_add_f32 v[168:169], v[168:169], v[170:171]
    v_pk_add_f32 v[172:173], v[172:173], v[174:175]
    v_pk_add_f32 v[160:161], v[160:161], v[164:165]
    v_pk_add_f32 v[168:169], v[168:169], v[172:173]
    v_pk_add_f32 v[160:161], v[160:161], v[168:169]
    v_mov_b64 v[162:163], v[160:161]
    s_nop 1
    v_permlane16_swap_b32 v160, v162
    v_permlane16_swap_b32 v161, v163
    v_pk_add_f32 v[160:161], v[160:161], v[162:163]
    v_mov_b64 v[162:163], v[160:161]
    s_nop 1
    v_permlane32_swap_b32 v160, v162
    v_permlane32_swap_b32 v161, v163
    v_pk_add_f32 v[160:161], v[160:161], v[162:163]
    v_mul_f32 v160, s42, v160
    v_mul_f32 v161, s42, v161
    v_fma_f32 v161, -v160, v160, v161
    v_max_f32 v161, 0, v161
    v_add_f32 v161, s43, v161
    v_rsq_f32 v161, v161
    s_nop 0
    v_mul_f32 v160, -v160, v161
    v_pk_fma_f32 v[180:181], v[180:181], v[160:161], v[160:161] op_sel:[0,1,0] op_sel_hi:[1,1,0]
    v_pk_fma_f32 v[182:183], v[182:183], v[160:161], v[160:161] op_sel:[0,1,0] op_sel_hi:[1,1,0]
    v_pk_fma_f32 v[184:185], v[184:185], v[160:161], v[160:161] op_sel:[0,1,0] op_sel_hi:[1,1,0]
    v_pk_fma_f32 v[186:187], v[186:187], v[160:161], v[160:161] op_sel:[0,1,0] op_sel_hi:[1,1,0]
    v_pk_fma_f32 v[188:189], v[188:189], v[160:161], v[160:161] op_sel:[0,1,0] op_sel_hi:[1,1,0]
    v_pk_fma_f32 v[190:191], v[190:191], v[160:161], v[160:161] op_sel:[0,1,0] op_sel_hi:[1,1,0]
    v_pk_fma_f32 v[192:193], v[192:193], v[160:161], v[160:161] op_sel:[0,1,0] op_sel_hi:[1,1,0]
    v_pk_fma_f32 v[194:195], v[194:195], v[160:161], v[160:161] op_sel:[0,1,0] op_sel_hi:[1,1,0]
    v_cvt_pk_bf16_f32 v164, v180, v181
    v_cvt_pk_bf16_f32 v165, v182, v183
    v_cvt_pk_bf16_f32 v166, v184, v185
    v_cvt_pk_bf16_f32 v167, v186, v187
    v_cvt_pk_bf16_f32 v168, v188, v189
    v_cvt_pk_bf16_f32 v169, v190, v191
    v_cvt_pk_bf16_f32 v170, v192, v193
    v_cvt_pk_bf16_f32 v171, v194, v195
    v_permlane16_swap_b32 v164, v168
    v_permlane16_swap_b32 v165, v169
    v_permlane16_swap_b32 v166, v170
    v_permlane16_swap_b32 v167, v171
    v_cndmask_b32 v160, v166, v164, s[40:41]
    v_cndmask_b32 v161, v167, v165, s[40:41]
    v_cndmask_b32 v162, v170, v168, s[40:41]
    v_cndmask_b32 v163, v171, v169, s[40:41]
    buffer_store_dwordx4 v[160:163], v15, s[20:23], s37 offen sc1
    s_mov_b64 exec, -1
    s_setprio 0
    s_waitcnt vmcnt(0)
    s_barrier
    s_cmp_ge_u32 s3, 4
    s_cbranch_scc1 k4a_w4
    s_lshl_b32 s28, s3, 6
    v_add_u32 v0, s28, v2
    v_lshlrev_b32 v5, 4, v2
    s_and_b32 s28, s2, 7
    s_lshl_b32 s28, s28, 1
    s_bfe_u32 s29, s2, 0x10003
    s_add_u32 s28, s28, s29
    s_lshr_b32 s29, s2, 4
    s_lshl_b32 s34, s28, 2
    s_add_u32 s34, s34, s3
    s_lshl_b32 s30, s34, 15
    s_add_u32 s30, s30, 0xf00000
    s_mov_b32 s41, s30
    s_lshl_b32 s32, s3, 11
    s_mul_i32 s31, s29, 98304
    s_add_u32 s31, s31, s32
    s_add_u32 s31, s31, 0xb00000
    buffer_load_dwordx4 v[16:19], v5, s[20:23], s30 offen offset:0
    buffer_load_dwordx4 v[20:23], v5, s[20:23], s30 offen offset:1024
    buffer_load_dwordx4 v[24:27], v5, s[20:23], s30 offen offset:2048
    buffer_load_dwordx4 v[28:31], v5, s[20:23], s30 offen offset:3072
    s_add_u32 s30, s30, 4096
    buffer_load_dwordx4 v[32:35], v5, s[20:23], s30 offen offset:0
    buffer_load_dwordx4 v[36:39], v5, s[20:23], s30 offen offset:1024
    buffer_load_dwordx4 v[40:43], v5, s[20:23], s30 offen offset:2048
    buffer_load_dwordx4 v[44:47], v5, s[20:23], s30 offen offset:3072
    s_add_u32 s30, s30, 4096
    buffer_load_dwordx4 v[48:51], v5, s[20:23], s30 offen offset:0
    buffer_load_dwordx4 v[52:55], v5, s[20:23], s30 offen offset:1024
    buffer_load_dwordx4 v[56:59], v5, s[20:23], s30 offen offset:2048
    buffer_load_dwordx4 v[60:63], v5, s[20:23], s30 offen offset:3072
    s_add_u32 s30, s30, 4096
    buffer_load_dwordx4 v[64:67], v5, s[20:23], s30 offen offset:0
    buffer_load_dwordx4 v[68:71], v5, s[20:23], s30 offen offset:1024
    buffer_load_dwordx4 v[72:75], v5, s[20:23], s30 offen offset:2048
    buffer_load_dwordx4 v[76:79], v5, s[20:23], s30 offen offset:3072
    s_add_u32 s30, s30, 4096
    v_add_u32 v6, 61440, v5
    v_add_u32 v8, 122880, v5
    s_mov_b32 s70, 0
    v_mov_b32 v208, 0x3f803f80
    v_mov_b32 v209, 0x3f803f80
    v_mov_b32 v210, 0x3f803f80
    v_mov_b32 v211, 0x3f803f80
    s_mov_b32 s36, 0x3fb8aa3b
    s_mov_b32 s37, 0x358637bd
    v_lshrrev_b32 v4, 5, v2
    s_mul_i32 s38, s3, 2176
    s_add_u32 s38, s38, 90624
    v_add_u32 v12, s38, v5
    v_and_b32 v15, 19, v2
    v_bfe_u32 v7, v2, 2, 1
    v_lshl_add_u32 v15, v7, 3, v15
    v_bfe_u32 v7, v2, 3, 1
    v_lshl_add_u32 v15, v7, 2, v15
    v_lshl_add_u32 v15, v15, 2, s38
    s_mov_b32 s42, 0x0000ffff
    s_mov_b32 s43, 0x0000ffff
    s_mov_b32 s44, 1
    s_mov_b32 s45, 1
    v_lshlrev_b32 v13, 2, v0
    v_add_u32 v14, 90624, v13
    s_mul_i32 s38, s29, 2176
    s_add_u32 s38, s38, 0x9b9000
    s_lshl_b32 s39, s34, 15
    s_lshl_b32 s40, s29, 11
    s_add_u32 s39, s39, s40
    s_add_u32 s39, s39, 0x1100000
    v_cmp_gt_u32 s[46:47], 32, v0
    ds_read_b128 v[192:195], v8 offset:15872
    ds_read_b128 v[196:199], v8 offset:16896
    ds_read_b128 v[228:231], v5 offset:24576
    s_waitcnt vmcnt(12)
k4ac_ck0:
    v_max3_u32 v7, v16, v17, v18
    v_max3_u32 v7, v7, v19, v20
    v_max3_u32 v7, v7, v21, v22
    v_max3_u32 v7, v7, v23, v24
    v_max3_u32 v7, v7, v25, v26
    v_max3_u32 v7, v7, v27, v28
    v_max3_u32 v7, v7, v29, v30
    v_max_u32 v7, v7, v31
    v_cmp_eq_u32 s[50:51], -1, v7
    s_cmp_lg_u64 s[50:51], 0
    s_cbranch_scc1 k4ac_rt0
k4ac_ok0:
    buffer_load_dwordx4 v[80:83], v5, s[20:23], s30 offen offset:0
    buffer_load_dwordx4 v[84:87], v5, s[20:23], s30 offen offset:1024
    buffer_load_dwordx4 v[88:91], v5, s[20:23], s30 offen offset:2048
    buffer_load_dwordx4 v[92:95], v5, s[20:23], s30 offen offset:3072
    s_add_u32 s30, s30, 4096
    ds_read_b128 v[200:203], v8 offset:17920
    ds_read_b128 v[204:207], v8 offset:18944
    ds_read_b128 v[232:235], v5 offset:25600
    s_waitcnt lgkmcnt(3)
    v_mfma_f32_32x32x16_bf16 v[160:175], v[16:19], v[192:195], 0
    v_mfma_f32_32x32x16_bf16 v[176:191], v[16:19], v[196:199], 0
    v_mfma_f32_32x32x16_bf16 v[144:159], v[228:231], v[16:19], 0
    ds_read_b128 v[192:195], v8 offset:19968
    ds_read_b128 v[196:199], v8 offset:20992
    ds_read_b128 v[228:231], v5 offset:26624
    s_waitcnt lgkmcnt(3)
    v_mfma_f32_32x32x16_bf16 v[160:175], v[20:23], v[200:203], v[160:175]
    v_mfma_f32_32x32x16_bf16 v[176:191], v[20:23], v[204:207], v[176:191]
    v_mfma_f32_32x32x16_bf16 v[144:159], v[232:235], v[20:23], v[144:159]
    ds_read_b128 v[200:203], v8 offset:22016
    ds_read_b128 v[204:207], v8 offset:23040
    ds_read_b128 v[232:235], v5 offset:27648
    s_waitcnt lgkmcnt(3)
    v_mfma_f32_32x32x16_bf16 v[160:175], v[24:27], v[192:195], v[160:175]
    v_mfma_f32_32x32x16_bf16 v[176:191], v[24:27], v[196:199], v[176:191]
    v_mfma_f32_32x32x16_bf16 v[144:159], v[228:231], v[24:27], v[144:159]
    ds_read_b128 v[192:195], v8 offset:24064
    ds_read_b128 v[196:199], v8 offset:25088
    ds_read_b128 v[228:231], v5 offset:28672
    s_waitcnt lgkmcnt(3)
    v_mfma_f32_32x32x16_bf16 v[160:175], v[28:31], v[200:203], v[160:175]
    v_mfma_f32_32x32x16_bf16 v[176:191], v[28:31], v[204:207], v[176:191]
    s_waitcnt vmcnt(12)
k4ac_ck1:
    v_max3_u32 v7, v32, v33, v34
    v_max3_u32 v7, v7, v35, v36
    v_max3_u32 v7, v7, v37, v38
    v_max3_u32 v7, v7, v39, v40
    v_max3_u32 v7, v7, v41, v42
    v_max3_u32 v7, v7, v43, v44
    v_max3_u32 v7, v7, v45, v46
    v_max_u32 v7, v7, v47
    v_cmp_eq_u32 s[50:51], -1, v7
    s_cmp_lg_u64 s[50:51], 0
    s_cbranch_scc1 k4ac_rt1
k4ac_ok1:
    v_mfma_f32_32x32x16_bf16 v[144:159], v[232:235], v[28:31], v[144:159]
    buffer_load_dwordx4 v[96:99], v5, s[20:23], s30 offen offset:0
    buffer_load_dwordx4 v[100:103], v5, s[20:23], s30 offen offset:1024
    buffer_load_dwordx4 v[104:107], v5, s[20:23], s30 offen offset:2048
    buffer_load_dwordx4 v[108:111], v5, s[20:23], s30 offen offset:3072
    s_add_u32 s30, s30, 4096
    ds_read_b128 v[200:203], v8 offset:26112
    ds_read_b128 v[204:207], v8 offset:27136
    ds_read_b128 v[232:235], v5 offset:29696
    s_waitcnt lgkmcnt(3)
    v_mfma_f32_32x32x16_bf16 v[160:175], v[32:35], v[192:195], v[160:175]
    v_mfma_f32_32x32x16_bf16 v[176:191], v[32:35], v[196:199], v[176:191]
    v_mfma_f32_32x32x16_bf16 v[144:159], v[228:231], v[32:35], v[144:159]
    ds_read_b128 v[192:195], v8 offset:28160
    ds_read_b128 v[196:199], v8 offset:29184
    ds_read_b128 v[228:231], v5 offset:30720
    s_waitcnt lgkmcnt(3)
    v_mfma_f32_32x32x16_bf16 v[160:175], v[36:39], v[200:203], v[160:175]
    v_mfma_f32_32x32x16_bf16 v[176:191], v[36:39], v[204:207], v[176:191]
    v_mfma_f32_32x32x16_bf16 v[144:159], v[232:235], v[36:39], v[144:159]
    ds_read_b128 v[200:203], v8 offset:30208
    ds_read_b128 v[204:207], v8 offset:31232
    ds_read_b128 v[232:235], v5 offset:31744
    s_waitcnt lgkmcnt(3)
    v_mfma_f32_32x32x16_bf16 v[160:175], v[40:43], v[192:195], v[160:175]
    v_mfma_f32_32x32x16_bf16 v[176:191], v[40:43], v[196:199], v[176:191]
    v_mfma_f32_32x32x16_bf16 v[144:159], v[228:231], v[40:43], v[144:159]
    ds_read_b128 v[192:195], v8 offset:32256
    ds_read_b128 v[196:199], v8 offset:33280
    ds_read_b128 v[228:231], v5 offset:32768
    s_waitcnt lgkmcnt(3)
    v_mfma_f32_32x32x16_bf16 v[160:175], v[44:47], v[200:203], v[160:175]
    v_mfma_f32_32x32x16_bf16 v[176:191], v[44:47], v[204:207], v[176:191]
    s_waitcnt vmcnt(12)
k4ac_ck2:
    v_max3_u32 v7, v48, v49, v50
    v_max3_u32 v7, v7, v51, v52
    v_max3_u32 v7, v7, v53, v54
    v_max3_u32 v7, v7, v55, v56
    v_max3_u32 v7, v7, v57, v58
    v_max3_u32 v7, v7, v59, v60
    v_max3_u32 v7, v7, v61, v62
    v_max_u32 v7, v7, v63
    v_cmp_eq_u32 s[50:51], -1, v7
    s_cmp_lg_u64 s[50:51], 0
    s_cbranch_scc1 k4ac_rt2
k4ac_ok2:
    v_mfma_f32_32x32x16_bf16 v[144:159], v[232:235], v[44:47], v[144:159]
    buffer_load_dwordx4 v[112:115], v5, s[20:23], s30 offen offset:0
    buffer_load_dwordx4 v[116:119], v5, s[20:23], s30 offen offset:1024
    buffer_load_dwordx4 v[120:123], v5, s[20:23], s30 offen offset:2048
    buffer_load_dwordx4 v[124:127], v5, s[20:23], s30 offen offset:3072
    s_add_u32 s30, s30, 4096
    ds_read_b128 v[200:203], v8 offset:34304
    ds_read_b128 v[204:207], v8 offset:35328
    ds_read_b128 v[232:235], v5 offset:33792
    s_waitcnt lgkmcnt(3)
    v_mfma_f32_32x32x16_bf16 v[160:175], v[48:51], v[192:195], v[160:175]
    v_mfma_f32_32x32x16_bf16 v[176:191], v[48:51], v[196:199], v[176:191]
    v_mfma_f32_32x32x16_bf16 v[144:159], v[228:231], v[48:51], v[144:159]
    ds_read_b128 v[192:195], v8 offset:36352
    ds_read_b128 v[196:199], v8 offset:37376
    ds_read_b128 v[228:231], v5 offset:34816
    s_waitcnt lgkmcnt(3)
    v_mfma_f32_32x32x16_bf16 v[160:175], v[52:55], v[200:203], v[160:175]
    v_mfma_f32_32x32x16_bf16 v[176:191], v[52:55], v[204:207], v[176:191]
    v_mfma_f32_32x32x16_bf16 v[144:159], v[232:235], v[52:55], v[144:159]
    ds_read_b128 v[200:203], v8 offset:38400
    ds_read_b128 v[204:207], v8 offset:39424
    ds_read_b128 v[232:235], v5 offset:35840
    s_waitcnt lgkmcnt(3)
    v_mfma_f32_32x32x16_bf16 v[160:175], v[56:59], v[192:195], v[160:175]
    v_mfma_f32_32x32x16_bf16 v[176:191], v[56:59], v[196:199], v[176:191]
    v_mfma_f32_32x32x16_bf16 v[144:159], v[228:231], v[56:59], v[144:159]
    ds_read_b128 v[192:195], v5 offset:0
    ds_read_b128 v[196:199], v5 offset:1024
    ds_read_b128 v[228:231], v5 offset:36864
    s_waitcnt lgkmcnt(3)
    v_mfma_f32_32x32x16_bf16 v[160:175], v[60:63], v[200:203], v[160:175]
    v_mfma_f32_32x32x16_bf16 v[176:191], v[60:63], v[204:207], v[176:191]
    s_waitcnt vmcnt(12)
k4ac_ck3:
    v_max3_u32 v7, v64, v65, v66
    v_max3_u32 v7, v7, v67, v68
    v_max3_u32 v7, v7, v69, v70
    v_max3_u32 v7, v7, v71, v72
    v_max3_u32 v7, v7, v73, v74
    v_max3_u32 v7, v7, v75, v76
    v_max3_u32 v7, v7, v77, v78
    v_max_u32 v7, v7, v79
    v_cmp_eq_u32 s[50:51], -1, v7
    s_cmp_lg_u64 s[50:51], 0
    s_cbranch_scc1 k4ac_rt3
k4ac_ok3:
    v_mfma_f32_32x32x16_bf16 v[144:159], v[232:235], v[60:63], v[144:159]
    buffer_load_dwordx4 v[128:131], v5, s[20:23], s30 offen offset:0
    buffer_load_dwordx4 v[132:135], v5, s[20:23], s30 offen offset:1024
    buffer_load_dwordx4 v[136:139], v5, s[20:23], s30 offen offset:2048
    buffer_load_dwordx4 v[140:143], v5, s[20:23], s30 offen offset:3072
    s_add_u32 s30, s30, 4096
    ds_read_b128 v[200:203], v5 offset:2048
    ds_read_b128 v[204:207], v5 offset:3072
    ds_read_b128 v[232:235], v5 offset:37888
    s_waitcnt lgkmcnt(3)
    v_mfma_f32_32x32x16_bf16 v[160:175], v[64:67], v[192:195], v[160:175]
    v_mfma_f32_32x32x16_bf16 v[176:191], v[64:67], v[196:199], v[176:191]
    v_mfma_f32_32x32x16_bf16 v[144:159], v[228:231], v[64:67], v[144:159]
    ds_read_b128 v[192:195], v5 offset:4096
    ds_read_b128 v[196:199], v5 offset:5120
    ds_read_b128 v[228:231], v5 offset:38912
    s_waitcnt lgkmcnt(3)
    v_mfma_f32_32x32x16_bf16 v[160:175], v[68:71], v[200:203], v[160:175]
    v_mfma_f32_32x32x16_bf16 v[176:191], v[68:71], v[204:207], v[176:191]
    v_mfma_f32_32x32x16_bf16 v[144:159], v[232:235], v[68:71], v[144:159]
    ds_read_b128 v[200:203], v5 offset:6144
    ds_read_b128 v[204:207], v5 offset:7168
    ds_read_b128 v[232:235], v5 offset:39936
    s_waitcnt lgkmcnt(3)
    v_mfma_f32_32x32x16_bf16 v[160:175], v[72:75], v[192:195], v[160:175]
    v_mfma_f32_32x32x16_bf16 v[176:191], v[72:75], v[196:199], v[176:191]
    v_mfma_f32_32x32x16_bf16 v[144:159], v[228:231], v[72:75], v[144:159]
    ds_read_b128 v[192:195], v5 offset:57344
    ds_read_b128 v[196:199], v5 offset:58368
    ds_read_b128 v[228:231], v8 offset:1024
    s_waitcnt lgkmcnt(3)
    v_mfma_f32_32x32x16_bf16 v[160:175], v[76:79], v[200:203], v[160:175]
    v_mfma_f32_32x32x16_bf16 v[176:191], v[76:79], v[204:207], v[176:191]
    s_waitcnt vmcnt(12)
k4ac_ck4:
    v_max3_u32 v7, v80, v81, v82
    v_max3_u32 v7, v7, v83, v84
    v_max3_u32 v7, v7, v85, v86
    v_max3_u32 v7, v7, v87, v88
    v_max3_u32 v7, v7, v89, v90
    v_max3_u32 v7, v7, v91, v92
    v_max3_u32 v7, v7, v93, v94
    v_max_u32 v7, v7, v95
    v_cmp_eq_u32 s[50:51], -1, v7
    s_cmp_lg_u64 s[50:51], 0
    s_cbranch_scc1 k4ac_rt4
k4ac_ok4:
    v_mfma_f32_32x32x16_bf16 v[144:159], v[232:235], v[76:79], v[144:159]
    ds_read_b128 v[200:203], v5 offset:59392
    ds_read_b128 v[204:207], v5 offset:60416
    ds_read_b128 v[232:235], v8 offset:2048
    s_waitcnt lgkmcnt(3)
    v_mfma_f32_32x32x16_bf16 v[160:175], v[80:83], v[192:195], v[160:175]
    v_mfma_f32_32x32x16_bf16 v[176:191], v[80:83], v[196:199], v[176:191]
    v_mfma_f32_32x32x16_bf16 v[144:159], v[228:231], v[80:83], v[144:159]
    ds_read_b128 v[192:195], v6 offset:0
    ds_read_b128 v[196:199], v6 offset:1024
    ds_read_b128 v[228:231], v8 offset:3072
    s_waitcnt lgkmcnt(3)
    v_mfma_f32_32x32x16_bf16 v[160:175], v[84:87], v[200:203], v[160:175]
    v_mfma_f32_32x32x16_bf16 v[176:191], v[84:87], v[204:207], v[176:191]
    v_mfma_f32_32x32x16_bf16 v[144:159], v[232:235], v[84:87], v[144:159]
    ds_read_b128 v[200:203], v6 offset:2048
    ds_read_b128 v[204:207], v6 offset:3072
    ds_read_b128 v[232:235], v8 offset:4096
    s_waitcnt lgkmcnt(3)
    v_mfma_f32_32x32x16_bf16 v[160:175], v[88:91], v[192:195], v[160:175]
    v_mfma_f32_32x32x16_bf16 v[176:191], v[88:91], v[196:199], v[176:191]
    v_mfma_f32_32x32x16_bf16 v[144:159], v[228:231], v[88:91], v[144:159]
    ds_read_b128 v[192:195], v6 offset:4096
    ds_read_b128 v[196:199], v6 offset:5120
    ds_read_b128 v[228:231], v5 offset:40960
    s_waitcnt lgkmcnt(3)
    v_mfma_f32_32x32x16_bf16 v[160:175], v[92:95], v[200:203], v[160:175]
    v_mfma_f32_32x32x16_bf16 v[176:191], v[92:95], v[204:207], v[176:191]
    s_waitcnt vmcnt(8)
k4ac_ck5:
    v_max3_u32 v7, v96, v97, v98
    v_max3_u32 v7, v7, v99, v100
    v_max3_u32 v7, v7, v101, v102
    v_max3_u32 v7, v7, v103, v104
    v_max3_u32 v7, v7, v105, v106
    v_max3_u32 v7, v7, v107, v108
    v_max3_u32 v7, v7, v109, v110
    v_max_u32 v7, v7, v111
    v_cmp_eq_u32 s[50:51], -1, v7
    s_cmp_lg_u64 s[50:51], 0
    s_cbranch_scc1 k4ac_rt5
k4ac_ok5:
    v_mfma_f32_32x32x16_bf16 v[144:159], v[232:235], v[92:95], v[144:159]
    ds_read_b128 v[200:203], v6 offset:6144
    ds_read_b128 v[204:207], v6 offset:7168
    ds_read_b128 v[232:235], v5 offset:41984
    s_waitcnt lgkmcnt(3)
    v_mfma_f32_32x32x16_bf16 v[160:175], v[96:99], v[192:195], v[160:175]
    v_mfma_f32_32x32x16_bf16 v[176:191], v[96:99], v[196:199], v[176:191]
    v_mfma_f32_32x32x16_bf16 v[144:159], v[228:231], v[96:99], v[144:159]
    ds_read_b128 v[192:195], v6 offset:8192
    ds_read_b128 v[196:199], v6 offset:9216
    ds_read_b128 v[228:231], v5 offset:43008
    s_waitcnt lgkmcnt(3)
    v_mfma_f32_32x32x16_bf16 v[160:175], v[100:103], v[200:203], v[160:175]
    v_mfma_f32_32x32x16_bf16 v[176:191], v[100:103], v[204:207], v[176:191]
    v_mfma_f32_32x32x16_bf16 v[144:159], v[232:235], v[100:103], v[144:159]
    ds_read_b128 v[200:203], v6 offset:10240
    ds_read_b128 v[204:207], v6 offset:11264
    ds_read_b128 v[232:235], v5 offset:44032
    s_waitcnt lgkmcnt(3)
    v_mfma_f32_32x32x16_bf16 v[160:175], v[104:107], v[192:195], v[160:175]
    v_mfma_f32_32x32x16_bf16 v[176:191], v[104:107], v[196:199], v[176:191]
    v_mfma_f32_32x32x16_bf16 v[144:159], v[228:231], v[104:107], v[144:159]
    ds_read_b128 v[192:195], v6 offset:12288
    ds_read_b128 v[196:199], v6 offset:13312
    ds_read_b128 v[228:231], v5 offset:45056
    s_waitcnt lgkmcnt(3)
    v_mfma_f32_32x32x16_bf16 v[160:175], v[108:111], v[200:203], v[160:175]
    v_mfma_f32_32x32x16_bf16 v[176:191], v[108:111], v[204:207], v[176:191]
    s_waitcnt vmcnt(4)
k4ac_ck6:
    v_max3_u32 v7, v112, v113, v114
    v_max3_u32 v7, v7, v115, v116
    v_max3_u32 v7, v7, v117, v118
    v_max3_u32 v7, v7, v119, v120
    v_max3_u32 v7, v7, v121, v122
    v_max3_u32 v7, v7, v123, v124
    v_max3_u32 v7, v7, v125, v126
    v_max_u32 v7, v7, v127
    v_cmp_eq_u32 s[50:51], -1, v7
    s_cmp_lg_u64 s[50:51], 0
    s_cbranch_scc1 k4ac_rt6
k4ac_ok6:
    v_mfma_f32_32x32x16_bf16 v[144:159], v[232:235], v[108:111], v[144:159]
    ds_read_b128 v[200:203], v6 offset:14336
    ds_read_b128 v[204:207], v6 offset:15360
    ds_read_b128 v[232:235], v5 offset:46080
    s_waitcnt lgkmcnt(3)
    v_mfma_f32_32x32x16_bf16 v[160:175], v[112:115], v[192:195], v[160:175]
    v_mfma_f32_32x32x16_bf16 v[176:191], v[112:115], v[196:199], v[176:191]
    v_mfma_f32_32x32x16_bf16 v[144:159], v[228:231], v[112:115], v[144:159]
    ds_read_b128 v[192:195], v6 offset:16384
    ds_read_b128 v[196:199], v6 offset:17408
    ds_read_b128 v[228:231], v5 offset:47104
    s_waitcnt lgkmcnt(3)
    v_mfma_f32_32x32x16_bf16 v[160:175], v[116:119], v[200:203], v[160:175]
    v_mfma_f32_32x32x16_bf16 v[176:191], v[116:119], v[204:207], v[176:191]
    v_mfma_f32_32x32x16_bf16 v[144:159], v[232:235], v[116:119], v[144:159]
    ds_read_b128 v[200:203], v6 offset:18432
    ds_read_b128 v[204:207], v6 offset:19456
    ds_read_b128 v[232:235], v5 offset:48128
    s_waitcnt lgkmcnt(3)
    v_mfma_f32_32x32x16_bf16 v[160:175], v[120:123], v[192:195], v[160:175]
    v_mfma_f32_32x32x16_bf16 v[176:191], v[120:123], v[196:199], v[176:191]
    v_mfma_f32_32x32x16_bf16 v[144:159], v[228:231], v[120:123], v[144:159]
    ds_read_b128 v[192:195], v6 offset:20480
    ds_read_b128 v[196:199], v6 offset:21504
    ds_read_b128 v[228:231], v5 offset:16384
    s_waitcnt lgkmcnt(3)
    v_mfma_f32_32x32x16_bf16 v[160:175], v[124:127], v[200:203], v[160:175]
    v_mfma_f32_32x32x16_bf16 v[176:191], v[124:127], v[204:207], v[176:191]
    s_waitcnt vmcnt(0)
k4ac_ck7:
    v_max3_u32 v7, v128, v129, v130
    v_max3_u32 v7, v7, v131, v132
    v_max3_u32 v7, v7, v133, v134
    v_max3_u32 v7, v7, v135, v136
    v_max3_u32 v7, v7, v137, v138
    v_max3_u32 v7, v7, v139, v140
    v_max3_u32 v7, v7, v141, v142
    v_max_u32 v7, v7, v143
    v_cmp_eq_u32 s[50:51], -1, v7
    s_cmp_lg_u64 s[50:51], 0
    s_cbranch_scc1 k4ac_rt7
k4ac_ok7:
    v_mfma_f32_32x32x16_bf16 v[144:159], v[232:235], v[124:127], v[144:159]
    ds_read_b128 v[200:203], v6 offset:22528
    ds_read_b128 v[204:207], v6 offset:23552
    ds_read_b128 v[232:235], v5 offset:17408
    s_waitcnt lgkmcnt(3)
    v_mfma_f32_32x32x16_bf16 v[160:175], v[128:131], v[192:195], v[160:175]
    v_mfma_f32_32x32x16_bf16 v[176:191], v[128:131], v[196:199], v[176:191]
    v_mfma_f32_32x32x16_bf16 v[144:159], v[228:231], v[128:131], v[144:159]
    ds_read_b128 v[192:195], v6 offset:24576
    ds_read_b128 v[196:199], v6 offset:25600
    ds_read_b128 v[228:231], v5 offset:18432
    s_waitcnt lgkmcnt(3)
    v_mfma_f32_32x32x16_bf16 v[160:175], v[132:135], v[200:203], v[160:175]
    v_mfma_f32_32x32x16_bf16 v[176:191], v[132:135], v[204:207], v[176:191]
    v_mfma_f32_32x32x16_bf16 v[144:159], v[232:235], v[132:135], v[144:159]
    ds_read_b128 v[200:203], v6 offset:26624
    ds_read_b128 v[204:207], v6 offset:27648
    ds_read_b128 v[232:235], v5 offset:19456
    s_waitcnt lgkmcnt(3)
    v_mfma_f32_32x32x16_bf16 v[160:175], v[136:139], v[192:195], v[160:175]
    v_mfma_f32_32x32x16_bf16 v[176:191], v[136:139], v[196:199], v[176:191]
    v_mfma_f32_32x32x16_bf16 v[144:159], v[228:231], v[136:139], v[144:159]
    s_waitcnt lgkmcnt(0)
    v_mfma_f32_32x32x16_bf16 v[160:175], v[140:143], v[200:203], v[160:175]
    v_mfma_f32_32x32x16_bf16 v[176:191], v[140:143], v[204:207], v[176:191]
    v_mfma_f32_32x32x16_bf16 v[144:159], v[232:235], v[140:143], v[144:159]
    s_nop 9
    v_mul_f32 v212, s36, v160
    v_mul_f32 v213, s36, v161
    v_mul_f32 v214, s36, v162
    v_mul_f32 v215, s36, v163
    v_mul_f32 v216, s36, v164
    v_mul_f32 v217, s36, v165
    v_mul_f32 v218, s36, v166
    v_mul_f32 v219, s36, v167
    v_mul_f32 v220, s36, v168
    v_mul_f32 v221, s36, v169
    v_mul_f32 v222, s36, v170
    v_mul_f32 v223, s36, v171
    v_mul_f32 v224, s36, v172
    v_mul_f32 v225, s36, v173
    v_mul_f32 v226, s36, v174
    v_mul_f32 v227, s36, v175
    v_exp_f32 v212, v212 clamp
    v_add_f32 v160, 1.0, v160
    v_exp_f32 v213, v213 clamp
    v_add_f32 v161, 1.0, v161
    v_exp_f32 v214, v214 clamp
    v_add_f32 v162, 1.0, v162
    v_exp_f32 v215, v215 clamp
    v_add_f32 v163, 1.0, v163
    v_exp_f32 v216, v216 clamp
    v_add_f32 v164, 1.0, v164
    v_exp_f32 v217, v217 clamp
    v_add_f32 v165, 1.0, v165
    v_exp_f32 v218, v218 clamp
    v_add_f32 v166, 1.0, v166
    v_exp_f32 v219, v219 clamp
    v_add_f32 v167, 1.0, v167
    v_exp_f32 v220, v220 clamp
    v_add_f32 v168, 1.0, v168
    v_exp_f32 v221, v221 clamp
    v_add_f32 v169, 1.0, v169
    v_exp_f32 v222, v222 clamp
    v_add_f32 v170, 1.0, v170
    v_exp_f32 v223, v223 clamp
    v_add_f32 v171, 1.0, v171
    v_exp_f32 v224, v224 clamp
    v_add_f32 v172, 1.0, v172
    v_exp_f32 v225, v225 clamp
    v_add_f32 v173, 1.0, v173
    v_exp_f32 v226, v226 clamp
    v_add_f32 v174, 1.0, v174
    v_exp_f32 v227, v227 clamp
    v_add_f32 v175, 1.0, v175
    v_cvt_pk_bf16_f32 v236, v176, v177
    v_cvt_pk_bf16_f32 v237, v178, v179
    v_cvt_pk_bf16_f32 v238, v180, v181
    v_cvt_pk_bf16_f32 v239, v182, v183
    v_cvt_pk_bf16_f32 v240, v184, v185
    v_cvt_pk_bf16_f32 v241, v186, v187
    v_cvt_pk_bf16_f32 v242, v188, v189
    v_cvt_pk_bf16_f32 v243, v190, v191
    v_max_f32 v160, v160, v212
    v_max_f32 v161, v161, v213
    v_max_f32 v162, v162, v214
    v_max_f32 v163, v163, v215
    v_max_f32 v164, v164, v216
    v_max_f32 v165, v165, v217
    v_max_f32 v166, v166, v218
    v_max_f32 v167, v167, v219
    v_max_f32 v168, v168, v220
    v_max_f32 v169, v169, v221
    v_max_f32 v170, v170, v222
    v_max_f32 v171, v171, v223
    v_max_f32 v172, v172, v224
    v_max_f32 v173, v173, v225
    v_max_f32 v174, v174, v226
    v_max_f32 v175, v175, v227
    v_add_f32 v160, s37, v160
    v_add_f32 v161, s37, v161
    v_add_f32 v162, s37, v162
    v_add_f32 v163, s37, v163
    v_add_f32 v164, s37, v164
    v_add_f32 v165, s37, v165
    v_add_f32 v166, s37, v166
    v_add_f32 v167, s37, v167
    v_add_f32 v168, s37, v168
    v_add_f32 v169, s37, v169
    v_add_f32 v170, s37, v170
    v_add_f32 v171, s37, v171
    v_add_f32 v172, s37, v172
    v_add_f32 v173, s37, v173
    v_add_f32 v174, s37, v174
    v_add_f32 v175, s37, v175
    v_cvt_pk_bf16_f32 v228, v160, v161
    v_cvt_pk_bf16_f32 v229, v162, v163
    v_cvt_pk_bf16_f32 v230, v164, v165
    v_cvt_pk_bf16_f32 v231, v166, v167
    v_cvt_pk_bf16_f32 v232, v168, v169
    v_cvt_pk_bf16_f32 v233, v170, v171
    v_cvt_pk_bf16_f32 v234, v172, v173
    v_cvt_pk_bf16_f32 v235, v174, v175
    v_mfma_f32_32x32x16_bf16 v[160:175], v[228:231], v[236:239], 0
    v_mfma_f32_32x32x16_bf16 v[176:191], v[208:211], v[228:231], 0
    v_mfma_f32_32x32x16_bf16 v[160:175], v[232:235], v[240:243], v[160:175]
    v_mfma_f32_32x32x16_bf16 v[176:191], v[208:211], v[232:235], v[176:191]
    v_mul_f32 v32, s36, v144
    v_mul_f32 v33, s36, v145
    v_mul_f32 v34, s36, v146
    v_mul_f32 v35, s36, v147
    v_mul_f32 v36, s36, v148
    v_mul_f32 v37, s36, v149
    v_mul_f32 v38, s36, v150
    v_mul_f32 v39, s36, v151
    v_mul_f32 v40, s36, v152
    v_mul_f32 v41, s36, v153
    v_mul_f32 v42, s36, v154
    v_mul_f32 v43, s36, v155
    v_mul_f32 v44, s36, v156
    v_mul_f32 v45, s36, v157
    v_mul_f32 v46, s36, v158
    v_mul_f32 v47, s36, v159
    v_exp_f32 v32, v32 clamp
    v_add_f32 v144, 1.0, v144
    v_exp_f32 v33, v33 clamp
    v_add_f32 v145, 1.0, v145
    v_exp_f32 v34, v34 clamp
    v_add_f32 v146, 1.0, v146
    v_exp_f32 v35, v35 clamp
    v_add_f32 v147, 1.0, v147
    v_exp_f32 v36, v36 clamp
    v_add_f32 v148, 1.0, v148
    v_exp_f32 v37, v37 clamp
    v_add_f32 v149, 1.0, v149
    v_exp_f32 v38, v38 clamp
    v_add_f32 v150, 1.0, v150
    v_exp_f32 v39, v39 clamp
    v_add_f32 v151, 1.0, v151
    v_exp_f32 v40, v40 clamp
    v_add_f32 v152, 1.0, v152
    v_exp_f32 v41, v41 clamp
    v_add_f32 v153, 1.0, v153
    v_cndmask_b32 v160, v168, v160, s[42:43]
    v_cndmask_b32 v161, v169, v161, s[42:43]
    v_cndmask_b32 v162, v170, v162, s[42:43]
    v_cndmask_b32 v163, v171, v163, s[42:43]
    v_cndmask_b32 v164, v172, v164, s[42:43]
    v_cndmask_b32 v165, v173, v165, s[42:43]
    v_cndmask_b32 v166, v174, v166, s[42:43]
    v_cndmask_b32 v167, v175, v167, s[42:43]
    ds_write_b128 v12, v[160:163]
    ds_write_b128 v12, v[164:167] offset:1024
    ds_write_b32 v15, v176 offset:2048
    v_exp_f32 v42, v42 clamp
    v_add_f32 v154, 1.0, v154
    v_exp_f32 v43, v43 clamp
    v_add_f32 v155, 1.0, v155
    v_exp_f32 v44, v44 clamp
    v_add_f32 v156, 1.0, v156
    v_exp_f32 v45, v45 clamp
    v_add_f32 v157, 1.0, v157
    v_exp_f32 v46, v46 clamp
    v_add_f32 v158, 1.0, v158
    v_exp_f32 v47, v47 clamp
    v_add_f32 v159, 1.0, v159
    s_waitcnt lgkmcnt(0)
    s_barrier
    ds_read_b32 v212, v14 offset:0
    ds_read_b32 v213, v14 offset:2176
    ds_read_b32 v214, v14 offset:4352
    ds_read_b32 v215, v14 offset:6528
    ds_read_b32 v216, v14 offset:1024
    ds_read_b32 v217, v14 offset:3200
    ds_read_b32 v218, v14 offset:5376
    ds_read_b32 v219, v14 offset:7552
    ds_read_b32 v220, v14 offset:2048
    ds_read_b32 v221, v14 offset:4224
    ds_read_b32 v222, v14 offset:6400
    ds_read_b32 v223, v14 offset:8576
    v_max_f32 v144, v144, v32
    v_max_f32 v145, v145, v33
    v_max_f32 v146, v146, v34
    v_max_f32 v147, v147, v35
    v_max_f32 v148, v148, v36
    v_max_f32 v149, v149, v37
    v_max_f32 v150, v150, v38
    v_max_f32 v151, v151, v39
    v_add_f32 v144, s37, v144
    v_add_f32 v145, s37, v145
    v_add_f32 v146, s37, v146
    v_add_f32 v147, s37, v147
    v_add_f32 v148, s37, v148
    v_add_f32 v149, s37, v149
    v_add_f32 v150, s37, v150
    v_add_f32 v151, s37, v151
    v_cvt_pk_bf16_f32 v16, v144, v145
    v_cvt_pk_bf16_f32 v17, v146, v147
    v_cvt_pk_bf16_f32 v18, v148, v149
    v_cvt_pk_bf16_f32 v19, v150, v151
    buffer_store_dwordx4 v[16:19], v5, s[20:23], s39 offen offset:0 sc1
    v_max_f32 v152, v152, v40
    v_max_f32 v153, v153, v41
    v_max_f32 v154, v154, v42
    s_waitcnt lgkmcnt(0)
    v_add_f32 v212, v212, v213
    v_add_f32 v214, v214, v215
    v_add_f32 v216, v216, v217
    v_add_f32 v218, v218, v219
    v_add_f32 v220, v220, v221
    v_add_f32 v222, v222, v223
    v_add_f32 v212, v212, v214
    v_add_f32 v216, v216, v218
    v_add_f32 v220, v220, v222
    buffer_atomic_add_f32 v212, v13, s[20:23], s38 offen
    buffer_atomic_add_f32 v216, v13, s[20:23], s38 offen offset:1024
    s_cmp_lg_u32 s3, 0
    s_cbranch_scc1 k4ac_noat
    s_mov_b64 exec, s[46:47]
    buffer_atomic_add_f32 v220, v13, s[20:23], s38 offen offset:2048
    s_mov_b64 exec, -1
k4ac_noat:
    v_max_f32 v155, v155, v43
    v_max_f32 v156, v156, v44
    v_max_f32 v157, v157, v45
    v_max_f32 v158, v158, v46
    v_max_f32 v159, v159, v47
    v_add_f32 v152, s37, v152
    v_add_f32 v153, s37, v153
    v_add_f32 v154, s37, v154
    v_add_f32 v155, s37, v155
    v_add_f32 v156, s37, v156
    v_add_f32 v157, s37, v157
    v_add_f32 v158, s37, v158
    v_add_f32 v159, s37, v159
    v_cvt_pk_bf16_f32 v20, v152, v153
    v_cvt_pk_bf16_f32 v21, v154, v155
    v_cvt_pk_bf16_f32 v22, v156, v157
    v_cvt_pk_bf16_f32 v23, v158, v159
    buffer_store_dwordx4 v[20:23], v5, s[20:23], s39 offen offset:1024 sc1
    s_waitcnt vmcnt(0)
    s_branch k4b_entry
k4ac_end:
    s_endpgm
k4ac_rt0:
    s_add_u32 s70, s70, 1
    s_cmp_gt_u32 s70, 0x40000
    s_cbranch_scc1 k4ac_ok0
    s_sleep 1
    s_add_u32 s52, s41, 0
    buffer_load_dwordx4 v[16:19], v5, s[20:23], s52 offen offset:0 sc1
    buffer_load_dwordx4 v[20:23], v5, s[20:23], s52 offen offset:1024 sc1
    buffer_load_dwordx4 v[24:27], v5, s[20:23], s52 offen offset:2048 sc1
    buffer_load_dwordx4 v[28:31], v5, s[20:23], s52 offen offset:3072 sc1
    s_waitcnt vmcnt(0)
    s_branch k4ac_ck0
k4ac_rt1:
    s_add_u32 s70, s70, 1
    s_cmp_gt_u32 s70, 0x40000
    s_cbranch_scc1 k4ac_ok1
    s_sleep 1
    s_add_u32 s52, s41, 4096
    buffer_load_dwordx4 v[32:35], v5, s[20:23], s52 offen offset:0 sc1
    buffer_load_dwordx4 v[36:39], v5, s[20:23], s52 offen offset:1024 sc1
    buffer_load_dwordx4 v[40:43], v5, s[20:23], s52 offen offset:2048 sc1
    buffer_load_dwordx4 v[44:47], v5, s[20:23], s52 offen offset:3072 sc1
    s_waitcnt vmcnt(0)
    s_branch k4ac_ck1
k4ac_rt2:
    s_add_u32 s70, s70, 1
    s_cmp_gt_u32 s70, 0x40000
    s_cbranch_scc1 k4ac_ok2
    s_sleep 1
    s_add_u32 s52, s41, 8192
    buffer_load_dwordx4 v[48:51], v5, s[20:23], s52 offen offset:0 sc1
    buffer_load_dwordx4 v[52:55], v5, s[20:23], s52 offen offset:1024 sc1
    buffer_load_dwordx4 v[56:59], v5, s[20:23], s52 offen offset:2048 sc1
    buffer_load_dwordx4 v[60:63], v5, s[20:23], s52 offen offset:3072 sc1
    s_waitcnt vmcnt(0)
    s_branch k4ac_ck2
k4ac_rt3:
    s_add_u32 s70, s70, 1
    s_cmp_gt_u32 s70, 0x40000
    s_cbranch_scc1 k4ac_ok3
    s_sleep 1
    s_add_u32 s52, s41, 12288
    buffer_load_dwordx4 v[64:67], v5, s[20:23], s52 offen offset:0 sc1
    buffer_load_dwordx4 v[68:71], v5, s[20:23], s52 offen offset:1024 sc1
    buffer_load_dwordx4 v[72:75], v5, s[20:23], s52 offen offset:2048 sc1
    buffer_load_dwordx4 v[76:79], v5, s[20:23], s52 offen offset:3072 sc1
    s_waitcnt vmcnt(0)
    s_branch k4ac_ck3
k4ac_rt4:
    s_add_u32 s70, s70, 1
    s_cmp_gt_u32 s70, 0x40000
    s_cbranch_scc1 k4ac_ok4
    s_sleep 1
    s_add_u32 s52, s41, 16384
    buffer_load_dwordx4 v[80:83], v5, s[20:23], s52 offen offset:0 sc1
    buffer_load_dwordx4 v[84:87], v5, s[20:23], s52 offen offset:1024 sc1
    buffer_load_dwordx4 v[88:91], v5, s[20:23], s52 offen offset:2048 sc1
    buffer_load_dwordx4 v[92:95], v5, s[20:23], s52 offen offset:3072 sc1
    s_waitcnt vmcnt(0)
    s_branch k4ac_ck4
k4ac_rt5:
    s_add_u32 s70, s70, 1
    s_cmp_gt_u32 s70, 0x40000
    s_cbranch_scc1 k4ac_ok5
    s_sleep 1
    s_add_u32 s52, s41, 20480
    buffer_load_dwordx4 v[96:99], v5, s[20:23], s52 offen offset:0 sc1
    buffer_load_dwordx4 v[100:103], v5, s[20:23], s52 offen offset:1024 sc1
    buffer_load_dwordx4 v[104:107], v5, s[20:23], s52 offen offset:2048 sc1
    buffer_load_dwordx4 v[108:111], v5, s[20:23], s52 offen offset:3072 sc1
    s_waitcnt vmcnt(0)
    s_branch k4ac_ck5
k4ac_rt6:
    s_add_u32 s70, s70, 1
    s_cmp_gt_u32 s70, 0x40000
    s_cbranch_scc1 k4ac_ok6
    s_sleep 1
    s_add_u32 s52, s41, 24576
    buffer_load_dwordx4 v[112:115], v5, s[20:23], s52 offen offset:0 sc1
    buffer_load_dwordx4 v[116:119], v5, s[20:23], s52 offen offset:1024 sc1
    buffer_load_dwordx4 v[120:123], v5, s[20:23], s52 offen offset:2048 sc1
    buffer_load_dwordx4 v[124:127], v5, s[20:23], s52 offen offset:3072 sc1
    s_waitcnt vmcnt(0)
    s_branch k4ac_ck6
k4ac_rt7:
    s_add_u32 s70, s70, 1
    s_cmp_gt_u32 s70, 0x40000
    s_cbranch_scc1 k4ac_ok7
    s_sleep 1
    s_add_u32 s52, s41, 28672
    buffer_load_dwordx4 v[128:131], v5, s[20:23], s52 offen offset:0 sc1
    buffer_load_dwordx4 v[132:135], v5, s[20:23], s52 offen offset:1024 sc1
    buffer_load_dwordx4 v[136:139], v5, s[20:23], s52 offen offset:2048 sc1
    buffer_load_dwordx4 v[140:143], v5, s[20:23], s52 offen offset:3072 sc1
    s_waitcnt vmcnt(0)
    s_branch k4ac_ck7
k4a_w4:
    s_barrier
    s_branch k4b_entry
k4a_end:
    s_endpgm
k4a_wsa:
    s_setprio 0
    s_sleep 1
    ds_read_b32 v14, v0
    s_waitcnt lgkmcnt(0)
    v_readfirstlane_b32 s37, v14
    s_cmp_ge_u32 s37, s76
    s_cbranch_scc0 k4a_wsa
    s_branch k4a_woa
k4a_wsb:
    s_setprio 0
    s_sleep 1
    ds_read_b32 v14, v0
    s_waitcnt lgkmcnt(0)
    v_readfirstlane_b32 s37, v14
    s_cmp_ge_u32 s37, s76
    s_cbranch_scc0 k4a_wsb
    s_setprio 1
    s_branch k4a_wob
k4a_rts:
    s_add_u32 s70, s70, 1
    s_cmp_gt_u32 s70, 0x40000
    s_cbranch_scc1 k4a_oks
    s_sleep 1
    buffer_load_dwordx4 v[16:19], v3, s[20:23], s60 offen offset:0 sc1
    s_waitcnt vmcnt(0)
    s_branch k4a_cks
k4a_rt0:
    s_add_u32 s70, s70, 1
    s_cmp_gt_u32 s70, 0x40000
    s_cbranch_scc1 k4a_ok0
    s_sleep 1
    buffer_load_dwordx4 v[20:23], v3, s[20:23], s60 offen offset:1024 sc1
    s_mov_b64 exec, s[40:41]
    buffer_load_dwordx4 v[48:51], v0, s[20:23], s62 offen offset:0 sc1
    buffer_load_dwordx4 v[52:55], v0, s[20:23], s62 offen offset:512 sc1
    s_mov_b64 exec, -1
    s_waitcnt vmcnt(0)
    s_branch k4a_ck0
k4a_rt1:
    s_add_u32 s70, s70, 1
    s_cmp_gt_u32 s70, 0x40000
    s_cbranch_scc1 k4a_ok1
    s_sleep 1
    buffer_load_dwordx4 v[24:27], v3, s[20:23], s60 offen offset:2048 sc1
    s_mov_b64 exec, s[40:41]
    buffer_load_dwordx4 v[56:59], v0, s[20:23], s62 offen offset:1024 sc1
    buffer_load_dwordx4 v[60:63], v0, s[20:23], s62 offen offset:1536 sc1
    s_mov_b64 exec, -1
    s_waitcnt vmcnt(0)
    s_branch k4a_ck1
k4a_rt2:
    s_add_u32 s70, s70, 1
    s_cmp_gt_u32 s70, 0x40000
    s_cbranch_scc1 k4a_ok2
    s_sleep 1
    buffer_load_dwordx4 v[28:31], v3, s[20:23], s60 offen offset:3072 sc1
    s_mov_b64 exec, s[40:41]
    buffer_load_dwordx4 v[64:67], v0, s[20:23], s62 offen offset:2048 sc1
    buffer_load_dwordx4 v[68:71], v0, s[20:23], s62 offen offset:2560 sc1
    s_mov_b64 exec, -1
    s_waitcnt vmcnt(0)
    s_branch k4a_ck2
k4a_rt3:
    s_add_u32 s70, s70, 1
    s_cmp_gt_u32 s70, 0x40000
    s_cbranch_scc1 k4a_ok3
    s_sleep 1
    buffer_load_dwordx4 v[32:35], v3, s[20:23], s61 offen offset:0 sc1
    s_mov_b64 exec, s[40:41]
    buffer_load_dwordx4 v[72:75], v0, s[20:23], s62 offen offset:3072 sc1
    buffer_load_dwordx4 v[76:79], v0, s[20:23], s62 offen offset:3584 sc1
    s_mov_b64 exec, -1
    s_waitcnt vmcnt(0)
    s_branch k4a_ck3
k4a_rt4:
    s_add_u32 s70, s70, 1
    s_cmp_gt_u32 s70, 0x40000
    s_cbranch_scc1 k4a_ok4
    s_sleep 1
    buffer_load_dwordx4 v[36:39], v3, s[20:23], s61 offen offset:1024 sc1
    s_mov_b64 exec, s[40:41]
    buffer_load_dwordx4 v[80:83], v0, s[20:23], s63 offen offset:0 sc1
    buffer_load_dwordx4 v[84:87], v0, s[20:23], s63 offen offset:512 sc1
    s_mov_b64 exec, -1
    s_waitcnt vmcnt(0)
    s_branch k4a_ck4
k4a_rt5:
    s_add_u32 s70, s70, 1
    s_cmp_gt_u32 s70, 0x40000
    s_cbranch_scc1 k4a_ok5
    s_sleep 1
    buffer_load_dwordx4 v[40:43], v3, s[20:23], s61 offen offset:2048 sc1
    s_mov_b64 exec, s[40:41]
    buffer_load_dwordx4 v[88:91], v0, s[20:23], s63 offen offset:1024 sc1
    buffer_load_dwordx4 v[92:95], v0, s[20:23], s63 offen offset:1536 sc1
    s_mov_b64 exec, -1
    s_waitcnt vmcnt(0)
    s_branch k4a_ck5
k4a_rt6:
    s_add_u32 s70, s70, 1
    s_cmp_gt_u32 s70, 0x40000
    s_cbranch_scc1 k4a_ok6
    s_sleep 1
    buffer_load_dwordx4 v[44:47], v3, s[20:23], s61 offen offset:3072 sc1
    s_mov_b64 exec, s[40:41]
    buffer_load_dwordx4 v[96:99], v0, s[20:23], s63 offen offset:2048 sc1
    buffer_load_dwordx4 v[100:103], v0, s[20:23], s63 offen offset:2560 sc1
    s_mov_b64 exec, -1
    s_waitcnt vmcnt(0)
    s_branch k4a_ck6
k4a_rt7:
    s_add_u32 s70, s70, 1
    s_cmp_gt_u32 s70, 0x40000
    s_cbranch_scc1 k4a_ok7
    s_sleep 1
    s_mov_b64 exec, s[40:41]
    buffer_load_dwordx4 v[104:107], v0, s[20:23], s63 offen offset:3072 sc1
    buffer_load_dwordx4 v[108:111], v0, s[20:23], s63 offen offset:3584 sc1
    s_mov_b64 exec, -1
    s_waitcnt vmcnt(0)
    s_branch k4a_ck7
k4a_fb:
    buffer_load_dwordx4 v[16:19], v3, s[20:23], s60 offen offset:0 sc1
    buffer_load_dwordx4 v[20:23], v3, s[20:23], s60 offen offset:1024 sc1
    buffer_load_dwordx4 v[24:27], v3, s[20:23], s60 offen offset:2048 sc1
    buffer_load_dwordx4 v[28:31], v3, s[20:23], s60 offen offset:3072 sc1
    buffer_load_dwordx4 v[32:35], v3, s[20:23], s61 offen offset:0 sc1
    buffer_load_dwordx4 v[36:39], v3, s[20:23], s61 offen offset:1024 sc1
    buffer_load_dwordx4 v[40:43], v3, s[20:23], s61 offen offset:2048 sc1
    buffer_load_dwordx4 v[44:47], v3, s[20:23], s61 offen offset:3072 sc1
    v_subrev_u32 v4, 9216, v4
    v_subrev_u32 v9, 8192, v9
    v_add_u32 v15, 49152, v10
    v_add_u32 v5, 33280, v5
    v_add_u32 v6, 4096, v6
    v_add_u32 v7, 33280, v7
    v_add_u32 v8, 4096, v8
    s_lshl_b32 s59, s3, 16
    s_add_u32 s59, s59, 0x900000
    s_mov_b32 s49, 1
    s_lshl_b32 s66, s3, 8
    s_add_u32 s66, s66, 132160
    s_waitcnt vmcnt(0)
k4a_fbg:
    s_and_b32 s37, s48, s49
    s_cbranch_scc0 k4a_fbn
    s_barrier
    s_mov_b32 s37, 0
k4a_fb1:
    v_add_u32 v13, s37, v4
    ds_read_b128 v[236:239], v13
    v_mov_b32 v14, 0xff800000
    s_waitcnt lgkmcnt(0)
    v_mfma_f32_32x32x16_bf16 v[180:195], v[16:19], v[236:239], 0
    s_nop 11
    v_max3_f32 v14, v14, v180, v181
    v_max3_f32 v14, v14, v182, v183
    v_max3_f32 v14, v14, v184, v185
    v_max3_f32 v14, v14, v186, v187
    v_max3_f32 v14, v14, v188, v189
    v_max3_f32 v14, v14, v190, v191
    v_max3_f32 v14, v14, v192, v193
    v_max3_f32 v14, v14, v194, v195
    v_mfma_f32_32x32x16_bf16 v[180:195], v[20:23], v[236:239], 0
    s_nop 11
    v_max3_f32 v14, v14, v180, v181
    v_max3_f32 v14, v14, v182, v183
    v_max3_f32 v14, v14, v184, v185
    v_max3_f32 v14, v14, v186, v187
    v_max3_f32 v14, v14, v188, v189
    v_max3_f32 v14, v14, v190, v191
    v_max3_f32 v14, v14, v192, v193
    v_max3_f32 v14, v14, v194, v195
    v_mfma_f32_32x32x16_bf16 v[180:195], v[24:27], v[236:239], 0
    s_nop 11
    v_max3_f32 v14, v14, v180, v181
    v_max3_f32 v14, v14, v182, v183
    v_max3_f32 v14, v14, v184, v185
    v_max3_f32 v14, v14, v186, v187
    v_max3_f32 v14, v14, v188, v189
    v_max3_f32 v14, v14, v190, v191
    v_max3_f32 v14, v14, v192, v193
    v_max3_f32 v14, v14, v194, v195
    v_mfma_f32_32x32x16_bf16 v[180:195], v[28:31], v[236:239], 0
    s_nop 11
    v_max3_f32 v14, v14, v180, v181
    v_max3_f32 v14, v14, v182, v183
    v_max3_f32 v14, v14, v184, v185
    v_max3_f32 v14, v14, v186, v187
    v_max3_f32 v14, v14, v188, v189
    v_max3_f32 v14, v14, v190, v191
    v_max3_f32 v14, v14, v192, v193
    v_max3_f32 v14, v14, v194, v195
    v_mfma_f32_32x32x16_bf16 v[180:195], v[32:35], v[236:239], 0
    s_nop 11
    v_max3_f32 v14, v14, v180, v181
    v_max3_f32 v14, v14, v182, v183
    v_max3_f32 v14, v14, v184, v185
    v_max3_f32 v14, v14, v186, v187
    v_max3_f32 v14, v14, v188, v189
    v_max3_f32 v14, v14, v190, v191
    v_max3_f32 v14, v14, v192, v193
    v_max3_f32 v14, v14, v194, v195
    v_mfma_f32_32x32x16_bf16 v[180:195], v[36:39], v[236:239], 0
    s_nop 11
    v_max3_f32 v14, v14, v180, v181
    v_max3_f32 v14, v14, v182, v183
    v_max3_f32 v14, v14, v184, v185
    v_max3_f32 v14, v14, v186, v187
    v_max3_f32 v14, v14, v188, v189
    v_max3_f32 v14, v14, v190, v191
    v_max3_f32 v14, v14, v192, v193
    v_max3_f32 v14, v14, v194, v195
    v_mfma_f32_32x32x16_bf16 v[180:195], v[40:43], v[236:239], 0
    s_nop 11
    v_max3_f32 v14, v14, v180, v181
    v_max3_f32 v14, v14, v182, v183
    v_max3_f32 v14, v14, v184, v185
    v_max3_f32 v14, v14, v186, v187
    v_max3_f32 v14, v14, v188, v189
    v_max3_f32 v14, v14, v190, v191
    v_max3_f32 v14, v14, v192, v193
    v_max3_f32 v14, v14, v194, v195
    v_mfma_f32_32x32x16_bf16 v[180:195], v[44:47], v[236:239], 0
    s_nop 11
    v_max3_f32 v14, v14, v180, v181
    v_max3_f32 v14, v14, v182, v183
    v_max3_f32 v14, v14, v184, v185
    v_max3_f32 v14, v14, v186, v187
    v_max3_f32 v14, v14, v188, v189
    v_max3_f32 v14, v14, v190, v191
    v_max3_f32 v14, v14, v192, v193
    v_max3_f32 v14, v14, v194, v195
    v_mov_b32 v13, v14
    s_nop 1
    v_permlane32_swap_b32 v14, v13
    v_max_f32 v14, v14, v13
    s_lshl_b32 s38, s37, 1
    s_add_u32 s38, s38, s66
    v_lshl_add_u32 v13, v2, 2, s38
    ds_write_b32 v13, v14
    s_add_u32 s37, s37, 1024
    s_cmp_lt_u32 s37, 2048
    s_cbranch_scc1 k4a_fb1
    s_waitcnt lgkmcnt(0)
    s_barrier
    s_mov_b32 s37, 0
k4a_fb2:
    v_add_u32 v13, s37, v4
    ds_read_b128 v[236:239], v13
    s_lshl_b32 s38, s37, 1
    s_add_u32 s38, s38, 132160
    v_lshl_add_u32 v13, v2, 2, s38
    ds_read_b32 v180, v13 offset:0
    ds_read_b32 v181, v13 offset:256
    ds_read_b32 v182, v13 offset:512
    ds_read_b32 v183, v13 offset:768
    ds_read_b32 v184, v13 offset:1024
    ds_read_b32 v185, v13 offset:1280
    ds_read_b32 v186, v13 offset:1536
    ds_read_b32 v187, v13 offset:1792
    s_waitcnt lgkmcnt(0)
    v_max3_f32 v14, v180, v181, v182
    v_max3_f32 v14, v14, v183, v184
    v_max3_f32 v14, v14, v185, v186
    v_max_f32 v14, v14, v187
    v_sub_f32 v160, 0, v14
    v_sub_f32 v161, 0, v14
    v_sub_f32 v162, 0, v14
    v_sub_f32 v163, 0, v14
    v_sub_f32 v164, 0, v14
    v_sub_f32 v165, 0, v14
    v_sub_f32 v166, 0, v14
    v_sub_f32 v167, 0, v14
    v_sub_f32 v168, 0, v14
    v_sub_f32 v169, 0, v14
    v_sub_f32 v170, 0, v14
    v_sub_f32 v171, 0, v14
    v_sub_f32 v172, 0, v14
    v_sub_f32 v173, 0, v14
    v_sub_f32 v174, 0, v14
    v_sub_f32 v175, 0, v14
    s_nop 1
    v_mfma_f32_32x32x16_bf16 v[180:195], v[16:19], v[236:239], v[160:175]
    s_nop 11
    v_exp_f32 v180, v180
    v_exp_f32 v181, v181
    v_exp_f32 v182, v182
    v_exp_f32 v183, v183
    v_exp_f32 v184, v184
    v_exp_f32 v185, v185
    v_exp_f32 v186, v186
    v_exp_f32 v187, v187
    v_exp_f32 v188, v188
    v_exp_f32 v189, v189
    v_exp_f32 v190, v190
    v_exp_f32 v191, v191
    v_exp_f32 v192, v192
    v_exp_f32 v193, v193
    v_exp_f32 v194, v194
    v_exp_f32 v195, v195
    v_cvt_pk_bf16_f32 v212, v180, v181
    v_cvt_pk_bf16_f32 v213, v182, v183
    v_cvt_pk_bf16_f32 v214, v184, v185
    v_cvt_pk_bf16_f32 v215, v186, v187
    v_cvt_pk_bf16_f32 v216, v188, v189
    v_cvt_pk_bf16_f32 v217, v190, v191
    v_cvt_pk_bf16_f32 v218, v192, v193
    v_cvt_pk_bf16_f32 v219, v194, v195
    v_mfma_f32_32x32x16_bf16 v[220:235], v[48:51], v[212:215], 0
    s_nop 0
    v_mfma_f32_32x32x16_bf16 v[220:235], v[52:55], v[216:219], v[220:235]
    v_mfma_f32_32x32x16_bf16 v[180:195], v[20:23], v[236:239], v[160:175]
    s_nop 11
    v_exp_f32 v180, v180
    v_exp_f32 v181, v181
    v_exp_f32 v182, v182
    v_exp_f32 v183, v183
    v_exp_f32 v184, v184
    v_exp_f32 v185, v185
    v_exp_f32 v186, v186
    v_exp_f32 v187, v187
    v_exp_f32 v188, v188
    v_exp_f32 v189, v189
    v_exp_f32 v190, v190
    v_exp_f32 v191, v191
    v_exp_f32 v192, v192
    v_exp_f32 v193, v193
    v_exp_f32 v194, v194
    v_exp_f32 v195, v195
    v_cvt_pk_bf16_f32 v212, v180, v181
    v_cvt_pk_bf16_f32 v213, v182, v183
    v_cvt_pk_bf16_f32 v214, v184, v185
    v_cvt_pk_bf16_f32 v215, v186, v187
    v_cvt_pk_bf16_f32 v216, v188, v189
    v_cvt_pk_bf16_f32 v217, v190, v191
    v_cvt_pk_bf16_f32 v218, v192, v193
    v_cvt_pk_bf16_f32 v219, v194, v195
    v_mfma_f32_32x32x16_bf16 v[220:235], v[56:59], v[212:215], v[220:235]
    s_nop 0
    v_mfma_f32_32x32x16_bf16 v[220:235], v[60:63], v[216:219], v[220:235]
    v_mfma_f32_32x32x16_bf16 v[180:195], v[24:27], v[236:239], v[160:175]
    s_nop 11
    v_exp_f32 v180, v180
    v_exp_f32 v181, v181
    v_exp_f32 v182, v182
    v_exp_f32 v183, v183
    v_exp_f32 v184, v184
    v_exp_f32 v185, v185
    v_exp_f32 v186, v186
    v_exp_f32 v187, v187
    v_exp_f32 v188, v188
    v_exp_f32 v189, v189
    v_exp_f32 v190, v190
    v_exp_f32 v191, v191
    v_exp_f32 v192, v192
    v_exp_f32 v193, v193
    v_exp_f32 v194, v194
    v_exp_f32 v195, v195
    v_cvt_pk_bf16_f32 v212, v180, v181
    v_cvt_pk_bf16_f32 v213, v182, v183
    v_cvt_pk_bf16_f32 v214, v184, v185
    v_cvt_pk_bf16_f32 v215, v186, v187
    v_cvt_pk_bf16_f32 v216, v188, v189
    v_cvt_pk_bf16_f32 v217, v190, v191
    v_cvt_pk_bf16_f32 v218, v192, v193
    v_cvt_pk_bf16_f32 v219, v194, v195
    v_mfma_f32_32x32x16_bf16 v[220:235], v[64:67], v[212:215], v[220:235]
    s_nop 0
    v_mfma_f32_32x32x16_bf16 v[220:235], v[68:71], v[216:219], v[220:235]
    v_mfma_f32_32x32x16_bf16 v[180:195], v[28:31], v[236:239], v[160:175]
    s_nop 11
    v_exp_f32 v180, v180
    v_exp_f32 v181, v181
    v_exp_f32 v182, v182
    v_exp_f32 v183, v183
    v_exp_f32 v184, v184
    v_exp_f32 v185, v185
    v_exp_f32 v186, v186
    v_exp_f32 v187, v187
    v_exp_f32 v188, v188
    v_exp_f32 v189, v189
    v_exp_f32 v190, v190
    v_exp_f32 v191, v191
    v_exp_f32 v192, v192
    v_exp_f32 v193, v193
    v_exp_f32 v194, v194
    v_exp_f32 v195, v195
    v_cvt_pk_bf16_f32 v212, v180, v181
    v_cvt_pk_bf16_f32 v213, v182, v183
    v_cvt_pk_bf16_f32 v214, v184, v185
    v_cvt_pk_bf16_f32 v215, v186, v187
    v_cvt_pk_bf16_f32 v216, v188, v189
    v_cvt_pk_bf16_f32 v217, v190, v191
    v_cvt_pk_bf16_f32 v218, v192, v193
    v_cvt_pk_bf16_f32 v219, v194, v195
    v_mfma_f32_32x32x16_bf16 v[220:235], v[72:75], v[212:215], v[220:235]
    s_nop 0
    v_mfma_f32_32x32x16_bf16 v[220:235], v[76:79], v[216:219], v[220:235]
    v_mfma_f32_32x32x16_bf16 v[180:195], v[32:35], v[236:239], v[160:175]
    s_nop 11
    v_exp_f32 v180, v180
    v_exp_f32 v181, v181
    v_exp_f32 v182, v182
    v_exp_f32 v183, v183
    v_exp_f32 v184, v184
    v_exp_f32 v185, v185
    v_exp_f32 v186, v186
    v_exp_f32 v187, v187
    v_exp_f32 v188, v188
    v_exp_f32 v189, v189
    v_exp_f32 v190, v190
    v_exp_f32 v191, v191
    v_exp_f32 v192, v192
    v_exp_f32 v193, v193
    v_exp_f32 v194, v194
    v_exp_f32 v195, v195
    v_cvt_pk_bf16_f32 v212, v180, v181
    v_cvt_pk_bf16_f32 v213, v182, v183
    v_cvt_pk_bf16_f32 v214, v184, v185
    v_cvt_pk_bf16_f32 v215, v186, v187
    v_cvt_pk_bf16_f32 v216, v188, v189
    v_cvt_pk_bf16_f32 v217, v190, v191
    v_cvt_pk_bf16_f32 v218, v192, v193
    v_cvt_pk_bf16_f32 v219, v194, v195
    v_mfma_f32_32x32x16_bf16 v[220:235], v[80:83], v[212:215], v[220:235]
    s_nop 0
    v_mfma_f32_32x32x16_bf16 v[220:235], v[84:87], v[216:219], v[220:235]
    v_mfma_f32_32x32x16_bf16 v[180:195], v[36:39], v[236:239], v[160:175]
    s_nop 11
    v_exp_f32 v180, v180
    v_exp_f32 v181, v181
    v_exp_f32 v182, v182
    v_exp_f32 v183, v183
    v_exp_f32 v184, v184
    v_exp_f32 v185, v185
    v_exp_f32 v186, v186
    v_exp_f32 v187, v187
    v_exp_f32 v188, v188
    v_exp_f32 v189, v189
    v_exp_f32 v190, v190
    v_exp_f32 v191, v191
    v_exp_f32 v192, v192
    v_exp_f32 v193, v193
    v_exp_f32 v194, v194
    v_exp_f32 v195, v195
    v_cvt_pk_bf16_f32 v212, v180, v181
    v_cvt_pk_bf16_f32 v213, v182, v183
    v_cvt_pk_bf16_f32 v214, v184, v185
    v_cvt_pk_bf16_f32 v215, v186, v187
    v_cvt_pk_bf16_f32 v216, v188, v189
    v_cvt_pk_bf16_f32 v217, v190, v191
    v_cvt_pk_bf16_f32 v218, v192, v193
    v_cvt_pk_bf16_f32 v219, v194, v195
    v_mfma_f32_32x32x16_bf16 v[220:235], v[88:91], v[212:215], v[220:235]
    s_nop 0
    v_mfma_f32_32x32x16_bf16 v[220:235], v[92:95], v[216:219], v[220:235]
    v_mfma_f32_32x32x16_bf16 v[180:195], v[40:43], v[236:239], v[160:175]
    s_nop 11
    v_exp_f32 v180, v180
    v_exp_f32 v181, v181
    v_exp_f32 v182, v182
    v_exp_f32 v183, v183
    v_exp_f32 v184, v184
    v_exp_f32 v185, v185
    v_exp_f32 v186, v186
    v_exp_f32 v187, v187
    v_exp_f32 v188, v188
    v_exp_f32 v189, v189
    v_exp_f32 v190, v190
    v_exp_f32 v191, v191
    v_exp_f32 v192, v192
    v_exp_f32 v193, v193
    v_exp_f32 v194, v194
    v_exp_f32 v195, v195
    v_cvt_pk_bf16_f32 v212, v180, v181
    v_cvt_pk_bf16_f32 v213, v182, v183
    v_cvt_pk_bf16_f32 v214, v184, v185
    v_cvt_pk_bf16_f32 v215, v186, v187
    v_cvt_pk_bf16_f32 v216, v188, v189
    v_cvt_pk_bf16_f32 v217, v190, v191
    v_cvt_pk_bf16_f32 v218, v192, v193
    v_cvt_pk_bf16_f32 v219, v194, v195
    v_mfma_f32_32x32x16_bf16 v[220:235], v[96:99], v[212:215], v[220:235]
    s_nop 0
    v_mfma_f32_32x32x16_bf16 v[220:235], v[100:103], v[216:219], v[220:235]
    v_mfma_f32_32x32x16_bf16 v[180:195], v[44:47], v[236:239], v[160:175]
    s_nop 11
    v_exp_f32 v180, v180
    v_exp_f32 v181, v181
    v_exp_f32 v182, v182
    v_exp_f32 v183, v183
    v_exp_f32 v184, v184
    v_exp_f32 v185, v185
    v_exp_f32 v186, v186
    v_exp_f32 v187, v187
    v_exp_f32 v188, v188
    v_exp_f32 v189, v189
    v_exp_f32 v190, v190
    v_exp_f32 v191, v191
    v_exp_f32 v192, v192
    v_exp_f32 v193, v193
    v_exp_f32 v194, v194
    v_exp_f32 v195, v195
    v_cvt_pk_bf16_f32 v212, v180, v181
    v_cvt_pk_bf16_f32 v213, v182, v183
    v_cvt_pk_bf16_f32 v214, v184, v185
    v_cvt_pk_bf16_f32 v215, v186, v187
    v_cvt_pk_bf16_f32 v216, v188, v189
    v_cvt_pk_bf16_f32 v217, v190, v191
    v_cvt_pk_bf16_f32 v218, v192, v193
    v_cvt_pk_bf16_f32 v219, v194, v195
    v_mfma_f32_32x32x16_bf16 v[220:235], v[104:107], v[212:215], v[220:235]
    s_nop 0
    v_mfma_f32_32x32x16_bf16 v[220:235], v[108:111], v[216:219], v[220:235]
    s_lshr_b32 s38, s37, 10
    s_mul_i32 s39, s38, 16640
    v_add_u32 v13, s39, v5
    s_lshl_b32 s39, s38, 11
    v_add_u32 v14, s39, v6
    s_nop 6
    ds_write_b128 v13, v[220:223]
    ds_write_b128 v13, v[224:227] offset:1024
    ds_write_b32 v14, v228
    s_add_u32 s37, s37, 1024
    s_cmp_lt_u32 s37, 2048
    s_cbranch_scc1 k4a_fb2
    s_mov_b32 s31, s59
    s_waitcnt lgkmcnt(0)
    buffer_load_dwordx4 v[112:115], v3, s[20:23], s31 offen offset:0
    buffer_load_dwordx4 v[116:119], v3, s[20:23], s31 offen offset:1024
    buffer_load_dwordx4 v[120:123], v3, s[20:23], s31 offen offset:2048
    buffer_load_dwordx4 v[124:127], v3, s[20:23], s31 offen offset:3072
    s_add_u32 s31, s31, 4096
    buffer_load_dwordx4 v[128:131], v3, s[20:23], s31 offen offset:0
    buffer_load_dwordx4 v[132:135], v3, s[20:23], s31 offen offset:1024
    buffer_load_dwordx4 v[136:139], v3, s[20:23], s31 offen offset:2048
    buffer_load_dwordx4 v[140:143], v3, s[20:23], s31 offen offset:3072
    s_add_u32 s31, s31, 4096
    buffer_load_dwordx4 v[180:183], v3, s[20:23], s31 offen offset:0
    buffer_load_dwordx4 v[184:187], v3, s[20:23], s31 offen offset:1024
    buffer_load_dwordx4 v[188:191], v3, s[20:23], s31 offen offset:2048
    buffer_load_dwordx4 v[192:195], v3, s[20:23], s31 offen offset:3072
    s_add_u32 s31, s31, 4096
    buffer_load_dwordx4 v[220:223], v3, s[20:23], s31 offen offset:0
    buffer_load_dwordx4 v[224:227], v3, s[20:23], s31 offen offset:1024
    buffer_load_dwordx4 v[228:231], v3, s[20:23], s31 offen offset:2048
    buffer_load_dwordx4 v[232:235], v3, s[20:23], s31 offen offset:3072
    s_barrier
    ds_read_b128 v[160:163], v7 offset:0
    ds_read_b32 v176, v8 offset:0
    ds_read_b128 v[164:167], v7 offset:2080
    ds_read_b32 v177, v8 offset:256
    ds_read_b128 v[168:171], v7 offset:4160
    ds_read_b32 v178, v8 offset:512
    ds_read_b128 v[172:175], v7 offset:6240
    ds_read_b32 v179, v8 offset:768
    s_waitcnt lgkmcnt(0)
    v_pk_add_f32 v[160:161], v[160:161], v[164:165]
    v_pk_add_f32 v[162:163], v[162:163], v[166:167]
    v_add_f32 v176, v176, v177
    v_pk_add_f32 v[168:169], v[168:169], v[172:173]
    v_pk_add_f32 v[170:171], v[170:171], v[174:175]
    v_add_f32 v178, v178, v179
    v_pk_add_f32 v[160:161], v[160:161], v[168:169]
    v_add_f32 v176, v176, v178
    v_pk_add_f32 v[162:163], v[162:163], v[170:171]
    v_add_f32_dpp v160, v160, v160 quad_perm:[1,0,3,2] row_mask:0xf bank_mask:0xf
    v_add_f32_dpp v176, v176, v176 quad_perm:[1,0,3,2] row_mask:0xf bank_mask:0xf
    v_add_f32_dpp v161, v161, v161 quad_perm:[1,0,3,2] row_mask:0xf bank_mask:0xf
    v_add_f32_dpp v162, v162, v162 quad_perm:[1,0,3,2] row_mask:0xf bank_mask:0xf
    v_add_f32_dpp v163, v163, v163 quad_perm:[1,0,3,2] row_mask:0xf bank_mask:0xf
    v_rcp_f32 v177, v176
    v_and_b32 v178, s49, v12
    v_cmp_ne_u32 s[50:51], 0, v178
    v_pk_mul_f32 v[160:161], v[160:161], v[176:177] op_sel:[0,1] op_sel_hi:[1,1]
    v_pk_mul_f32 v[162:163], v[162:163], v[176:177] op_sel:[0,1] op_sel_hi:[1,1]
    v_cvt_pk_bf16_f32 v160, v160, v161
    v_cvt_pk_bf16_f32 v161, v162, v163
    v_cndmask_b32 v160, 0, v160, s[50:51]
    v_cndmask_b32 v161, 0, v161, s[50:51]
    ds_write_b64 v9, v[160:161] offset:0
    s_waitcnt lgkmcnt(0)
    s_barrier
    ds_read_b128 v[144:147], v15 offset:0
    ds_read_b128 v[148:151], v15 offset:512
    ds_read_b128 v[152:155], v15 offset:1024
    ds_read_b128 v[156:159], v15 offset:1536
    s_waitcnt vmcnt(8)
    s_waitcnt lgkmcnt(3)
    v_mfma_f32_16x16x32_bf16 v[240:243], v[112:115], v[144:147], v[240:243]
    v_mfma_f32_16x16x32_bf16 v[244:247], v[128:131], v[144:147], v[244:247]
    s_waitcnt lgkmcnt(2)
    v_mfma_f32_16x16x32_bf16 v[240:243], v[116:119], v[148:151], v[240:243]
    v_mfma_f32_16x16x32_bf16 v[244:247], v[132:135], v[148:151], v[244:247]
    s_waitcnt lgkmcnt(1)
    v_mfma_f32_16x16x32_bf16 v[240:243], v[120:123], v[152:155], v[240:243]
    v_mfma_f32_16x16x32_bf16 v[244:247], v[136:139], v[152:155], v[244:247]
    s_waitcnt lgkmcnt(0)
    v_mfma_f32_16x16x32_bf16 v[240:243], v[124:127], v[156:159], v[240:243]
    v_mfma_f32_16x16x32_bf16 v[244:247], v[140:143], v[156:159], v[244:247]
    s_waitcnt vmcnt(0)
    v_mfma_f32_16x16x32_bf16 v[248:251], v[180:183], v[144:147], v[248:251]
    v_mfma_f32_16x16x32_bf16 v[252:255], v[220:223], v[144:147], v[252:255]
    v_mfma_f32_16x16x32_bf16 v[248:251], v[184:187], v[148:151], v[248:251]
    v_mfma_f32_16x16x32_bf16 v[252:255], v[224:227], v[148:151], v[252:255]
    v_mfma_f32_16x16x32_bf16 v[248:251], v[188:191], v[152:155], v[248:251]
    v_mfma_f32_16x16x32_bf16 v[252:255], v[228:231], v[152:155], v[252:255]
    v_mfma_f32_16x16x32_bf16 v[248:251], v[192:195], v[156:159], v[248:251]
    v_mfma_f32_16x16x32_bf16 v[252:255], v[232:235], v[156:159], v[252:255]
k4a_fbn:
    v_add_u32 v4, 2048, v4
    s_add_u32 s59, s59, 16384
    s_lshl_b32 s49, s49, 1
    s_cmp_lt_u32 s49, 16
    s_cbranch_scc1 k4a_fbg
    s_waitcnt lgkmcnt(0)
    s_barrier
    s_branch k4a_epi
k4b_entry:
    v_lshlrev_b32 v3, 4, v2
    s_and_b32 s28, s2, 7
    s_lshl_b32 s28, s28, 3
    s_bfe_u32 s29, s2, 0x30003
    s_add_u32 s28, s28, s29
    s_lshr_b32 s29, s2, 6
    s_lshl_b32 s30, s28, 15
    s_lshl_b32 s31, s3, 12
    s_add_u32 s30, s30, s31
    s_add_u32 s30, s30, 0x1100000
    s_mul_i32 s32, s3, 4352
    s_add_u32 s32, s32, 0x9b9000
    s_and_b32 s33, s3, 3
    s_lshl_b32 s34, s29, 2
    s_add_u32 s34, s34, s33
    s_lshl_b32 s34, s34, 15
    s_lshr_b32 s35, s3, 2
    s_lshl_b32 s37, s35, 14
    s_add_u32 s34, s34, s37
    s_add_u32 s34, s34, 0x800000
    v_bfe_u32 v10, v2, 3, 1
    v_and_b32 v11, 7, v2
    v_mul_u32_u24 v12, 2176, v10
    v_lshl_add_u32 v12, v11, 4, v12
    s_lshl_b32 s78, s3, 14
    s_add_u32 s67, s78, 0x880000
    s_and_b32 s68, s3, 1
    s_lshl_b32 s68, s68, 14
    s_lshr_b32 s79, s3, 1
    s_lshl_b32 s69, s79, 11
    s_lshl_b32 s79, s79, 12
    s_add_u32 s68, s68, s79
    s_add_u32 s68, s68, 0x980000
    s_cmp_lt_u32 s3, 4
    s_cbranch_scc1 k4b_e1
    buffer_load_dwordx4 v[48:51], v3, s[20:23], s34 offen offset:0
    buffer_load_dwordx4 v[52:55], v3, s[20:23], s34 offen offset:1024
    buffer_load_dwordx4 v[56:59], v3, s[20:23], s34 offen offset:2048
    buffer_load_dwordx4 v[60:63], v3, s[20:23], s34 offen offset:3072
    s_add_u32 s34, s34, 4096
    buffer_load_dwordx4 v[64:67], v3, s[20:23], s34 offen offset:0
    buffer_load_dwordx4 v[68:71], v3, s[20:23], s34 offen offset:1024
    buffer_load_dwordx4 v[72:75], v3, s[20:23], s34 offen offset:2048
    buffer_load_dwordx4 v[76:79], v3, s[20:23], s34 offen offset:3072
    s_add_u32 s34, s34, 4096
    buffer_load_dwordx4 v[80:83], v3, s[20:23], s34 offen offset:0
    buffer_load_dwordx4 v[84:87], v3, s[20:23], s34 offen offset:1024
    buffer_load_dwordx4 v[88:91], v3, s[20:23], s34 offen offset:2048
    buffer_load_dwordx4 v[92:95], v3, s[20:23], s34 offen offset:3072
    s_add_u32 s34, s34, 4096
    buffer_load_dwordx4 v[96:99], v3, s[20:23], s34 offen offset:0
    buffer_load_dwordx4 v[100:103], v3, s[20:23], s34 offen offset:1024
    buffer_load_dwordx4 v[104:107], v3, s[20:23], s34 offen offset:2048
    buffer_load_dwordx4 v[108:111], v3, s[20:23], s34 offen offset:3072
    s_add_u32 s34, s34, 4096
    buffer_load_dwordx4 v[16:19], v3, s[20:23], s68 offen offset:0
    buffer_load_dwordx4 v[20:23], v3, s[20:23], s68 offen offset:1024
    buffer_load_dwordx4 v[24:27], v3, s[20:23], s68 offen offset:2048
    buffer_load_dwordx4 v[28:31], v3, s[20:23], s68 offen offset:3072
    s_add_u32 s68, s68, 4096
    buffer_load_dwordx4 v[144:147], v3, s[20:23], s67 offen offset:0
    buffer_load_dwordx4 v[148:151], v3, s[20:23], s67 offen offset:1024
    buffer_load_dwordx4 v[152:155], v3, s[20:23], s67 offen offset:2048
    buffer_load_dwordx4 v[156:159], v3, s[20:23], s67 offen offset:3072
    s_add_u32 s67, s67, 4096
    buffer_load_dwordx4 v[160:163], v3, s[20:23], s67 offen offset:0
    buffer_load_dwordx4 v[164:167], v3, s[20:23], s67 offen offset:1024
    buffer_load_dwordx4 v[168:171], v3, s[20:23], s67 offen offset:2048
    buffer_load_dwordx4 v[172:175], v3, s[20:23], s67 offen offset:3072
    s_add_u32 s67, s67, 4096
    buffer_load_dwordx4 v[180:183], v3, s[20:23], s67 offen offset:0
    buffer_load_dwordx4 v[184:187], v3, s[20:23], s67 offen offset:1024
    buffer_load_dwordx4 v[188:191], v3, s[20:23], s67 offen offset:2048
    buffer_load_dwordx4 v[192:195], v3, s[20:23], s67 offen offset:3072
    s_add_u32 s67, s67, 4096
    buffer_load_dwordx4 v[196:199], v3, s[20:23], s67 offen offset:0
    buffer_load_dwordx4 v[200:203], v3, s[20:23], s67 offen offset:1024
    buffer_load_dwordx4 v[204:207], v3, s[20:23], s67 offen offset:2048
    buffer_load_dwordx4 v[208:211], v3, s[20:23], s67 offen offset:3072
    s_add_u32 s67, s67, 4096
    s_barrier
    s_branch k4b_e2
k4b_e1:
    s_barrier
    s_cmp_lg_u32 s3, 0
    s_cbranch_scc1 k4b_e15
    v_lshlrev_b32 v4, 10, v2
    v_mov_b32 v5, 1
    s_lshl_b32 s36, s2, 2
    s_add_u32 s36, s36, 0x9c4000
    s_mov_b64 exec, 0xff
    buffer_store_dword v5, v4, s[20:23], s36 offen sc1
    s_mov_b64 exec, -1
k4b_e15:
    buffer_load_dwordx4 v[48:51], v3, s[20:23], s34 offen offset:0
    buffer_load_dwordx4 v[52:55], v3, s[20:23], s34 offen offset:1024
    buffer_load_dwordx4 v[56:59], v3, s[20:23], s34 offen offset:2048
    buffer_load_dwordx4 v[60:63], v3, s[20:23], s34 offen offset:3072
    s_add_u32 s34, s34, 4096
    buffer_load_dwordx4 v[64:67], v3, s[20:23], s34 offen offset:0
    buffer_load_dwordx4 v[68:71], v3, s[20:23], s34 offen offset:1024
    buffer_load_dwordx4 v[72:75], v3, s[20:23], s34 offen offset:2048
    buffer_load_dwordx4 v[76:79], v3, s[20:23], s34 offen offset:3072
    s_add_u32 s34, s34, 4096
    buffer_load_dwordx4 v[80:83], v3, s[20:23], s34 offen offset:0
    buffer_load_dwordx4 v[84:87], v3, s[20:23], s34 offen offset:1024
    buffer_load_dwordx4 v[88:91], v3, s[20:23], s34 offen offset:2048
    buffer_load_dwordx4 v[92:95], v3, s[20:23], s34 offen offset:3072
    s_add_u32 s34, s34, 4096
    buffer_load_dwordx4 v[96:99], v3, s[20:23], s34 offen offset:0
    buffer_load_dwordx4 v[100:103], v3, s[20:23], s34 offen offset:1024
    buffer_load_dwordx4 v[104:107], v3, s[20:23], s34 offen offset:2048
    buffer_load_dwordx4 v[108:111], v3, s[20:23], s34 offen offset:3072
    s_add_u32 s34, s34, 4096
    buffer_load_dwordx4 v[16:19], v3, s[20:23], s68 offen offset:0
    buffer_load_dwordx4 v[20:23], v3, s[20:23], s68 offen offset:1024
    buffer_load_dwordx4 v[24:27], v3, s[20:23], s68 offen offset:2048
    buffer_load_dwordx4 v[28:31], v3, s[20:23], s68 offen offset:3072
    s_add_u32 s68, s68, 4096
    buffer_load_dwordx4 v[144:147], v3, s[20:23], s67 offen offset:0
    buffer_load_dwordx4 v[148:151], v3, s[20:23], s67 offen offset:1024
    buffer_load_dwordx4 v[152:155], v3, s[20:23], s67 offen offset:2048
    buffer_load_dwordx4 v[156:159], v3, s[20:23], s67 offen offset:3072
    s_add_u32 s67, s67, 4096
    buffer_load_dwordx4 v[160:163], v3, s[20:23], s67 offen offset:0
    buffer_load_dwordx4 v[164:167], v3, s[20:23], s67 offen offset:1024
    buffer_load_dwordx4 v[168:171], v3, s[20:23], s67 offen offset:2048
    buffer_load_dwordx4 v[172:175], v3, s[20:23], s67 offen offset:3072
    s_add_u32 s67, s67, 4096
    buffer_load_dwordx4 v[180:183], v3, s[20:23], s67 offen offset:0
    buffer_load_dwordx4 v[184:187], v3, s[20:23], s67 offen offset:1024
    buffer_load_dwordx4 v[188:191], v3, s[20:23], s67 offen offset:2048
    buffer_load_dwordx4 v[192:195], v3, s[20:23], s67 offen offset:3072
    s_add_u32 s67, s67, 4096
    buffer_load_dwordx4 v[196:199], v3, s[20:23], s67 offen offset:0
    buffer_load_dwordx4 v[200:203], v3, s[20:23], s67 offen offset:1024
    buffer_load_dwordx4 v[204:207], v3, s[20:23], s67 offen offset:2048
    buffer_load_dwordx4 v[208:211], v3, s[20:23], s67 offen offset:3072
    s_add_u32 s67, s67, 4096
k4b_e2:
    s_cmp_lg_u32 s3, 7
    s_cbranch_scc1 k4b_e3
    s_and_b32 s36, s2, 7
    s_lshl_b32 s36, s36, 10
    s_add_u32 s36, s36, 0x9c4000
    s_mov_b32 s70, 0
k4b_ep:
    buffer_load_dwordx4 v[244:247], v3, s[20:23], s36 offen sc1
    s_add_u32 s70, s70, 1
    s_waitcnt vmcnt(0)
    v_min3_u32 v4, v244, v245, v246
    v_min_u32 v4, v4, v247
    v_cmp_eq_u32 s[50:51], 0, v4
    s_cmp_eq_u64 s[50:51], 0
    s_cbranch_scc1 k4b_e3
    s_sleep 1
    s_cmp_lt_u32 s70, 0x40000
    s_cbranch_scc1 k4b_ep
k4b_e3:
    s_barrier
    buffer_load_dwordx4 v[32:35], v12, s[20:23], s32 offen offset:2048
    buffer_load_dwordx4 v[128:131], v3, s[20:23], s32 offen offset:0
    buffer_load_dwordx4 v[132:135], v3, s[20:23], s32 offen offset:1024
    buffer_load_dwordx4 v[136:139], v3, s[20:23], s32 offen offset:2176
    buffer_load_dwordx4 v[140:143], v3, s[20:23], s32 offen offset:3200
    buffer_load_dwordx4 v[112:115], v3, s[20:23], s30 offen offset:0
    buffer_load_dwordx4 v[116:119], v3, s[20:23], s30 offen offset:1024
    buffer_load_dwordx4 v[120:123], v3, s[20:23], s30 offen offset:2048
    buffer_load_dwordx4 v[124:127], v3, s[20:23], s30 offen offset:3072
    s_add_u32 s12, s10, 0x400000
    s_addc_u32 s13, s11, 0
    s_mov_b32 s14, 0x200000
    s_mov_b32 s15, 0x20000
    v_and_b32 v4, 31, v2
    v_lshrrev_b32 v5, 5, v2
    s_mul_i32 s36, s3, 2304
    s_add_u32 s36, s36, 24576
    v_min_u32 v6, 16, v4
    v_lshlrev_b32 v6, 5, v6
    v_lshl_add_u32 v6, v5, 4, v6
    v_add_u32 v6, s36, v6
    v_bfe_u32 v9, v2, 4, 1
    v_mul_u32_u24 v9, 544, v9
    v_and_b32 v13, 15, v2
    v_lshl_add_u32 v9, v13, 5, v9
    v_lshl_add_u32 v9, v5, 4, v9
    v_add_u32 v9, s36, v9
    v_lshrrev_b32 v14, 2, v11
    v_lshl_add_u32 v14, v10, 1, v14
    v_mul_u32_u24 v14, 544, v14
    v_and_b32 v11, 3, v11
    v_lshl_add_u32 v14, v11, 3, v14
    v_add_u32 v14, s36, v14
    s_add_u32 s36, s31, 57344
    v_add_u32 v8, s36, v3
    s_add_u32 s36, s37, 57344
    v_add_u32 v15, s36, v3
    v_lshrrev_b32 v10, 4, v2
    v_lshlrev_b32 v7, 10, v10
    v_lshl_add_u32 v7, v13, 4, v7
    s_lshl_b32 s38, s28, 15
    s_add_u32 s38, s38, s31
    s_lshl_b32 s39, s29, 8
    s_add_u32 s38, s38, s39
    s_mul_i32 s39, s3, 2112
    s_add_u32 s39, s39, 90112
    v_mul_u32_u24 v10, 528, v10
    v_lshl_add_u32 v10, v13, 5, v10
    v_add_u32 v10, s39, v10
    s_mul_i32 s39, s35, 16896
    s_lshl_b32 s40, s33, 7
    s_add_u32 s39, s39, s40
    s_add_u32 s39, s39, 90112
    v_mul_u32_u24 v11, 528, v4
    v_lshl_add_u32 v11, v5, 4, v11
    v_add_u32 v11, s39, v11
    s_mov_b32 s40, 0x358637bd
    s_waitcnt vmcnt(8)
    v_cvt_pk_bf16_f32 v32, v32, v33
    v_cvt_pk_bf16_f32 v33, v34, v35
    ds_write_b64 v14, v[32:33] offset:512
    s_waitcnt vmcnt(7)
    v_cvt_pk_bf16_f32 v128, v128, v129
    v_cvt_pk_bf16_f32 v129, v130, v131
    ds_write_b64 v9, v[128:129] offset:0
    s_waitcnt vmcnt(6)
    v_cvt_pk_bf16_f32 v132, v132, v133
    v_cvt_pk_bf16_f32 v133, v134, v135
    ds_write_b64 v9, v[132:133] offset:8
    s_waitcnt vmcnt(5)
    v_cvt_pk_bf16_f32 v136, v136, v137
    v_cvt_pk_bf16_f32 v137, v138, v139
    ds_write_b64 v9, v[136:137] offset:1088
    s_waitcnt vmcnt(4)
    v_cvt_pk_bf16_f32 v140, v140, v141
    v_cvt_pk_bf16_f32 v141, v142, v143
    ds_write_b64 v9, v[140:141] offset:1096
    ds_read_b128 v[128:131], v6 offset:0
    ds_read_b128 v[132:135], v6 offset:544
    ds_read_b128 v[136:139], v6 offset:1088
    ds_read_b128 v[140:143], v6 offset:1632
    s_waitcnt vmcnt(3) lgkmcnt(3)
    v_mfma_f32_32x32x16_bf16 v[212:227], v[128:131], v[112:115], 0
    s_waitcnt vmcnt(2) lgkmcnt(2)
    v_mfma_f32_32x32x16_bf16 v[228:243], v[132:135], v[116:119], 0
    s_nop 9
    v_add_f32 v12, s40, v220
    v_rcp_f32 v12, v12
    s_nop 0
    v_mov_b32 v13, v12
    v_pk_mul_f32 v[212:213], v[212:213], v[12:13]
    v_pk_mul_f32 v[214:215], v[214:215], v[12:13]
    v_pk_mul_f32 v[216:217], v[216:217], v[12:13]
    v_pk_mul_f32 v[218:219], v[218:219], v[12:13]
    v_cvt_pk_bf16_f32 v112, v212, v213
    v_cvt_pk_bf16_f32 v113, v214, v215
    v_cvt_pk_bf16_f32 v114, v216, v217
    v_cvt_pk_bf16_f32 v115, v218, v219
    ds_write_b128 v8, v[112:115] offset:0
    s_waitcnt vmcnt(1) lgkmcnt(2)
    v_mfma_f32_32x32x16_bf16 v[212:227], v[136:139], v[120:123], 0
    v_add_f32 v12, s40, v236
    v_rcp_f32 v12, v12
    s_nop 0
    v_mov_b32 v13, v12
    v_pk_mul_f32 v[228:229], v[228:229], v[12:13]
    v_pk_mul_f32 v[230:231], v[230:231], v[12:13]
    v_pk_mul_f32 v[232:233], v[232:233], v[12:13]
    v_pk_mul_f32 v[234:235], v[234:235], v[12:13]
    v_cvt_pk_bf16_f32 v116, v228, v229
    v_cvt_pk_bf16_f32 v117, v230, v231
    v_cvt_pk_bf16_f32 v118, v232, v233
    v_cvt_pk_bf16_f32 v119, v234, v235
    ds_write_b128 v8, v[116:119] offset:1024
    s_waitcnt vmcnt(0) lgkmcnt(2)
    v_mfma_f32_32x32x16_bf16 v[228:243], v[140:143], v[124:127], 0
    v_add_f32 v12, s40, v220
    v_rcp_f32 v12, v12
    s_nop 0
    v_mov_b32 v13, v12
    v_pk_mul_f32 v[212:213], v[212:213], v[12:13]
    v_pk_mul_f32 v[214:215], v[214:215], v[12:13]
    v_pk_mul_f32 v[216:217], v[216:217], v[12:13]
    v_pk_mul_f32 v[218:219], v[218:219], v[12:13]
    v_cvt_pk_bf16_f32 v120, v212, v213
    v_cvt_pk_bf16_f32 v121, v214, v215
    v_cvt_pk_bf16_f32 v122, v216, v217
    v_cvt_pk_bf16_f32 v123, v218, v219
    ds_write_b128 v8, v[120:123] offset:2048
    v_add_f32 v12, s40, v236
    v_rcp_f32 v12, v12
    s_nop 0
    v_mov_b32 v13, v12
    v_pk_mul_f32 v[228:229], v[228:229], v[12:13]
    v_pk_mul_f32 v[230:231], v[230:231], v[12:13]
    v_pk_mul_f32 v[232:233], v[232:233], v[12:13]
    v_pk_mul_f32 v[234:235], v[234:235], v[12:13]
    v_cvt_pk_bf16_f32 v124, v228, v229
    v_cvt_pk_bf16_f32 v125, v230, v231
    v_cvt_pk_bf16_f32 v126, v232, v233
    v_cvt_pk_bf16_f32 v127, v234, v235
    ds_write_b128 v8, v[124:127] offset:3072
    s_and_b32 s29, s2, 7
    s_lshl_b32 s29, s29, 5
    s_lshr_b32 s30, s2, 3
    s_add_u32 s29, s29, s30
    s_lshl_b32 s36, s3, 14
    s_waitcnt lgkmcnt(0)
    s_barrier
    ds_read_b128 v[112:115], v15 offset:0
    ds_read_b128 v[116:119], v15 offset:1024
    ds_read_b128 v[120:123], v15 offset:2048
    ds_read_b128 v[124:127], v15 offset:3072
    ds_read_b128 v[128:131], v15 offset:4096
    ds_read_b128 v[132:135], v15 offset:5120
    ds_read_b128 v[136:139], v15 offset:6144
    s_waitcnt vmcnt(24) lgkmcnt(6)
    v_mfma_f32_32x32x16_bf16 v[212:227], v[48:51], v[112:115], 0
    ds_read_b128 v[140:143], v15 offset:7168
    s_waitcnt vmcnt(23) lgkmcnt(6)
    v_mfma_f32_32x32x16_bf16 v[228:243], v[52:55], v[116:119], 0
    ds_read_b128 v[112:115], v15 offset:8192
    s_waitcnt vmcnt(22) lgkmcnt(6)
    v_mfma_f32_32x32x16_bf16 v[212:227], v[56:59], v[120:123], v[212:227]
    ds_read_b128 v[116:119], v15 offset:9216
    s_waitcnt vmcnt(21) lgkmcnt(6)
    v_mfma_f32_32x32x16_bf16 v[228:243], v[60:63], v[124:127], v[228:243]
    ds_read_b128 v[120:123], v15 offset:10240
    s_waitcnt vmcnt(20) lgkmcnt(6)
    v_mfma_f32_32x32x16_bf16 v[212:227], v[64:67], v[128:131], v[212:227]
    ds_read_b128 v[124:127], v15 offset:11264
    s_waitcnt vmcnt(19) lgkmcnt(6)
    v_mfma_f32_32x32x16_bf16 v[228:243], v[68:71], v[132:135], v[228:243]
    ds_read_b128 v[128:131], v15 offset:12288
    buffer_load_dwordx4 v[244:247], v7, s[12:15], s38 offen
    s_waitcnt vmcnt(19) lgkmcnt(6)
    v_mfma_f32_32x32x16_bf16 v[212:227], v[72:75], v[136:139], v[212:227]
    ds_read_b128 v[132:135], v15 offset:13312
    s_waitcnt vmcnt(18) lgkmcnt(6)
    v_mfma_f32_32x32x16_bf16 v[228:243], v[76:79], v[140:143], v[228:243]
    ds_read_b128 v[136:139], v15 offset:14336
    s_waitcnt vmcnt(17) lgkmcnt(6)
    v_mfma_f32_32x32x16_bf16 v[212:227], v[80:83], v[112:115], v[212:227]
    ds_read_b128 v[140:143], v15 offset:15360
    s_waitcnt vmcnt(16) lgkmcnt(6)
    v_mfma_f32_32x32x16_bf16 v[228:243], v[84:87], v[116:119], v[228:243]
    s_waitcnt vmcnt(15) lgkmcnt(5)
    v_mfma_f32_32x32x16_bf16 v[212:227], v[88:91], v[120:123], v[212:227]
    s_waitcnt vmcnt(14) lgkmcnt(4)
    v_mfma_f32_32x32x16_bf16 v[228:243], v[92:95], v[124:127], v[228:243]
    s_waitcnt vmcnt(13) lgkmcnt(3)
    v_mfma_f32_32x32x16_bf16 v[212:227], v[96:99], v[128:131], v[212:227]
    s_waitcnt vmcnt(12) lgkmcnt(2)
    v_mfma_f32_32x32x16_bf16 v[228:243], v[100:103], v[132:135], v[228:243]
    s_waitcnt vmcnt(11) lgkmcnt(1)
    v_mfma_f32_32x32x16_bf16 v[212:227], v[104:107], v[136:139], v[212:227]
    s_waitcnt vmcnt(10) lgkmcnt(0)
    v_mfma_f32_32x32x16_bf16 v[228:243], v[108:111], v[140:143], v[228:243]
    s_add_u32 s38, s38, 0x600000
    s_nop 10
    v_pk_add_f32 v[212:213], v[212:213], v[228:229]
    v_pk_add_f32 v[214:215], v[214:215], v[230:231]
    v_pk_add_f32 v[216:217], v[216:217], v[232:233]
    v_pk_add_f32 v[218:219], v[218:219], v[234:235]
    v_pk_add_f32 v[220:221], v[220:221], v[236:237]
    v_pk_add_f32 v[222:223], v[222:223], v[238:239]
    v_pk_add_f32 v[224:225], v[224:225], v[240:241]
    v_pk_add_f32 v[226:227], v[226:227], v[242:243]
    ds_write_b128 v11, v[212:215] offset:0
    ds_write_b128 v11, v[216:219] offset:32
    ds_write_b128 v11, v[220:223] offset:64
    ds_write_b128 v11, v[224:227] offset:96
    s_waitcnt vmcnt(0)
    v_lshlrev_b32 v112, 16, v244
    v_and_b32 v113, 0xffff0000, v244
    v_lshlrev_b32 v114, 16, v245
    v_and_b32 v115, 0xffff0000, v245
    v_lshlrev_b32 v116, 16, v246
    v_and_b32 v117, 0xffff0000, v246
    v_lshlrev_b32 v118, 16, v247
    v_and_b32 v119, 0xffff0000, v247
    s_waitcnt lgkmcnt(0)
    s_barrier
    ds_read_b128 v[212:215], v10 offset:0
    ds_read_b128 v[216:219], v10 offset:16
    ds_read_b128 v[220:223], v10 offset:16896
    ds_read_b128 v[224:227], v10 offset:16912
    s_waitcnt lgkmcnt(2)
    v_pk_add_f32 v[112:113], v[112:113], v[212:213]
    v_pk_add_f32 v[114:115], v[114:115], v[214:215]
    v_pk_add_f32 v[116:117], v[116:117], v[216:217]
    v_pk_add_f32 v[118:119], v[118:119], v[218:219]
    s_waitcnt lgkmcnt(0)
    v_pk_add_f32 v[112:113], v[112:113], v[220:221]
    v_pk_add_f32 v[114:115], v[114:115], v[222:223]
    v_pk_add_f32 v[116:117], v[116:117], v[224:225]
    v_pk_add_f32 v[118:119], v[118:119], v[226:227]
    v_cvt_pk_bf16_f32 v244, v112, v113
    v_cvt_pk_bf16_f32 v245, v114, v115
    v_cvt_pk_bf16_f32 v246, v116, v117
    v_cvt_pk_bf16_f32 v247, v118, v119
    buffer_store_dwordx4 v[244:247], v7, s[20:23], s38 offen sc1
    s_lshl_b32 s77, s29, 3
    s_add_u32 s77, s77, s3
    s_lshl_b32 s77, s77, 10
    s_add_u32 s77, s77, 0x600000
    s_mov_b32 s32, s10
    s_mov_b32 s33, s11
    s_mov_b32 s34, 0x1300000
    s_mov_b32 s35, 0x20000
    s_mov_b32 s24, s4
    s_mov_b32 s25, s5
    s_mov_b32 s26, 0x200000
    s_mov_b32 s27, 0x20000
    v_and_b32 v13, 31, v2
    v_lshrrev_b32 v14, 5, v2
    v_lshlrev_b32 v4, 5, v13
    v_lshl_add_u32 v4, v14, 4, v4
    v_add_u32 v4, 8192, v4
    s_mul_i32 s30, s3, 2080
    s_add_u32 s30, s30, 57344
    v_add_u32 v5, s30, v3
    s_lshl_b32 s30, s3, 8
    s_add_u32 s30, s30, 123904
    v_lshl_add_u32 v6, v2, 2, s30
    s_lshr_b32 s30, s3, 2
    s_bfe_u32 s31, s3, 0x10001
    s_and_b32 s37, s3, 1
    s_mul_i32 s38, s30, 16640
    s_lshl_b32 s39, s31, 10
    s_add_u32 s38, s38, s39
    s_lshl_b32 s39, s37, 9
    s_add_u32 s38, s38, s39
    s_add_u32 s38, s38, 57344
    v_lshrrev_b32 v13, 1, v2
    v_and_b32 v14, 1, v2
    v_mul_u32_u24 v7, 8320, v14
    v_lshl_add_u32 v7, v13, 4, v7
    v_add_u32 v7, s38, v7
    s_lshl_b32 s38, s30, 11
    s_add_u32 s38, s38, 123904
    v_lshlrev_b32 v8, 10, v14
    v_lshl_add_u32 v8, v13, 2, v8
    v_add_u32 v8, s38, v8
    s_lshl_b32 s38, s30, 10
    s_lshl_b32 s39, s31, 7
    s_add_u32 s38, s38, s39
    s_lshl_b32 s39, s37, 3
    s_add_u32 s38, s38, s39
    s_add_u32 s38, s38, 24576
    v_lshrrev_b32 v14, 4, v13
    v_lshlrev_b32 v9, 9, v14
    v_bfe_u32 v14, v13, 3, 1
    v_lshl_add_u32 v9, v14, 8, v9
    v_and_b32 v13, 7, v13
    v_lshl_add_u32 v9, v13, 4, v9
    v_add_u32 v9, s38, v9
    v_lshrrev_b32 v13, 4, v2
    v_and_b32 v14, 7, v2
    v_lshlrev_b32 v10, 7, v13
    v_lshl_add_u32 v10, v14, 4, v10
    s_lshl_b32 s38, s3, 8
    s_add_u32 s38, s38, 8192
    v_lshl_add_u32 v11, v14, 5, s38
    v_and_b32 v14, 1, v13
    v_lshl_add_u32 v11, v14, 4, v11
    v_lshrrev_b32 v14, 1, v13
    v_lshl_add_u32 v11, v14, 3, v11
    v_mov_b32 v12, 0
    v_mov_b32 v13, 132096
    ds_write_b32 v13, v12
    ds_write_b32 v13, v12 offset:16
    s_mov_b32 s42, 0x3b000000
    s_mov_b32 s43, 0x3727c5ac
    s_mov_b32 s44, 0x3eb8aa3b
    s_mov_b32 s45, 0x17800000
    s_mov_b32 s46, 0x71800000
    s_mov_b32 s47, 0x7e800000
    s_mov_b32 s40, 0x0000ffff
    s_mov_b32 s41, 0x0000ffff
    s_lshl_b32 s30, s3, 13
    s_add_u32 s60, s30, 0x9d0000
    s_add_u32 s61, s60, 4096
    s_add_u32 s62, s30, 0x9e0000
    s_add_u32 s63, s62, 4096
    s_add_u32 s58, s36, 0x8a0000
    s_lshl_b32 s59, s3, 16
    s_add_u32 s59, s59, 0x900000
    s_mov_b32 s70, 0
k4b_xp:
    buffer_load_dwordx4 v[212:215], v3, s[20:23], s77 offen sc1
    s_add_u32 s70, s70, 1
    s_waitcnt vmcnt(0)
    v_max3_u32 v13, v212, v213, v214
    v_max_u32 v13, v13, v215
    v_cmp_eq_u32 s[50:51], -1, v13
    s_cmp_eq_u64 s[50:51], 0
    s_cbranch_scc1 k4b_xok
    s_cmp_lt_u32 s70, 0x40000
    s_cbranch_scc1 k4b_xp
k4b_xok:
    s_lshl_b32 s30, s3, 10
    v_add_u32 v15, s30, v3
    ds_write_b128 v15, v[212:215] offset:16384
    v_lshlrev_b32 v220, 16, v212
    v_and_b32 v221, 0xffff0000, v212
    v_lshlrev_b32 v222, 16, v213
    v_and_b32 v223, 0xffff0000, v213
    v_lshlrev_b32 v224, 16, v214
    v_and_b32 v225, 0xffff0000, v214
    v_lshlrev_b32 v226, 16, v215
    v_and_b32 v227, 0xffff0000, v215
    v_add_f32 v13, v220, v221
    v_add_f32 v13, v13, v222
    v_add_f32 v13, v13, v223
    v_add_f32 v13, v13, v224
    v_add_f32 v13, v13, v225
    v_add_f32 v13, v13, v226
    v_add_f32 v13, v13, v227
    s_nop 1
    v_add_f32_dpp v13, v13, v13 quad_perm:[1,0,3,2] row_mask:0xf bank_mask:0xf
    s_nop 1
    v_add_f32_dpp v13, v13, v13 quad_perm:[2,3,0,1] row_mask:0xf bank_mask:0xf
    s_nop 1
    v_add_f32_dpp v13, v13, v13 row_half_mirror row_mask:0xf bank_mask:0xf
    s_nop 1
    v_add_f32_dpp v13, v13, v13 row_mirror row_mask:0xf bank_mask:0xf
    v_mov_b32 v14, v13
    s_nop 1
    v_permlane16_swap_b32 v13, v14
    v_add_f32 v13, v13, v14
    v_mov_b32 v14, v13
    s_nop 1
    v_permlane32_swap_b32 v13, v14
    v_add_f32 v13, v13, v14
    v_mul_f32 v13, s42, v13
    v_sub_f32 v220, v220, v13
    v_sub_f32 v221, v221, v13
    v_sub_f32 v222, v222, v13
    v_sub_f32 v223, v223, v13
    v_sub_f32 v224, v224, v13
    v_sub_f32 v225, v225, v13
    v_sub_f32 v226, v226, v13
    v_sub_f32 v227, v227, v13
    v_mul_f32 v13, v220, v220
    v_fmac_f32 v13, v221, v221
    v_fmac_f32 v13, v222, v222
    v_fmac_f32 v13, v223, v223
    v_fmac_f32 v13, v224, v224
    v_fmac_f32 v13, v225, v225
    v_fmac_f32 v13, v226, v226
    v_fmac_f32 v13, v227, v227
    s_nop 1
    v_add_f32_dpp v13, v13, v13 quad_perm:[1,0,3,2] row_mask:0xf bank_mask:0xf
    s_nop 1
    v_add_f32_dpp v13, v13, v13 quad_perm:[2,3,0,1] row_mask:0xf bank_mask:0xf
    s_nop 1
    v_add_f32_dpp v13, v13, v13 row_half_mirror row_mask:0xf bank_mask:0xf
    s_nop 1
    v_add_f32_dpp v13, v13, v13 row_mirror row_mask:0xf bank_mask:0xf
    v_mov_b32 v14, v13
    s_nop 1
    v_permlane16_swap_b32 v13, v14
    v_add_f32 v13, v13, v14
    v_mov_b32 v14, v13
    s_nop 1
    v_permlane32_swap_b32 v13, v14
    v_add_f32 v13, v13, v14
    v_mov_b32 v14, s43
    v_fmac_f32 v14, s42, v13
    v_rsq_f32 v14, v14
    s_nop 0
    v_mul_f32 v220, v220, v14
    v_mul_f32 v221, v221, v14
    v_mul_f32 v222, v222, v14
    v_mul_f32 v223, v223, v14
    v_mul_f32 v224, v224, v14
    v_mul_f32 v225, v225, v14
    v_mul_f32 v226, v226, v14
    v_mul_f32 v227, v227, v14
    v_cvt_pk_bf16_f32 v216, v220, v221
    v_cvt_pk_bf16_f32 v217, v222, v223
    v_cvt_pk_bf16_f32 v218, v224, v225
    v_cvt_pk_bf16_f32 v219, v226, v227
    s_lshl_b32 s30, s3, 4
    v_lshl_add_u32 v15, v2, 7, s30
    ds_write_b128 v15, v[216:219] offset:0
    v_add_u32 v15, s69, v10
    s_lshl_b32 s30, s3, 10
    s_add_u32 s30, s30, 57344
    v_add_u32 v13, s30, v3
    s_waitcnt lgkmcnt(0)
    s_barrier
    ds_read_b128 v[220:223], v15 offset:0
    ds_read_b128 v[224:227], v15 offset:512
    ds_read_b128 v[228:231], v15 offset:1024
    ds_read_b128 v[232:235], v15 offset:1536
    s_bitcmp1_b32 s3, 0
    s_cbranch_scc1 k4b_mv
    s_waitcnt lgkmcnt(3)
    v_mfma_f32_16x16x32_bf16 v[176:179], v[16:19], v[220:223], 0
    s_waitcnt lgkmcnt(2)
    v_mfma_f32_16x16x32_bf16 v[212:215], v[20:23], v[224:227], 0
    s_waitcnt lgkmcnt(1)
    v_mfma_f32_16x16x32_bf16 v[176:179], v[24:27], v[228:231], v[176:179]
    s_waitcnt lgkmcnt(0)
    v_mfma_f32_16x16x32_bf16 v[212:215], v[28:31], v[232:235], v[212:215]
    s_branch k4b_mj
k4b_mv:
    s_waitcnt lgkmcnt(3)
    v_mfma_f32_16x16x32_bf16 v[176:179], v[220:223], v[16:19], 0
    s_waitcnt lgkmcnt(2)
    v_mfma_f32_16x16x32_bf16 v[212:215], v[224:227], v[20:23], 0
    s_waitcnt lgkmcnt(1)
    v_mfma_f32_16x16x32_bf16 v[176:179], v[228:231], v[24:27], v[176:179]
    s_waitcnt lgkmcnt(0)
    v_mfma_f32_16x16x32_bf16 v[212:215], v[232:235], v[28:31], v[212:215]
k4b_mj:
    s_nop 7
    v_pk_add_f32 v[176:177], v[176:177], v[212:213]
    v_pk_add_f32 v[178:179], v[178:179], v[214:215]
    ds_write_b128 v13, v[176:179]
    s_waitcnt lgkmcnt(0)
    s_barrier
    s_cmp_lt_u32 s3, 2
    s_cbranch_scc1 k4b_kv
    s_branch k4b_q0
k4b_kv:
    ds_read_b128 v[212:215], v13 offset:2048
    ds_read_b128 v[216:219], v13 offset:4096
    ds_read_b128 v[236:239], v13 offset:6144
    v_and_b32 v13, 15, v2
    v_lshlrev_b32 v13, 4, v13
    v_bfe_u32 v14, v2, 4, 1
    s_lshr_b32 s30, s29, 2
    s_lshl_b32 s30, s30, 10
    s_cmp_eq_u32 s3, 1
    s_cbranch_scc1 k4b_pv
    v_lshl_add_u32 v13, v14, 9, v13
    v_lshrrev_b32 v14, 5, v2
    v_lshl_add_u32 v13, v14, 3, v13
    s_and_b32 s31, s29, 3
    s_lshl_b32 s31, s31, 7
    s_add_u32 s30, s30, s31
    s_add_u32 s30, s30, 0x9d0000
    s_mov_b32 s50, 0x00ff00ff
    s_mov_b32 s51, 0x00ff00ff
    s_branch k4b_pj
k4b_pv:
    v_lshl_add_u32 v13, v14, 8, v13
    s_bfe_u32 s31, s29, 0x10001
    s_lshl_b32 s31, s31, 9
    s_add_u32 s30, s30, s31
    s_and_b32 s31, s29, 1
    s_lshl_b32 s31, s31, 3
    s_add_u32 s30, s30, s31
    s_add_u32 s30, s30, 0x9e0000
    s_mov_b32 s50, -1
    s_mov_b32 s51, 0
k4b_pj:
    s_waitcnt lgkmcnt(0)
    v_pk_add_f32 v[176:177], v[176:177], v[212:213]
    v_pk_add_f32 v[216:217], v[216:217], v[236:237]
    v_pk_add_f32 v[178:179], v[178:179], v[214:215]
    v_pk_add_f32 v[218:219], v[218:219], v[238:239]
    v_pk_add_f32 v[176:177], v[176:177], v[216:217]
    v_pk_add_f32 v[178:179], v[178:179], v[218:219]
    v_cvt_pk_bf16_f32 v176, v176, v177
    v_cvt_pk_bf16_f32 v177, v178, v179
    s_mov_b64 exec, s[50:51]
    buffer_store_dwordx2 v[176:177], v13, s[20:23], s30 offen sc1
    s_mov_b64 exec, -1
k4b_q0:
    buffer_load_dwordx4 v[112:115], v3, s[20:23], s58 offen offset:0
    buffer_load_dwordx4 v[116:119], v3, s[20:23], s58 offen offset:1024
    buffer_load_dwordx4 v[120:123], v3, s[20:23], s58 offen offset:2048
    buffer_load_dwordx4 v[124:127], v3, s[20:23], s58 offen offset:3072
    s_add_u32 s58, s58, 4096
    buffer_load_dwordx4 v[128:131], v3, s[20:23], s58 offen offset:0
    buffer_load_dwordx4 v[132:135], v3, s[20:23], s58 offen offset:1024
    buffer_load_dwordx4 v[136:139], v3, s[20:23], s58 offen offset:2048
    buffer_load_dwordx4 v[140:143], v3, s[20:23], s58 offen offset:3072
    s_add_u32 s58, s58, 4096
    v_and_b32 v13, 15, v2
    v_lshrrev_b32 v14, 5, v2
    v_lshlrev_b32 v13, 4, v13
    v_lshl_add_u32 v0, v14, 8, v13
    v_and_b32 v13, 31, v2
    v_cmp_eq_u32 s[50:51], 16, v13
    v_mov_b32 v14, 0x3f803f80
    s_nop 0
    v_cndmask_b32 v48, 0, v14, s[50:51]
    v_mov_b32 v49, v48
    v_mov_b64 v[50:51], v[48:49]
    v_mov_b64 v[52:53], v[48:49]
    v_mov_b64 v[54:55], v[48:49]
    v_mov_b64 v[56:57], v[48:49]
    v_mov_b64 v[58:59], v[48:49]
    v_mov_b64 v[60:61], v[48:49]
    v_mov_b64 v[62:63], v[48:49]
    v_mov_b64 v[64:65], v[48:49]
    v_mov_b64 v[66:67], v[48:49]
    v_mov_b64 v[68:69], v[48:49]
    v_mov_b64 v[70:71], v[48:49]
    v_mov_b64 v[72:73], v[48:49]
    v_mov_b64 v[74:75], v[48:49]
    v_mov_b64 v[76:77], v[48:49]
    v_mov_b64 v[78:79], v[48:49]
    v_mov_b64 v[80:81], v[48:49]
    v_mov_b64 v[82:83], v[48:49]
    v_mov_b64 v[84:85], v[48:49]
    v_mov_b64 v[86:87], v[48:49]
    v_mov_b64 v[88:89], v[48:49]
    v_mov_b64 v[90:91], v[48:49]
    v_mov_b64 v[92:93], v[48:49]
    v_mov_b64 v[94:95], v[48:49]
    v_mov_b64 v[96:97], v[48:49]
    v_mov_b64 v[98:99], v[48:49]
    v_mov_b64 v[100:101], v[48:49]
    v_mov_b64 v[102:103], v[48:49]
    v_mov_b64 v[104:105], v[48:49]
    v_mov_b64 v[106:107], v[48:49]
    v_mov_b64 v[108:109], v[48:49]
    v_mov_b64 v[110:111], v[48:49]
    ds_read_b128 v[220:223], v10 offset:0
    ds_read_b128 v[224:227], v10 offset:512
    ds_read_b128 v[228:231], v10 offset:1024
    ds_read_b128 v[232:235], v10 offset:1536
    ds_read_b128 v[240:243], v10 offset:2048
    ds_read_b128 v[244:247], v10 offset:2560
    ds_read_b128 v[248:251], v10 offset:3072
    ds_read_b128 v[252:255], v10 offset:3584
    s_waitcnt vmcnt(23) lgkmcnt(7)
    v_mfma_f32_16x16x32_bf16 v[176:179], v[144:147], v[220:223], 0
    ds_read_b128 v[220:223], v10 offset:4096
    s_waitcnt vmcnt(22) lgkmcnt(7)
    v_mfma_f32_16x16x32_bf16 v[212:215], v[148:151], v[224:227], 0
    ds_read_b128 v[224:227], v10 offset:4608
    s_waitcnt vmcnt(21) lgkmcnt(7)
    v_mfma_f32_16x16x32_bf16 v[216:219], v[152:155], v[228:231], 0
    ds_read_b128 v[228:231], v10 offset:5120
    s_waitcnt vmcnt(20) lgkmcnt(7)
    v_mfma_f32_16x16x32_bf16 v[236:239], v[156:159], v[232:235], 0
    ds_read_b128 v[232:235], v10 offset:5632
    s_waitcnt vmcnt(19) lgkmcnt(7)
    v_mfma_f32_16x16x32_bf16 v[176:179], v[160:163], v[240:243], v[176:179]
    ds_read_b128 v[240:243], v10 offset:6144
    s_waitcnt vmcnt(18) lgkmcnt(7)
    v_mfma_f32_16x16x32_bf16 v[212:215], v[164:167], v[244:247], v[212:215]
    ds_read_b128 v[244:247], v10 offset:6656
    s_waitcnt vmcnt(17) lgkmcnt(7)
    v_mfma_f32_16x16x32_bf16 v[216:219], v[168:171], v[248:251], v[216:219]
    ds_read_b128 v[248:251], v10 offset:7168
    s_waitcnt vmcnt(16) lgkmcnt(7)
    v_mfma_f32_16x16x32_bf16 v[236:239], v[172:175], v[252:255], v[236:239]
    ds_read_b128 v[252:255], v10 offset:7680
    s_waitcnt vmcnt(15) lgkmcnt(7)
    v_mfma_f32_16x16x32_bf16 v[176:179], v[180:183], v[220:223], v[176:179]
    s_waitcnt vmcnt(14) lgkmcnt(6)
    v_mfma_f32_16x16x32_bf16 v[212:215], v[184:187], v[224:227], v[212:215]
    s_waitcnt vmcnt(13) lgkmcnt(5)
    v_mfma_f32_16x16x32_bf16 v[216:219], v[188:191], v[228:231], v[216:219]
    s_waitcnt vmcnt(12) lgkmcnt(4)
    v_mfma_f32_16x16x32_bf16 v[236:239], v[192:195], v[232:235], v[236:239]
    s_waitcnt vmcnt(11) lgkmcnt(3)
    v_mfma_f32_16x16x32_bf16 v[176:179], v[196:199], v[240:243], v[176:179]
    s_waitcnt vmcnt(10) lgkmcnt(2)
    v_mfma_f32_16x16x32_bf16 v[212:215], v[200:203], v[244:247], v[212:215]
    s_waitcnt vmcnt(9) lgkmcnt(1)
    v_mfma_f32_16x16x32_bf16 v[216:219], v[204:207], v[248:251], v[216:219]
    s_waitcnt vmcnt(8) lgkmcnt(0)
    v_mfma_f32_16x16x32_bf16 v[236:239], v[208:211], v[252:255], v[236:239]
    s_nop 3
    v_pk_add_f32 v[176:177], v[176:177], v[212:213]
    s_nop 2
    v_pk_add_f32 v[216:217], v[216:217], v[236:237]
    v_pk_add_f32 v[178:179], v[178:179], v[214:215]
    v_pk_add_f32 v[218:219], v[218:219], v[238:239]
    v_pk_add_f32 v[176:177], v[176:177], v[216:217]
    v_pk_add_f32 v[178:179], v[178:179], v[218:219]
    v_mul_f32 v176, s44, v176
    v_mul_f32 v177, s44, v177
    v_mul_f32 v178, s44, v178
    v_mul_f32 v179, s44, v179
    v_cvt_pk_bf16_f32 v176, v176, v177
    v_cvt_pk_bf16_f32 v177, v178, v179
    ds_write_b64 v11, v[176:177]
    v_add_u32 v11, 2048, v11
    s_waitcnt vmcnt(0)
    buffer_load_dwordx4 v[16:19], v3, s[20:23], s60 offen offset:0
    buffer_load_dwordx4 v[20:23], v3, s[20:23], s60 offen offset:1024
    s_mov_b64 exec, s[40:41]
    buffer_load_dwordx4 v[48:51], v0, s[20:23], s62 offen offset:0
    buffer_load_dwordx4 v[52:55], v0, s[20:23], s62 offen offset:512
    s_mov_b64 exec, -1
    buffer_load_dwordx4 v[24:27], v3, s[20:23], s60 offen offset:2048
    s_mov_b64 exec, s[40:41]
    buffer_load_dwordx4 v[56:59], v0, s[20:23], s62 offen offset:1024
    buffer_load_dwordx4 v[60:63], v0, s[20:23], s62 offen offset:1536
    s_mov_b64 exec, -1
    v_mov_b64 v[240:241], 0
    v_mov_b64 v[242:243], 0
    v_mov_b64 v[244:245], 0
    v_mov_b64 v[246:247], 0
    v_mov_b64 v[248:249], 0
    v_mov_b64 v[250:251], 0
    v_mov_b64 v[252:253], 0
    v_mov_b64 v[254:255], 0
    s_mov_b32 s49, 1
    s_mov_b32 s64, 24576
    v_mov_b32 v15, v10
    s_waitcnt lgkmcnt(0)
    s_barrier
    ds_read_b128 v[236:239], v4
    v_add_u32 v4, 1024, v4
    s_mov_b32 s70, 0
    s_waitcnt vmcnt(6) lgkmcnt(0)
k4b_cks:
    v_max3_u32 v13, v16, v17, v18
    v_max_u32 v13, v13, v19
    v_cmp_eq_u32 s[50:51], -1, v13
    s_cmp_lg_u64 s[50:51], 0
    s_cbranch_scc1 k4b_rts
k4b_oks:
    v_mfma_f32_32x32x16_bf16 v[180:195], v[16:19], v[236:239], 0
    s_waitcnt vmcnt(3)
k4b_ck0:
    v_max3_u32 v13, v20, v21, v22
    v_max3_u32 v13, v13, v23, v48
    v_max3_u32 v13, v13, v49, v50
    v_max3_u32 v13, v13, v51, v52
    v_max3_u32 v13, v13, v53, v54
    v_max_u32 v13, v13, v55
    v_cmp_eq_u32 s[50:51], -1, v13
    s_cmp_lg_u64 s[50:51], 0
    s_cbranch_scc1 k4b_rt0
k4b_ok0:
    v_mfma_f32_32x32x16_bf16 v[196:211], v[20:23], v[236:239], 0
    buffer_load_dwordx4 v[28:31], v3, s[20:23], s60 offen offset:3072
    s_mov_b64 exec, s[40:41]
    buffer_load_dwordx4 v[64:67], v0, s[20:23], s62 offen offset:2048
    buffer_load_dwordx4 v[68:71], v0, s[20:23], s62 offen offset:2560
    s_mov_b64 exec, -1
    v_exp_f32 v180, v180
    v_exp_f32 v181, v181
    v_exp_f32 v182, v182
    v_exp_f32 v183, v183
    v_exp_f32 v184, v184
    v_exp_f32 v185, v185
    v_exp_f32 v186, v186
    v_exp_f32 v187, v187
    v_cvt_pk_bf16_f32 v212, v180, v181
    v_cvt_pk_bf16_f32 v213, v182, v183
    v_exp_f32 v188, v188
    v_exp_f32 v189, v189
    v_cvt_pk_bf16_f32 v214, v184, v185
    v_cvt_pk_bf16_f32 v215, v186, v187
    v_exp_f32 v190, v190
    v_exp_f32 v191, v191
    v_mfma_f32_32x32x16_bf16 v[220:235], v[48:51], v[212:215], 0
    v_exp_f32 v192, v192
    v_exp_f32 v193, v193
    v_exp_f32 v194, v194
    v_exp_f32 v195, v195
    v_cvt_pk_bf16_f32 v216, v188, v189
    v_cvt_pk_bf16_f32 v217, v190, v191
    v_cvt_pk_bf16_f32 v218, v192, v193
    v_cvt_pk_bf16_f32 v219, v194, v195
    s_setprio 0
    s_waitcnt vmcnt(3)
k4b_ck1:
    v_max3_u32 v13, v24, v25, v26
    v_max3_u32 v13, v13, v27, v56
    v_max3_u32 v13, v13, v57, v58
    v_max3_u32 v13, v13, v59, v60
    v_max3_u32 v13, v13, v61, v62
    v_max_u32 v13, v13, v63
    v_cmp_eq_u32 s[50:51], -1, v13
    s_cmp_lg_u64 s[50:51], 0
    s_cbranch_scc1 k4b_rt1
k4b_ok1:
    v_mfma_f32_32x32x16_bf16 v[180:195], v[24:27], v[236:239], 0
    buffer_load_dwordx4 v[32:35], v3, s[20:23], s61 offen offset:0
    s_mov_b64 exec, s[40:41]
    buffer_load_dwordx4 v[72:75], v0, s[20:23], s62 offen offset:3072
    buffer_load_dwordx4 v[76:79], v0, s[20:23], s62 offen offset:3584
    s_mov_b64 exec, -1
    v_exp_f32 v196, v196
    v_exp_f32 v197, v197
    v_exp_f32 v198, v198
    v_exp_f32 v199, v199
    v_mfma_f32_32x32x16_bf16 v[220:235], v[52:55], v[216:219], v[220:235]
    v_exp_f32 v200, v200
    v_exp_f32 v201, v201
    v_exp_f32 v202, v202
    v_exp_f32 v203, v203
    v_cvt_pk_bf16_f32 v212, v196, v197
    v_cvt_pk_bf16_f32 v213, v198, v199
    v_exp_f32 v204, v204
    v_exp_f32 v205, v205
    v_cvt_pk_bf16_f32 v214, v200, v201
    v_cvt_pk_bf16_f32 v215, v202, v203
    v_exp_f32 v206, v206
    v_exp_f32 v207, v207
    v_mfma_f32_32x32x16_bf16 v[220:235], v[56:59], v[212:215], v[220:235]
    v_exp_f32 v208, v208
    v_exp_f32 v209, v209
    v_exp_f32 v210, v210
    v_exp_f32 v211, v211
    v_cvt_pk_bf16_f32 v216, v204, v205
    v_cvt_pk_bf16_f32 v217, v206, v207
    v_cvt_pk_bf16_f32 v218, v208, v209
    v_cvt_pk_bf16_f32 v219, v210, v211
    s_waitcnt vmcnt(3)
k4b_ck2:
    v_max3_u32 v13, v28, v29, v30
    v_max3_u32 v13, v13, v31, v64
    v_max3_u32 v13, v13, v65, v66
    v_max3_u32 v13, v13, v67, v68
    v_max3_u32 v13, v13, v69, v70
    v_max_u32 v13, v13, v71
    v_cmp_eq_u32 s[50:51], -1, v13
    s_cmp_lg_u64 s[50:51], 0
    s_cbranch_scc1 k4b_rt2
k4b_ok2:
    v_mfma_f32_32x32x16_bf16 v[196:211], v[28:31], v[236:239], 0
    buffer_load_dwordx4 v[36:39], v3, s[20:23], s61 offen offset:1024
    s_mov_b64 exec, s[40:41]
    buffer_load_dwordx4 v[80:83], v0, s[20:23], s63 offen offset:0
    buffer_load_dwordx4 v[84:87], v0, s[20:23], s63 offen offset:512
    s_mov_b64 exec, -1
    v_exp_f32 v180, v180
    v_exp_f32 v181, v181
    v_exp_f32 v182, v182
    v_exp_f32 v183, v183
    v_mfma_f32_32x32x16_bf16 v[220:235], v[60:63], v[216:219], v[220:235]
    v_exp_f32 v184, v184
    v_exp_f32 v185, v185
    v_exp_f32 v186, v186
    v_exp_f32 v187, v187
    v_cvt_pk_bf16_f32 v212, v180, v181
    v_cvt_pk_bf16_f32 v213, v182, v183
    v_exp_f32 v188, v188
    v_exp_f32 v189, v189
    v_cvt_pk_bf16_f32 v214, v184, v185
    v_cvt_pk_bf16_f32 v215, v186, v187
    v_exp_f32 v190, v190
    v_exp_f32 v191, v191
    v_mfma_f32_32x32x16_bf16 v[220:235], v[64:67], v[212:215], v[220:235]
    v_exp_f32 v192, v192
    v_exp_f32 v193, v193
    v_exp_f32 v194, v194
    v_exp_f32 v195, v195
    v_cvt_pk_bf16_f32 v216, v188, v189
    v_cvt_pk_bf16_f32 v217, v190, v191
    v_cvt_pk_bf16_f32 v218, v192, v193
    v_cvt_pk_bf16_f32 v219, v194, v195
    s_waitcnt vmcnt(3)
k4b_ck3:
    v_max3_u32 v13, v32, v33, v34
    v_max3_u32 v13, v13, v35, v72
    v_max3_u32 v13, v13, v73, v74
    v_max3_u32 v13, v13, v75, v76
    v_max3_u32 v13, v13, v77, v78
    v_max_u32 v13, v13, v79
    v_cmp_eq_u32 s[50:51], -1, v13
    s_cmp_lg_u64 s[50:51], 0
    s_cbranch_scc1 k4b_rt3
k4b_ok3:
    v_mfma_f32_32x32x16_bf16 v[180:195], v[32:35], v[236:239], 0
    buffer_load_dwordx4 v[40:43], v3, s[20:23], s61 offen offset:2048
    s_mov_b64 exec, s[40:41]
    buffer_load_dwordx4 v[88:91], v0, s[20:23], s63 offen offset:1024
    buffer_load_dwordx4 v[92:95], v0, s[20:23], s63 offen offset:1536
    s_mov_b64 exec, -1
    v_exp_f32 v196, v196
    v_exp_f32 v197, v197
    v_exp_f32 v198, v198
    v_exp_f32 v199, v199
    v_mfma_f32_32x32x16_bf16 v[220:235], v[68:71], v[216:219], v[220:235]
    v_exp_f32 v200, v200
    v_exp_f32 v201, v201
    v_exp_f32 v202, v202
    v_exp_f32 v203, v203
    v_cvt_pk_bf16_f32 v212, v196, v197
    v_cvt_pk_bf16_f32 v213, v198, v199
    s_setprio 3
    v_exp_f32 v204, v204
    v_exp_f32 v205, v205
    v_cvt_pk_bf16_f32 v214, v200, v201
    v_cvt_pk_bf16_f32 v215, v202, v203
    v_exp_f32 v206, v206
    v_exp_f32 v207, v207
    v_mfma_f32_32x32x16_bf16 v[220:235], v[72:75], v[212:215], v[220:235]
    v_exp_f32 v208, v208
    v_exp_f32 v209, v209
    v_exp_f32 v210, v210
    v_exp_f32 v211, v211
    v_cvt_pk_bf16_f32 v216, v204, v205
    v_cvt_pk_bf16_f32 v217, v206, v207
    v_cvt_pk_bf16_f32 v218, v208, v209
    v_cvt_pk_bf16_f32 v219, v210, v211
    s_waitcnt vmcnt(3)
k4b_ck4:
    v_max3_u32 v13, v36, v37, v38
    v_max3_u32 v13, v13, v39, v80
    v_max3_u32 v13, v13, v81, v82
    v_max3_u32 v13, v13, v83, v84
    v_max3_u32 v13, v13, v85, v86
    v_max_u32 v13, v13, v87
    v_cmp_eq_u32 s[50:51], -1, v13
    s_cmp_lg_u64 s[50:51], 0
    s_cbranch_scc1 k4b_rt4
k4b_ok4:
    v_mfma_f32_32x32x16_bf16 v[196:211], v[36:39], v[236:239], 0
    buffer_load_dwordx4 v[44:47], v3, s[20:23], s61 offen offset:3072
    s_mov_b64 exec, s[40:41]
    buffer_load_dwordx4 v[96:99], v0, s[20:23], s63 offen offset:2048
    buffer_load_dwordx4 v[100:103], v0, s[20:23], s63 offen offset:2560
    s_mov_b64 exec, -1
    v_exp_f32 v180, v180
    v_exp_f32 v181, v181
    v_exp_f32 v182, v182
    v_exp_f32 v183, v183
    v_mfma_f32_32x32x16_bf16 v[220:235], v[76:79], v[216:219], v[220:235]
    v_exp_f32 v184, v184
    v_exp_f32 v185, v185
    v_exp_f32 v186, v186
    v_exp_f32 v187, v187
    v_cvt_pk_bf16_f32 v212, v180, v181
    v_cvt_pk_bf16_f32 v213, v182, v183
    v_exp_f32 v188, v188
    v_exp_f32 v189, v189
    v_cvt_pk_bf16_f32 v214, v184, v185
    v_cvt_pk_bf16_f32 v215, v186, v187
    v_exp_f32 v190, v190
    v_exp_f32 v191, v191
    v_mfma_f32_32x32x16_bf16 v[220:235], v[80:83], v[212:215], v[220:235]
    v_exp_f32 v192, v192
    v_exp_f32 v193, v193
    v_exp_f32 v194, v194
    v_exp_f32 v195, v195
    v_cvt_pk_bf16_f32 v216, v188, v189
    v_cvt_pk_bf16_f32 v217, v190, v191
    v_cvt_pk_bf16_f32 v218, v192, v193
    v_cvt_pk_bf16_f32 v219, v194, v195
    s_setprio 2
    s_waitcnt vmcnt(3)
k4b_ck5:
    v_max3_u32 v13, v40, v41, v42
    v_max3_u32 v13, v13, v43, v88
    v_max3_u32 v13, v13, v89, v90
    v_max3_u32 v13, v13, v91, v92
    v_max3_u32 v13, v13, v93, v94
    v_max_u32 v13, v13, v95
    v_cmp_eq_u32 s[50:51], -1, v13
    s_cmp_lg_u64 s[50:51], 0
    s_cbranch_scc1 k4b_rt5
k4b_ok5:
    v_mfma_f32_32x32x16_bf16 v[180:195], v[40:43], v[236:239], 0
    s_mov_b64 exec, s[40:41]
    buffer_load_dwordx4 v[104:107], v0, s[20:23], s63 offen offset:3072
    buffer_load_dwordx4 v[108:111], v0, s[20:23], s63 offen offset:3584
    s_mov_b64 exec, -1
    v_exp_f32 v196, v196
    v_exp_f32 v197, v197
    v_exp_f32 v198, v198
    v_exp_f32 v199, v199
    v_mfma_f32_32x32x16_bf16 v[220:235], v[84:87], v[216:219], v[220:235]
    v_exp_f32 v200, v200
    v_exp_f32 v201, v201
    v_exp_f32 v202, v202
    v_exp_f32 v203, v203
    v_cvt_pk_bf16_f32 v212, v196, v197
    v_cvt_pk_bf16_f32 v213, v198, v199
    v_exp_f32 v204, v204
    v_exp_f32 v205, v205
    v_cvt_pk_bf16_f32 v214, v200, v201
    v_cvt_pk_bf16_f32 v215, v202, v203
    v_exp_f32 v206, v206
    v_exp_f32 v207, v207
    v_mfma_f32_32x32x16_bf16 v[220:235], v[88:91], v[212:215], v[220:235]
    v_exp_f32 v208, v208
    v_exp_f32 v209, v209
    v_exp_f32 v210, v210
    v_exp_f32 v211, v211
    v_cvt_pk_bf16_f32 v216, v204, v205
    v_cvt_pk_bf16_f32 v217, v206, v207
    v_cvt_pk_bf16_f32 v218, v208, v209
    v_cvt_pk_bf16_f32 v219, v210, v211
    s_waitcnt vmcnt(2)
k4b_ck6:
    v_max3_u32 v13, v44, v45, v46
    v_max3_u32 v13, v13, v47, v96
    v_max3_u32 v13, v13, v97, v98
    v_max3_u32 v13, v13, v99, v100
    v_max3_u32 v13, v13, v101, v102
    v_max_u32 v13, v13, v103
    v_cmp_eq_u32 s[50:51], -1, v13
    s_cmp_lg_u64 s[50:51], 0
    s_cbranch_scc1 k4b_rt6
k4b_ok6:
    v_mfma_f32_32x32x16_bf16 v[196:211], v[44:47], v[236:239], 0
    ds_read_b128 v[236:239], v4
    v_add_u32 v4, 1024, v4
    v_exp_f32 v180, v180
    v_exp_f32 v181, v181
    v_exp_f32 v182, v182
    v_exp_f32 v183, v183
    v_mfma_f32_32x32x16_bf16 v[220:235], v[92:95], v[216:219], v[220:235]
    v_exp_f32 v184, v184
    v_exp_f32 v185, v185
    v_exp_f32 v186, v186
    v_exp_f32 v187, v187
    v_cvt_pk_bf16_f32 v212, v180, v181
    v_cvt_pk_bf16_f32 v213, v182, v183
    v_exp_f32 v188, v188
    v_exp_f32 v189, v189
    v_cvt_pk_bf16_f32 v214, v184, v185
    v_cvt_pk_bf16_f32 v215, v186, v187
    v_exp_f32 v190, v190
    v_exp_f32 v191, v191
    v_mfma_f32_32x32x16_bf16 v[220:235], v[96:99], v[212:215], v[220:235]
    v_exp_f32 v192, v192
    v_exp_f32 v193, v193
    v_exp_f32 v194, v194
    v_exp_f32 v195, v195
    v_cvt_pk_bf16_f32 v216, v188, v189
    v_cvt_pk_bf16_f32 v217, v190, v191
    v_cvt_pk_bf16_f32 v218, v192, v193
    v_cvt_pk_bf16_f32 v219, v194, v195
    s_setprio 1
    s_waitcnt vmcnt(0)
k4b_ck7:
    v_max3_u32 v13, v104, v105, v106
    v_max3_u32 v13, v13, v107, v108
    v_max3_u32 v13, v13, v109, v110
    v_max_u32 v13, v13, v111
    v_cmp_eq_u32 s[50:51], -1, v13
    s_cmp_lg_u64 s[50:51], 0
    s_cbranch_scc1 k4b_rt7
k4b_ok7:
    s_waitcnt lgkmcnt(0)
    v_mfma_f32_32x32x16_bf16 v[180:195], v[16:19], v[236:239], 0
    v_exp_f32 v196, v196
    v_exp_f32 v197, v197
    v_exp_f32 v198, v198
    v_exp_f32 v199, v199
    v_mfma_f32_32x32x16_bf16 v[220:235], v[100:103], v[216:219], v[220:235]
    v_exp_f32 v200, v200
    v_exp_f32 v201, v201
    v_exp_f32 v202, v202
    v_exp_f32 v203, v203
    v_cvt_pk_bf16_f32 v212, v196, v197
    v_cvt_pk_bf16_f32 v213, v198, v199
    v_exp_f32 v204, v204
    v_exp_f32 v205, v205
    v_cvt_pk_bf16_f32 v214, v200, v201
    v_cvt_pk_bf16_f32 v215, v202, v203
    v_exp_f32 v206, v206
    v_exp_f32 v207, v207
    v_mfma_f32_32x32x16_bf16 v[220:235], v[104:107], v[212:215], v[220:235]
    v_exp_f32 v208, v208
    v_exp_f32 v209, v209
    v_exp_f32 v210, v210
    v_exp_f32 v211, v211
    v_cvt_pk_bf16_f32 v216, v204, v205
    v_cvt_pk_bf16_f32 v217, v206, v207
    v_cvt_pk_bf16_f32 v218, v208, v209
    v_cvt_pk_bf16_f32 v219, v210, v211
    s_mov_b32 s30, s58
    s_add_u32 s58, s58, 122880
    ds_read_b128 v[144:147], v15 offset:0
    ds_read_b128 v[148:151], v15 offset:512
    v_mov_b32 v0, 132112
    s_mov_b32 s76, 8
    v_mfma_f32_32x32x16_bf16 v[196:211], v[20:23], v[236:239], 0
    v_exp_f32 v180, v180
    v_exp_f32 v181, v181
    v_exp_f32 v182, v182
    v_exp_f32 v183, v183
    v_mfma_f32_32x32x16_bf16 v[220:235], v[108:111], v[216:219], v[220:235]
    v_exp_f32 v184, v184
    v_exp_f32 v185, v185
    v_exp_f32 v186, v186
    v_exp_f32 v187, v187
    v_cvt_pk_bf16_f32 v212, v180, v181
    v_cvt_pk_bf16_f32 v213, v182, v183
    s_waitcnt vmcnt(31) lgkmcnt(1)
    v_mfma_f32_16x16x32_bf16 v[240:243], v[112:115], v[144:147], v[240:243]
    buffer_load_dwordx4 v[112:115], v3, s[32:35], s30 offen offset:0
    ds_read_b128 v[152:155], v15 offset:1024
    v_exp_f32 v188, v188
    v_exp_f32 v189, v189
    v_cvt_pk_bf16_f32 v214, v184, v185
    v_cvt_pk_bf16_f32 v215, v186, v187
    s_waitcnt vmcnt(31) lgkmcnt(1)
    v_mfma_f32_16x16x32_bf16 v[240:243], v[116:119], v[148:151], v[240:243]
    buffer_load_dwordx4 v[116:119], v3, s[32:35], s30 offen offset:1024
    ds_read_b128 v[156:159], v15 offset:1536
    v_exp_f32 v190, v190
    v_exp_f32 v191, v191
    ds_write_b128 v5, v[220:223]
    ds_write_b128 v5, v[224:227] offset:1024
    ds_write_b32 v6, v228
    v_mfma_f32_32x32x16_bf16 v[220:235], v[48:51], v[212:215], 0
    v_exp_f32 v192, v192
    v_exp_f32 v193, v193
    v_exp_f32 v194, v194
    v_exp_f32 v195, v195
    v_cvt_pk_bf16_f32 v216, v188, v189
    v_cvt_pk_bf16_f32 v217, v190, v191
    s_waitcnt vmcnt(31) lgkmcnt(1)
    v_mfma_f32_16x16x32_bf16 v[240:243], v[120:123], v[152:155], v[240:243]
    buffer_load_dwordx4 v[120:123], v3, s[32:35], s30 offen offset:2048
    ds_read_b128 v[144:147], v15 offset:2048
    v_cvt_pk_bf16_f32 v218, v192, v193
    v_cvt_pk_bf16_f32 v219, v194, v195
    v_add_u32 v5, 16640, v5
    v_add_u32 v6, 2048, v6
    s_setprio 0
    v_mfma_f32_32x32x16_bf16 v[180:195], v[24:27], v[236:239], 0
    v_exp_f32 v196, v196
    v_exp_f32 v197, v197
    v_exp_f32 v198, v198
    v_exp_f32 v199, v199
    v_mfma_f32_32x32x16_bf16 v[220:235], v[52:55], v[216:219], v[220:235]
    v_exp_f32 v200, v200
    v_exp_f32 v201, v201
    v_exp_f32 v202, v202
    v_exp_f32 v203, v203
    v_cvt_pk_bf16_f32 v212, v196, v197
    v_cvt_pk_bf16_f32 v213, v198, v199
    s_waitcnt vmcnt(31) lgkmcnt(1)
    v_mfma_f32_16x16x32_bf16 v[240:243], v[124:127], v[156:159], v[240:243]
    buffer_load_dwordx4 v[124:127], v3, s[32:35], s30 offen offset:3072
    s_add_u32 s30, s30, 4096
    ds_read_b128 v[148:151], v15 offset:2560
    v_exp_f32 v204, v204
    v_exp_f32 v205, v205
    v_cvt_pk_bf16_f32 v214, v200, v201
    v_cvt_pk_bf16_f32 v215, v202, v203
    s_waitcnt vmcnt(31) lgkmcnt(1)
    v_mfma_f32_16x16x32_bf16 v[244:247], v[128:131], v[144:147], v[244:247]
    buffer_load_dwordx4 v[128:131], v3, s[32:35], s30 offen offset:0
    ds_read_b128 v[152:155], v15 offset:3072
    v_exp_f32 v206, v206
    v_exp_f32 v207, v207
    v_mfma_f32_32x32x16_bf16 v[220:235], v[56:59], v[212:215], v[220:235]
    v_exp_f32 v208, v208
    v_exp_f32 v209, v209
    v_exp_f32 v210, v210
    v_exp_f32 v211, v211
    v_cvt_pk_bf16_f32 v216, v204, v205
    v_cvt_pk_bf16_f32 v217, v206, v207
    s_waitcnt vmcnt(31) lgkmcnt(1)
    v_mfma_f32_16x16x32_bf16 v[244:247], v[132:135], v[148:151], v[244:247]
    buffer_load_dwordx4 v[132:135], v3, s[32:35], s30 offen offset:1024
    ds_read_b128 v[156:159], v15 offset:3584
    v_cvt_pk_bf16_f32 v218, v208, v209
    v_cvt_pk_bf16_f32 v219, v210, v211
    v_mfma_f32_32x32x16_bf16 v[196:211], v[28:31], v[236:239], 0
    v_exp_f32 v180, v180
    v_exp_f32 v181, v181
    v_exp_f32 v182, v182
    v_exp_f32 v183, v183
    v_mfma_f32_32x32x16_bf16 v[220:235], v[60:63], v[216:219], v[220:235]
    v_exp_f32 v184, v184
    v_exp_f32 v185, v185
    v_exp_f32 v186, v186
    v_exp_f32 v187, v187
    v_cvt_pk_bf16_f32 v212, v180, v181
    v_cvt_pk_bf16_f32 v213, v182, v183
    s_waitcnt vmcnt(31) lgkmcnt(1)
    v_mfma_f32_16x16x32_bf16 v[244:247], v[136:139], v[152:155], v[244:247]
    buffer_load_dwordx4 v[136:139], v3, s[32:35], s30 offen offset:2048
    ds_read_b128 v[144:147], v15 offset:4096
    v_exp_f32 v188, v188
    v_exp_f32 v189, v189
    v_cvt_pk_bf16_f32 v214, v184, v185
    v_cvt_pk_bf16_f32 v215, v186, v187
    s_waitcnt vmcnt(31) lgkmcnt(1)
    v_mfma_f32_16x16x32_bf16 v[244:247], v[140:143], v[156:159], v[244:247]
    buffer_load_dwordx4 v[140:143], v3, s[32:35], s30 offen offset:3072
    ds_read_b128 v[148:151], v15 offset:4608
    v_exp_f32 v190, v190
    v_exp_f32 v191, v191
    v_mfma_f32_32x32x16_bf16 v[220:235], v[64:67], v[212:215], v[220:235]
    v_exp_f32 v192, v192
    v_exp_f32 v193, v193
    v_exp_f32 v194, v194
    v_exp_f32 v195, v195
    v_cvt_pk_bf16_f32 v216, v188, v189
    v_cvt_pk_bf16_f32 v217, v190, v191
    s_mov_b32 s30, s58
    s_add_u32 s58, s58, 0x20000
    s_waitcnt vmcnt(7) lgkmcnt(1)
    v_mfma_f32_16x16x32_bf16 v[248:251], v[112:115], v[144:147], v[248:251]
    buffer_load_dwordx4 v[112:115], v3, s[32:35], s30 offen offset:0
    ds_read_b128 v[152:155], v15 offset:5120
    v_cvt_pk_bf16_f32 v218, v192, v193
    v_cvt_pk_bf16_f32 v219, v194, v195
    v_mfma_f32_32x32x16_bf16 v[180:195], v[32:35], v[236:239], 0
    v_exp_f32 v196, v196
    v_exp_f32 v197, v197
    v_exp_f32 v198, v198
    v_exp_f32 v199, v199
    v_mfma_f32_32x32x16_bf16 v[220:235], v[68:71], v[216:219], v[220:235]
    v_exp_f32 v200, v200
    v_exp_f32 v201, v201
    v_exp_f32 v202, v202
    v_exp_f32 v203, v203
    v_cvt_pk_bf16_f32 v212, v196, v197
    v_cvt_pk_bf16_f32 v213, v198, v199
    s_waitcnt vmcnt(7) lgkmcnt(1)
    v_mfma_f32_16x16x32_bf16 v[248:251], v[116:119], v[148:151], v[248:251]
    buffer_load_dwordx4 v[116:119], v3, s[32:35], s30 offen offset:1024
    ds_read_b128 v[156:159], v15 offset:5632
    s_setprio 3
    v_exp_f32 v204, v204
    v_exp_f32 v205, v205
    v_cvt_pk_bf16_f32 v214, v200, v201
    v_cvt_pk_bf16_f32 v215, v202, v203
    s_waitcnt vmcnt(7) lgkmcnt(1)
    v_mfma_f32_16x16x32_bf16 v[248:251], v[120:123], v[152:155], v[248:251]
    buffer_load_dwordx4 v[120:123], v3, s[32:35], s30 offen offset:2048
    ds_read_b128 v[144:147], v15 offset:6144
    v_exp_f32 v206, v206
    v_exp_f32 v207, v207
    v_mfma_f32_32x32x16_bf16 v[220:235], v[72:75], v[212:215], v[220:235]
    v_exp_f32 v208, v208
    v_exp_f32 v209, v209
    v_exp_f32 v210, v210
    v_exp_f32 v211, v211
    v_cvt_pk_bf16_f32 v216, v204, v205
    v_cvt_pk_bf16_f32 v217, v206, v207
    s_waitcnt vmcnt(7) lgkmcnt(1)
    v_mfma_f32_16x16x32_bf16 v[248:251], v[124:127], v[156:159], v[248:251]
    buffer_load_dwordx4 v[124:127], v3, s[32:35], s30 offen offset:3072
    s_add_u32 s30, s30, 4096
    ds_read_b128 v[148:151], v15 offset:6656
    v_cvt_pk_bf16_f32 v218, v208, v209
    v_cvt_pk_bf16_f32 v219, v210, v211
    v_mfma_f32_32x32x16_bf16 v[196:211], v[36:39], v[236:239], 0
    v_exp_f32 v180, v180
    v_exp_f32 v181, v181
    v_exp_f32 v182, v182
    v_exp_f32 v183, v183
    v_mfma_f32_32x32x16_bf16 v[220:235], v[76:79], v[216:219], v[220:235]
    v_exp_f32 v184, v184
    v_exp_f32 v185, v185
    v_exp_f32 v186, v186
    v_exp_f32 v187, v187
    v_cvt_pk_bf16_f32 v212, v180, v181
    v_cvt_pk_bf16_f32 v213, v182, v183
    s_waitcnt vmcnt(7) lgkmcnt(1)
    v_mfma_f32_16x16x32_bf16 v[252:255], v[128:131], v[144:147], v[252:255]
    buffer_load_dwordx4 v[128:131], v3, s[32:35], s30 offen offset:0
    ds_read_b128 v[152:155], v15 offset:7168
    v_exp_f32 v188, v188
    v_exp_f32 v189, v189
    v_cvt_pk_bf16_f32 v214, v184, v185
    v_cvt_pk_bf16_f32 v215, v186, v187
    s_waitcnt vmcnt(7) lgkmcnt(1)
    v_mfma_f32_16x16x32_bf16 v[252:255], v[132:135], v[148:151], v[252:255]
    buffer_load_dwordx4 v[132:135], v3, s[32:35], s30 offen offset:1024
    ds_read_b128 v[156:159], v15 offset:7680
    v_exp_f32 v190, v190
    v_exp_f32 v191, v191
    v_mfma_f32_32x32x16_bf16 v[220:235], v[80:83], v[212:215], v[220:235]
    v_exp_f32 v192, v192
    v_exp_f32 v193, v193
    s_waitcnt vmcnt(7) lgkmcnt(1)
    v_mfma_f32_16x16x32_bf16 v[252:255], v[136:139], v[152:155], v[252:255]
    buffer_load_dwordx4 v[136:139], v3, s[32:35], s30 offen offset:2048
    v_exp_f32 v194, v194
    v_exp_f32 v195, v195
    v_cvt_pk_bf16_f32 v216, v188, v189
    v_cvt_pk_bf16_f32 v217, v190, v191
    s_waitcnt vmcnt(7) lgkmcnt(0)
    v_mfma_f32_16x16x32_bf16 v[252:255], v[140:143], v[156:159], v[252:255]
    buffer_load_dwordx4 v[140:143], v3, s[32:35], s30 offen offset:3072
    s_add_u32 s30, s30, 4096
    v_cvt_pk_bf16_f32 v218, v192, v193
    v_cvt_pk_bf16_f32 v219, v194, v195
    s_setprio 2
    v_mfma_f32_32x32x16_bf16 v[180:195], v[40:43], v[236:239], 0
    v_exp_f32 v196, v196
    v_exp_f32 v197, v197
    v_exp_f32 v198, v198
    v_exp_f32 v199, v199
    v_mfma_f32_32x32x16_bf16 v[220:235], v[84:87], v[216:219], v[220:235]
    v_exp_f32 v200, v200
    v_exp_f32 v201, v201
    v_exp_f32 v202, v202
    v_exp_f32 v203, v203
    v_cvt_pk_bf16_f32 v212, v196, v197
    v_cvt_pk_bf16_f32 v213, v198, v199
    v_exp_f32 v204, v204
    v_exp_f32 v205, v205
    v_cvt_pk_bf16_f32 v214, v200, v201
    v_cvt_pk_bf16_f32 v215, v202, v203
    v_exp_f32 v206, v206
    v_exp_f32 v207, v207
    v_mfma_f32_32x32x16_bf16 v[220:235], v[88:91], v[212:215], v[220:235]
    v_exp_f32 v208, v208
    v_exp_f32 v209, v209
    v_exp_f32 v210, v210
    v_exp_f32 v211, v211
    v_cvt_pk_bf16_f32 v216, v204, v205
    v_cvt_pk_bf16_f32 v217, v206, v207
    v_cvt_pk_bf16_f32 v218, v208, v209
    v_cvt_pk_bf16_f32 v219, v210, v211
    v_pk_add_f32 v[240:241], v[240:241], v[244:245]
    v_pk_add_f32 v[242:243], v[242:243], v[246:247]
    v_pk_add_f32 v[248:249], v[248:249], v[252:253]
    v_pk_add_f32 v[250:251], v[250:251], v[254:255]
    v_pk_add_f32 v[240:241], v[240:241], v[248:249]
    v_pk_add_f32 v[242:243], v[242:243], v[250:251]
    v_mul_f32 v240, s44, v240
    v_mul_f32 v241, s44, v241
    v_mul_f32 v242, s44, v242
    v_mul_f32 v243, s44, v243
    v_cvt_pk_bf16_f32 v144, v240, v241
    v_cvt_pk_bf16_f32 v145, v242, v243
    ds_write_b64 v11, v[144:145]
    v_add_u32 v11, 2048, v11
    v_mov_b64 v[240:241], 0
    v_mov_b64 v[242:243], 0
    v_mov_b64 v[244:245], 0
    v_mov_b64 v[246:247], 0
    v_mov_b64 v[248:249], 0
    v_mov_b64 v[250:251], 0
    v_mov_b64 v[252:253], 0
    v_mov_b64 v[254:255], 0
    s_waitcnt lgkmcnt(0)
    s_barrier
    v_mfma_f32_32x32x16_bf16 v[196:211], v[44:47], v[236:239], 0
    ds_read_b128 v[236:239], v4
    v_add_u32 v4, 1024, v4
    v_exp_f32 v180, v180
    v_exp_f32 v181, v181
    v_exp_f32 v182, v182
    v_exp_f32 v183, v183
    v_mfma_f32_32x32x16_bf16 v[220:235], v[92:95], v[216:219], v[220:235]
    v_exp_f32 v184, v184
    v_exp_f32 v185, v185
    v_exp_f32 v186, v186
    v_exp_f32 v187, v187
    v_cvt_pk_bf16_f32 v212, v180, v181
    v_cvt_pk_bf16_f32 v213, v182, v183
    v_exp_f32 v188, v188
    v_exp_f32 v189, v189
    v_cvt_pk_bf16_f32 v214, v184, v185
    v_cvt_pk_bf16_f32 v215, v186, v187
    v_exp_f32 v190, v190
    v_exp_f32 v191, v191
    v_mfma_f32_32x32x16_bf16 v[220:235], v[96:99], v[212:215], v[220:235]
    v_exp_f32 v192, v192
    v_exp_f32 v193, v193
    v_exp_f32 v194, v194
    v_exp_f32 v195, v195
    v_cvt_pk_bf16_f32 v216, v188, v189
    v_cvt_pk_bf16_f32 v217, v190, v191
    v_cvt_pk_bf16_f32 v218, v192, v193
    v_cvt_pk_bf16_f32 v219, v194, v195
    s_setprio 1
    s_waitcnt lgkmcnt(0)
    v_mfma_f32_32x32x16_bf16 v[180:195], v[16:19], v[236:239], 0
    v_exp_f32 v196, v196
    v_exp_f32 v197, v197
    v_exp_f32 v198, v198
    v_exp_f32 v199, v199
    v_mfma_f32_32x32x16_bf16 v[220:235], v[100:103], v[216:219], v[220:235]
    v_exp_f32 v200, v200
    v_exp_f32 v201, v201
    v_exp_f32 v202, v202
    v_exp_f32 v203, v203
    v_cvt_pk_bf16_f32 v212, v196, v197
    v_cvt_pk_bf16_f32 v213, v198, v199
    v_exp_f32 v204, v204
    v_exp_f32 v205, v205
    v_cvt_pk_bf16_f32 v214, v200, v201
    v_cvt_pk_bf16_f32 v215, v202, v203
    v_exp_f32 v206, v206
    v_exp_f32 v207, v207
    v_mfma_f32_32x32x16_bf16 v[220:235], v[104:107], v[212:215], v[220:235]
    v_exp_f32 v208, v208
    v_exp_f32 v209, v209
    v_exp_f32 v210, v210
    v_exp_f32 v211, v211
    v_cvt_pk_bf16_f32 v216, v204, v205
    v_cvt_pk_bf16_f32 v217, v206, v207
    v_cvt_pk_bf16_f32 v218, v208, v209
    v_cvt_pk_bf16_f32 v219, v210, v211
    s_mov_b32 s28, 2
k4b_slot:
    v_mfma_f32_32x32x16_bf16 v[196:211], v[20:23], v[236:239], 0
    v_exp_f32 v180, v180
    v_exp_f32 v181, v181
    v_exp_f32 v182, v182
    v_exp_f32 v183, v183
    v_mfma_f32_32x32x16_bf16 v[220:235], v[108:111], v[216:219], v[220:235]
    v_exp_f32 v184, v184
    v_exp_f32 v185, v185
    v_exp_f32 v186, v186
    v_exp_f32 v187, v187
    v_cvt_pk_bf16_f32 v212, v180, v181
    v_cvt_pk_bf16_f32 v213, v182, v183
    v_exp_f32 v188, v188
    v_exp_f32 v189, v189
    v_cvt_pk_bf16_f32 v214, v184, v185
    v_cvt_pk_bf16_f32 v215, v186, v187
    v_exp_f32 v190, v190
    v_exp_f32 v191, v191
    ds_write_b128 v5, v[220:223]
    ds_write_b128 v5, v[224:227] offset:1024
    ds_write_b32 v6, v228
    v_mfma_f32_32x32x16_bf16 v[220:235], v[48:51], v[212:215], 0
    v_exp_f32 v192, v192
    v_exp_f32 v193, v193
    v_exp_f32 v194, v194
    v_exp_f32 v195, v195
    v_cvt_pk_bf16_f32 v216, v188, v189
    v_cvt_pk_bf16_f32 v217, v190, v191
    v_cvt_pk_bf16_f32 v218, v192, v193
    v_cvt_pk_bf16_f32 v219, v194, v195
    s_and_b32 s37, s28, 3
    s_mov_b32 s37, -49920
    s_cselect_b32 s37, 16640, s37
    v_add_u32 v5, s37, v5
    s_mov_b32 s37, -6144
    s_cselect_b32 s37, 2048, s37
    v_add_u32 v6, s37, v6
    s_bitcmp0_b32 0x18, s28
    s_cbranch_scc1 k4b_noq
    v_pk_add_f32 v[240:241], v[240:241], v[244:245]
    v_pk_add_f32 v[242:243], v[242:243], v[246:247]
    v_pk_add_f32 v[248:249], v[248:249], v[252:253]
    v_pk_add_f32 v[250:251], v[250:251], v[254:255]
    v_pk_add_f32 v[240:241], v[240:241], v[248:249]
    v_pk_add_f32 v[242:243], v[242:243], v[250:251]
    v_mul_f32 v240, s44, v240
    v_mul_f32 v241, s44, v241
    v_mul_f32 v242, s44, v242
    v_mul_f32 v243, s44, v243
    v_cvt_pk_bf16_f32 v144, v240, v241
    v_cvt_pk_bf16_f32 v145, v242, v243
    ds_write_b64 v11, v[144:145]
    v_add_u32 v11, 2048, v11
    v_mov_b64 v[240:241], 0
    v_mov_b64 v[242:243], 0
    v_mov_b64 v[244:245], 0
    v_mov_b64 v[246:247], 0
    v_mov_b64 v[248:249], 0
    v_mov_b64 v[250:251], 0
    v_mov_b64 v[252:253], 0
    v_mov_b64 v[254:255], 0
k4b_noq:
    s_cmp_eq_u32 s28, 5
    s_cselect_b32 s37, 8192, 0
    s_bitcmp1_b32 0xd0, s28
    s_cselect_b32 s37, s64, s37
    s_cselect_b32 s38, 8192, 0
    s_add_u32 s64, s64, s38
    v_add_u32 v15, s37, v10
    s_cmp_ge_u32 s28, 4
    s_cselect_b64 vcc, -1, 0
    s_bitcmp0_b32 0x5c, s28
    s_cbranch_scc1 k4b_na0
    s_mov_b64 exec, 1
    ds_inc_u32 v0, v0
    s_mov_b64 exec, -1
k4b_na0:
    ds_read_b128 v[144:147], v15 offset:0
    ds_read_b128 v[148:151], v15 offset:512
    s_setprio 0
    v_mfma_f32_32x32x16_bf16 v[180:195], v[24:27], v[236:239], 0
    v_exp_f32 v196, v196
    v_exp_f32 v197, v197
    v_exp_f32 v198, v198
    v_exp_f32 v199, v199
    v_mfma_f32_32x32x16_bf16 v[220:235], v[52:55], v[216:219], v[220:235]
    v_exp_f32 v200, v200
    v_exp_f32 v201, v201
    v_exp_f32 v202, v202
    v_exp_f32 v203, v203
    v_cvt_pk_bf16_f32 v212, v196, v197
    v_cvt_pk_bf16_f32 v213, v198, v199
    s_waitcnt vmcnt(7) lgkmcnt(1)
    v_mfma_f32_16x16x32_bf16 v[240:243], v[112:115], v[144:147], v[240:243]
    buffer_load_dwordx4 v[112:115], v3, s[32:35], s30 offen offset:0
    ds_read_b128 v[152:155], v15 offset:1024
    v_exp_f32 v204, v204
    v_exp_f32 v205, v205
    v_cvt_pk_bf16_f32 v214, v200, v201
    v_cvt_pk_bf16_f32 v215, v202, v203
    v_exp_f32 v206, v206
    v_exp_f32 v207, v207
    v_mfma_f32_32x32x16_bf16 v[220:235], v[56:59], v[212:215], v[220:235]
    v_exp_f32 v208, v208
    v_exp_f32 v209, v209
    v_exp_f32 v210, v210
    v_exp_f32 v211, v211
    v_cvt_pk_bf16_f32 v216, v204, v205
    v_cvt_pk_bf16_f32 v217, v206, v207
    s_waitcnt vmcnt(7) lgkmcnt(1)
    v_mfma_f32_16x16x32_bf16 v[240:243], v[116:119], v[148:151], v[240:243]
    buffer_load_dwordx4 v[116:119], v3, s[32:35], s30 offen offset:1024
    ds_read_b128 v[156:159], v15 offset:1536
    v_cvt_pk_bf16_f32 v218, v208, v209
    v_cvt_pk_bf16_f32 v219, v210, v211
    v_mfma_f32_32x32x16_bf16 v[196:211], v[28:31], v[236:239], 0
    v_exp_f32 v180, v180
    v_exp_f32 v181, v181
    v_exp_f32 v182, v182
    v_exp_f32 v183, v183
    v_mfma_f32_32x32x16_bf16 v[220:235], v[60:63], v[216:219], v[220:235]
    v_exp_f32 v184, v184
    v_exp_f32 v185, v185
    v_exp_f32 v186, v186
    v_exp_f32 v187, v187
    v_cvt_pk_bf16_f32 v212, v180, v181
    v_cvt_pk_bf16_f32 v213, v182, v183
    s_waitcnt vmcnt(7) lgkmcnt(1)
    v_mfma_f32_16x16x32_bf16 v[240:243], v[120:123], v[152:155], v[240:243]
    buffer_load_dwordx4 v[120:123], v3, s[32:35], s30 offen offset:2048
    s_cbranch_vccnz k4b_nb2
    ds_read_b128 v[144:147], v15 offset:2048
k4b_nb2:
    v_exp_f32 v188, v188
    v_exp_f32 v189, v189
    v_cvt_pk_bf16_f32 v214, v184, v185
    v_cvt_pk_bf16_f32 v215, v186, v187
    v_exp_f32 v190, v190
    v_exp_f32 v191, v191
    v_mfma_f32_32x32x16_bf16 v[220:235], v[64:67], v[212:215], v[220:235]
    v_exp_f32 v192, v192
    v_exp_f32 v193, v193
    v_exp_f32 v194, v194
    v_exp_f32 v195, v195
    v_cvt_pk_bf16_f32 v216, v188, v189
    v_cvt_pk_bf16_f32 v217, v190, v191
    s_waitcnt vmcnt(7) lgkmcnt(0)
    v_mfma_f32_16x16x32_bf16 v[240:243], v[124:127], v[156:159], v[240:243]
    buffer_load_dwordx4 v[124:127], v3, s[32:35], s30 offen offset:3072
    s_add_u32 s30, s30, 4096
    s_cbranch_vccnz k4b_nb3
    ds_read_b128 v[148:151], v15 offset:2560
k4b_nb3:
    ds_read_b32 v14, v0
    v_cvt_pk_bf16_f32 v218, v192, v193
    v_cvt_pk_bf16_f32 v219, v194, v195
    v_mfma_f32_32x32x16_bf16 v[180:195], v[32:35], v[236:239], 0
    v_exp_f32 v196, v196
    v_exp_f32 v197, v197
    v_exp_f32 v198, v198
    v_exp_f32 v199, v199
    v_mfma_f32_32x32x16_bf16 v[220:235], v[68:71], v[216:219], v[220:235]
    v_exp_f32 v200, v200
    v_exp_f32 v201, v201
    v_exp_f32 v202, v202
    v_exp_f32 v203, v203
    v_cvt_pk_bf16_f32 v212, v196, v197
    v_cvt_pk_bf16_f32 v213, v198, v199
    s_waitcnt vmcnt(7) lgkmcnt(1)
    v_mfma_f32_16x16x32_bf16 v[244:247], v[128:131], v[144:147], v[244:247]
    buffer_load_dwordx4 v[128:131], v3, s[32:35], s30 offen offset:0
    s_bitcmp0_b32 0x5c, s28
    s_cbranch_scc1 k4b_nw0
    s_waitcnt lgkmcnt(0)
    v_readfirstlane_b32 s37, v14
    s_cmp_ge_u32 s37, s76
    s_cbranch_scc0 k4b_wsa
k4b_woa:
    s_add_u32 s76, s76, 8
k4b_nw0:
    s_cbranch_vccnz k4b_nb4
    ds_read_b128 v[152:155], v15 offset:3072
k4b_nb4:
    s_setprio 3
    s_bitcmp1_b32 s28, 0
    s_cbranch_scc1 k4b_nrr
    ds_read_b128 v[160:163], v7 offset:0
    ds_read_b32 v176, v8 offset:0
    ds_read_b128 v[164:167], v7 offset:2080
    ds_read_b32 v177, v8 offset:256
    ds_read_b128 v[168:171], v7 offset:4160
    ds_read_b32 v178, v8 offset:512
    ds_read_b128 v[172:175], v7 offset:6240
    ds_read_b32 v179, v8 offset:768
k4b_nrr:
    v_exp_f32 v204, v204
    v_exp_f32 v205, v205
    v_cvt_pk_bf16_f32 v214, v200, v201
    v_cvt_pk_bf16_f32 v215, v202, v203
    v_exp_f32 v206, v206
    v_exp_f32 v207, v207
    v_mfma_f32_32x32x16_bf16 v[220:235], v[72:75], v[212:215], v[220:235]
    v_exp_f32 v208, v208
    v_exp_f32 v209, v209
    v_exp_f32 v210, v210
    v_exp_f32 v211, v211
    v_cvt_pk_bf16_f32 v216, v204, v205
    v_cvt_pk_bf16_f32 v217, v206, v207
    s_waitcnt vmcnt(7) lgkmcnt(1)
    v_mfma_f32_16x16x32_bf16 v[244:247], v[132:135], v[148:151], v[244:247]
    buffer_load_dwordx4 v[132:135], v3, s[32:35], s30 offen offset:1024
    s_cbranch_vccnz k4b_nb5
    ds_read_b128 v[156:159], v15 offset:3584
k4b_nb5:
    v_cvt_pk_bf16_f32 v218, v208, v209
    v_cvt_pk_bf16_f32 v219, v210, v211
    v_mfma_f32_32x32x16_bf16 v[196:211], v[36:39], v[236:239], 0
    v_exp_f32 v180, v180
    v_exp_f32 v181, v181
    v_exp_f32 v182, v182
    v_exp_f32 v183, v183
    v_mfma_f32_32x32x16_bf16 v[220:235], v[76:79], v[216:219], v[220:235]
    v_exp_f32 v184, v184
    v_exp_f32 v185, v185
    v_exp_f32 v186, v186
    v_exp_f32 v187, v187
    v_cvt_pk_bf16_f32 v212, v180, v181
    v_cvt_pk_bf16_f32 v213, v182, v183
    s_waitcnt vmcnt(7) lgkmcnt(1)
    v_mfma_f32_16x16x32_bf16 v[244:247], v[136:139], v[152:155], v[244:247]
    buffer_load_dwordx4 v[136:139], v3, s[32:35], s30 offen offset:2048
    s_cbranch_vccnz k4b_nb6
    ds_read_b128 v[144:147], v15 offset:4096
k4b_nb6:
    v_exp_f32 v188, v188
    v_exp_f32 v189, v189
    v_cvt_pk_bf16_f32 v214, v184, v185
    v_cvt_pk_bf16_f32 v215, v186, v187
    v_exp_f32 v190, v190
    v_exp_f32 v191, v191
    v_mfma_f32_32x32x16_bf16 v[220:235], v[80:83], v[212:215], v[220:235]
    v_exp_f32 v192, v192
    v_exp_f32 v193, v193
    v_exp_f32 v194, v194
    v_exp_f32 v195, v195
    v_cvt_pk_bf16_f32 v216, v188, v189
    v_cvt_pk_bf16_f32 v217, v190, v191
    s_waitcnt vmcnt(7) lgkmcnt(1)
    v_mfma_f32_16x16x32_bf16 v[244:247], v[140:143], v[156:159], v[244:247]
    buffer_load_dwordx4 v[140:143], v3, s[32:35], s30 offen offset:3072
    s_cbranch_vccnz k4b_nb7
    ds_read_b128 v[148:151], v15 offset:4608
k4b_nb7:
    v_cvt_pk_bf16_f32 v218, v192, v193
    v_cvt_pk_bf16_f32 v219, v194, v195
    s_bitcmp1_b32 s28, 0
    s_cbranch_scc1 k4b_nored
    s_waitcnt lgkmcnt(0)
    v_pk_add_f32 v[160:161], v[160:161], v[164:165]
    v_pk_add_f32 v[162:163], v[162:163], v[166:167]
    v_add_f32 v176, v176, v177
    v_pk_add_f32 v[168:169], v[168:169], v[172:173]
    v_pk_add_f32 v[170:171], v[170:171], v[174:175]
    v_add_f32 v178, v178, v179
    v_pk_add_f32 v[160:161], v[160:161], v[168:169]
    v_add_f32 v176, v176, v178
    v_pk_add_f32 v[162:163], v[162:163], v[170:171]
    v_add_f32_dpp v160, v160, v160 quad_perm:[1,0,3,2] row_mask:0xf bank_mask:0xf
    v_add_f32_dpp v176, v176, v176 quad_perm:[1,0,3,2] row_mask:0xf bank_mask:0xf
    v_add_f32_dpp v161, v161, v161 quad_perm:[1,0,3,2] row_mask:0xf bank_mask:0xf
    v_add_f32_dpp v162, v162, v162 quad_perm:[1,0,3,2] row_mask:0xf bank_mask:0xf
    v_add_f32_dpp v163, v163, v163 quad_perm:[1,0,3,2] row_mask:0xf bank_mask:0xf
    v_rcp_f32 v177, v176
    v_max3_f32 v178, |v160|, |v161|, |v162|
    v_max_f32 v178, |v163|, v178
    v_cmp_le_f32 s[50:51], s45, v176
    v_cmp_ge_f32 s[52:53], s46, v176
    v_cmp_gt_f32 s[54:55], s47, v178
    v_add_f32 v179, v160, v161
    v_add_f32 v178, v162, v163
    v_cmp_o_f32 s[56:57], v179, v178
    s_and_b64 s[50:51], s[50:51], s[52:53]
    s_and_b64 s[54:55], s[54:55], s[56:57]
    s_and_b64 s[50:51], s[50:51], s[54:55]
    v_pk_mul_f32 v[160:161], v[160:161], v[176:177] op_sel:[0,1] op_sel_hi:[1,1]
    v_pk_mul_f32 v[162:163], v[162:163], v[176:177] op_sel:[0,1] op_sel_hi:[1,1]
    v_cvt_pk_bf16_f32 v160, v160, v161
    v_cvt_pk_bf16_f32 v161, v162, v163
    v_cndmask_b32 v160, 0, v160, s[50:51]
    v_cndmask_b32 v161, 0, v161, s[50:51]
    ds_write_b64 v9, v[160:161] offset:0
    s_cmp_eq_u64 s[50:51], exec
    s_cbranch_scc1 k4b_rokl
    v_mov_b32 v13, s49
    v_cndmask_b32 v13, v13, 0, s[50:51]
    v_or_b32 v12, v12, v13
    v_mov_b32 v14, 132096
    ds_or_b32 v14, v13
k4b_rokl:
    v_add_u32 v9, 8192, v9
    s_and_b32 s37, s49, 5
    s_mov_b32 s37, -33280
    s_cselect_b32 s37, 33280, s37
    v_add_u32 v7, s37, v7
    s_mov_b32 s37, -4096
    s_cselect_b32 s37, 4096, s37
    v_add_u32 v8, s37, v8
    s_lshl_b32 s49, s49, 1
k4b_nored:
    s_setprio 2
    v_mfma_f32_32x32x16_bf16 v[180:195], v[40:43], v[236:239], 0
    v_exp_f32 v196, v196
    v_exp_f32 v197, v197
    v_exp_f32 v198, v198
    v_exp_f32 v199, v199
    v_mfma_f32_32x32x16_bf16 v[220:235], v[84:87], v[216:219], v[220:235]
    v_exp_f32 v200, v200
    v_exp_f32 v201, v201
    v_exp_f32 v202, v202
    v_exp_f32 v203, v203
    v_cvt_pk_bf16_f32 v212, v196, v197
    v_cvt_pk_bf16_f32 v213, v198, v199
    s_add_u32 s37, s28, 1
    s_cmp_eq_u32 s37, 3
    s_cselect_b32 s30, s58, s59
    s_bitcmp1_b32 0x1d0, s37
    s_cselect_b32 s38, 16384, 0
    s_add_u32 s59, s59, s38
    s_cmp_eq_u32 s37, 5
    s_cselect_b32 s34, 0, 0x1300000
    s_waitcnt vmcnt(7) lgkmcnt(1)
    v_mfma_f32_16x16x32_bf16 v[248:251], v[112:115], v[144:147], v[248:251]
    buffer_load_dwordx4 v[112:115], v3, s[32:35], s30 offen offset:0
    s_cbranch_vccnz k4b_nb8
    ds_read_b128 v[152:155], v15 offset:5120
k4b_nb8:
    v_exp_f32 v204, v204
    v_exp_f32 v205, v205
    v_cvt_pk_bf16_f32 v214, v200, v201
    v_cvt_pk_bf16_f32 v215, v202, v203
    v_exp_f32 v206, v206
    v_exp_f32 v207, v207
    v_mfma_f32_32x32x16_bf16 v[220:235], v[88:91], v[212:215], v[220:235]
    v_exp_f32 v208, v208
    v_exp_f32 v209, v209
    v_exp_f32 v210, v210
    v_exp_f32 v211, v211
    v_cvt_pk_bf16_f32 v216, v204, v205
    v_cvt_pk_bf16_f32 v217, v206, v207
    s_waitcnt vmcnt(7) lgkmcnt(1)
    v_mfma_f32_16x16x32_bf16 v[248:251], v[116:119], v[148:151], v[248:251]
    buffer_load_dwordx4 v[116:119], v3, s[32:35], s30 offen offset:1024
    s_cbranch_vccnz k4b_nb9
    ds_read_b128 v[156:159], v15 offset:5632
k4b_nb9:
    v_cvt_pk_bf16_f32 v218, v208, v209
    v_cvt_pk_bf16_f32 v219, v210, v211
    s_bitcmp0_b32 0x50, s28
    s_cbranch_scc1 k4b_na1
    s_mov_b64 exec, 1
    ds_inc_u32 v0, v0
    s_mov_b64 exec, -1
k4b_na1:
    v_mfma_f32_32x32x16_bf16 v[196:211], v[44:47], v[236:239], 0
    ds_read_b128 v[236:239], v4
    v_add_u32 v4, 1024, v4
    v_exp_f32 v180, v180
    v_exp_f32 v181, v181
    v_exp_f32 v182, v182
    v_exp_f32 v183, v183
    v_mfma_f32_32x32x16_bf16 v[220:235], v[92:95], v[216:219], v[220:235]
    v_exp_f32 v184, v184
    v_exp_f32 v185, v185
    v_exp_f32 v186, v186
    v_exp_f32 v187, v187
    v_cvt_pk_bf16_f32 v212, v180, v181
    v_cvt_pk_bf16_f32 v213, v182, v183
    s_waitcnt vmcnt(7) lgkmcnt(1)
    v_mfma_f32_16x16x32_bf16 v[248:251], v[120:123], v[152:155], v[248:251]
    buffer_load_dwordx4 v[120:123], v3, s[32:35], s30 offen offset:2048
    s_cbranch_vccnz k4b_nb10
    ds_read_b128 v[144:147], v15 offset:6144
k4b_nb10:
    v_exp_f32 v188, v188
    v_exp_f32 v189, v189
    v_cvt_pk_bf16_f32 v214, v184, v185
    v_cvt_pk_bf16_f32 v215, v186, v187
    s_waitcnt vmcnt(7) lgkmcnt(1)
    v_mfma_f32_16x16x32_bf16 v[248:251], v[124:127], v[156:159], v[248:251]
    buffer_load_dwordx4 v[124:127], v3, s[32:35], s30 offen offset:3072
    s_add_u32 s30, s30, 4096
    s_cbranch_vccnz k4b_nb11
    ds_read_b128 v[148:151], v15 offset:6656
k4b_nb11:
    v_exp_f32 v190, v190
    v_exp_f32 v191, v191
    v_mfma_f32_32x32x16_bf16 v[220:235], v[96:99], v[212:215], v[220:235]
    v_exp_f32 v192, v192
    v_exp_f32 v193, v193
    v_exp_f32 v194, v194
    v_exp_f32 v195, v195
    v_cvt_pk_bf16_f32 v216, v188, v189
    v_cvt_pk_bf16_f32 v217, v190, v191
    s_waitcnt vmcnt(7) lgkmcnt(1)
    v_mfma_f32_16x16x32_bf16 v[252:255], v[128:131], v[144:147], v[252:255]
    buffer_load_dwordx4 v[128:131], v3, s[32:35], s30 offen offset:0
    s_cbranch_vccnz k4b_nb12
    ds_read_b128 v[152:155], v15 offset:7168
k4b_nb12:
    v_cvt_pk_bf16_f32 v218, v192, v193
    v_cvt_pk_bf16_f32 v219, v194, v195
    s_setprio 1
    s_waitcnt lgkmcnt(0)
    v_mfma_f32_32x32x16_bf16 v[180:195], v[16:19], v[236:239], 0
    v_exp_f32 v196, v196
    v_exp_f32 v197, v197
    v_exp_f32 v198, v198
    v_exp_f32 v199, v199
    v_mfma_f32_32x32x16_bf16 v[220:235], v[100:103], v[216:219], v[220:235]
    v_exp_f32 v200, v200
    v_exp_f32 v201, v201
    v_exp_f32 v202, v202
    v_exp_f32 v203, v203
    v_cvt_pk_bf16_f32 v212, v196, v197
    v_cvt_pk_bf16_f32 v213, v198, v199
    s_waitcnt vmcnt(7) lgkmcnt(1)
    v_mfma_f32_16x16x32_bf16 v[252:255], v[132:135], v[148:151], v[252:255]
    buffer_load_dwordx4 v[132:135], v3, s[32:35], s30 offen offset:1024
    s_cbranch_vccnz k4b_nb13
    ds_read_b128 v[156:159], v15 offset:7680
k4b_nb13:
    v_exp_f32 v204, v204
    v_exp_f32 v205, v205
    v_cvt_pk_bf16_f32 v214, v200, v201
    v_cvt_pk_bf16_f32 v215, v202, v203
    s_waitcnt vmcnt(7) lgkmcnt(1)
    v_mfma_f32_16x16x32_bf16 v[252:255], v[136:139], v[152:155], v[252:255]
    buffer_load_dwordx4 v[136:139], v3, s[32:35], s30 offen offset:2048
    ds_read_b32 v14, v0
    v_exp_f32 v206, v206
    v_exp_f32 v207, v207
    v_mfma_f32_32x32x16_bf16 v[220:235], v[104:107], v[212:215], v[220:235]
    v_exp_f32 v208, v208
    v_exp_f32 v209, v209
    v_exp_f32 v210, v210
    v_exp_f32 v211, v211
    v_cvt_pk_bf16_f32 v216, v204, v205
    v_cvt_pk_bf16_f32 v217, v206, v207
    s_waitcnt vmcnt(7) lgkmcnt(0)
    v_mfma_f32_16x16x32_bf16 v[252:255], v[140:143], v[156:159], v[252:255]
    buffer_load_dwordx4 v[140:143], v3, s[32:35], s30 offen offset:3072
    s_add_u32 s30, s30, 4096
    v_cvt_pk_bf16_f32 v218, v208, v209
    v_cvt_pk_bf16_f32 v219, v210, v211
    s_bitcmp0_b32 0x60, s28
    s_cbranch_scc1 k4b_nw1
    v_readfirstlane_b32 s37, v14
    s_cmp_ge_u32 s37, s76
    s_cbranch_scc0 k4b_wsb
k4b_wob:
    s_add_u32 s76, s76, 8
k4b_nw1:
    s_add_u32 s28, s28, 1
    s_cmp_lt_u32 s28, 8
    s_cbranch_scc1 k4b_slot
    v_mfma_f32_32x32x16_bf16 v[220:235], v[108:111], v[216:219], v[220:235]
    v_and_b32 v204, 7, v2
    v_lshrrev_b32 v205, 4, v2
    v_lshlrev_b32 v204, 10, v204
    v_lshl_add_u32 v204, v205, 3, v204
    s_lshl_b32 s31, s3, 7
    v_add_u32 v11, s31, v204
    v_add_u32 v15, s64, v10
    buffer_load_dwordx4 v[16:19], v3, s[20:23], s30 offen offset:0
    buffer_load_dwordx4 v[20:23], v3, s[20:23], s30 offen offset:1024
    buffer_load_dwordx4 v[24:27], v3, s[20:23], s30 offen offset:2048
    buffer_load_dwordx4 v[28:31], v3, s[20:23], s30 offen offset:3072
    s_add_u32 s30, s30, 4096
    ds_write_b128 v5, v[220:223]
    ds_write_b128 v5, v[224:227] offset:1024
    ds_write_b32 v6, v228
    buffer_load_dwordx4 v[32:35], v3, s[20:23], s30 offen offset:0
    buffer_load_dwordx4 v[36:39], v3, s[20:23], s30 offen offset:1024
    buffer_load_dwordx4 v[40:43], v3, s[20:23], s30 offen offset:2048
    buffer_load_dwordx4 v[44:47], v3, s[20:23], s30 offen offset:3072
    v_add_u32 v5, -49920, v5
    v_add_u32 v6, -6144, v6
    s_waitcnt lgkmcnt(0)
    s_barrier
    ds_read_b128 v[160:163], v7 offset:0
    ds_read_b32 v176, v8 offset:0
    ds_read_b128 v[164:167], v7 offset:2080
    ds_read_b32 v177, v8 offset:256
    ds_read_b128 v[168:171], v7 offset:4160
    ds_read_b32 v178, v8 offset:512
    ds_read_b128 v[172:175], v7 offset:6240
    ds_read_b32 v179, v8 offset:768
    ds_read_b64 v[196:197], v11 offset:16384
    ds_read_b64 v[198:199], v11 offset:16416
    ds_read_b64 v[200:201], v11 offset:16448
    ds_read_b64 v[202:203], v11 offset:16480
    s_waitcnt lgkmcnt(4)
    v_pk_add_f32 v[160:161], v[160:161], v[164:165]
    v_pk_add_f32 v[162:163], v[162:163], v[166:167]
    v_add_f32 v176, v176, v177
    v_pk_add_f32 v[168:169], v[168:169], v[172:173]
    v_pk_add_f32 v[170:171], v[170:171], v[174:175]
    v_add_f32 v178, v178, v179
    v_pk_add_f32 v[160:161], v[160:161], v[168:169]
    v_add_f32 v176, v176, v178
    v_pk_add_f32 v[162:163], v[162:163], v[170:171]
    v_add_f32_dpp v160, v160, v160 quad_perm:[1,0,3,2] row_mask:0xf bank_mask:0xf
    v_add_f32_dpp v176, v176, v176 quad_perm:[1,0,3,2] row_mask:0xf bank_mask:0xf
    v_add_f32_dpp v161, v161, v161 quad_perm:[1,0,3,2] row_mask:0xf bank_mask:0xf
    v_add_f32_dpp v162, v162, v162 quad_perm:[1,0,3,2] row_mask:0xf bank_mask:0xf
    v_add_f32_dpp v163, v163, v163 quad_perm:[1,0,3,2] row_mask:0xf bank_mask:0xf
    v_rcp_f32 v177, v176
    v_max3_f32 v178, |v160|, |v161|, |v162|
    v_max_f32 v178, |v163|, v178
    v_cmp_le_f32 s[50:51], s45, v176
    v_cmp_ge_f32 s[52:53], s46, v176
    v_cmp_gt_f32 s[54:55], s47, v178
    v_add_f32 v179, v160, v161
    v_add_f32 v178, v162, v163
    v_cmp_o_f32 s[56:57], v179, v178
    s_and_b64 s[50:51], s[50:51], s[52:53]
    s_and_b64 s[54:55], s[54:55], s[56:57]
    s_and_b64 s[50:51], s[50:51], s[54:55]
    v_pk_mul_f32 v[160:161], v[160:161], v[176:177] op_sel:[0,1] op_sel_hi:[1,1]
    v_pk_mul_f32 v[162:163], v[162:163], v[176:177] op_sel:[0,1] op_sel_hi:[1,1]
    v_cvt_pk_bf16_f32 v160, v160, v161
    v_cvt_pk_bf16_f32 v161, v162, v163
    v_cndmask_b32 v160, 0, v160, s[50:51]
    v_cndmask_b32 v161, 0, v161, s[50:51]
    ds_write_b64 v9, v[160:161] offset:0
    s_cmp_eq_u64 s[50:51], exec
    s_cbranch_scc1 k4b_rokf
    v_mov_b32 v13, s49
    v_cndmask_b32 v13, v13, 0, s[50:51]
    v_or_b32 v12, v12, v13
    v_mov_b32 v14, 132096
    ds_or_b32 v14, v13
k4b_rokf:
    v_add_u32 v9, 8192, v9
    s_and_b32 s37, s49, 5
    s_mov_b32 s37, -33280
    s_cselect_b32 s37, 33280, s37
    v_add_u32 v7, s37, v7
    s_mov_b32 s37, -4096
    s_cselect_b32 s37, 4096, s37
    v_add_u32 v8, s37, v8
    s_lshl_b32 s49, s49, 1
    s_waitcnt lgkmcnt(0)
    s_barrier
    v_mov_b32 v14, 132096
    ds_read_b32 v13, v14
    ds_read_b128 v[144:147], v15 offset:0
    ds_read_b128 v[148:151], v15 offset:512
    ds_read_b128 v[152:155], v15 offset:1024
    ds_read_b128 v[156:159], v15 offset:1536
    s_waitcnt vmcnt(8)
    s_waitcnt lgkmcnt(3)
    v_mfma_f32_16x16x32_bf16 v[240:243], v[112:115], v[144:147], v[240:243]
    v_mfma_f32_16x16x32_bf16 v[244:247], v[128:131], v[144:147], v[244:247]
    s_waitcnt lgkmcnt(2)
    v_mfma_f32_16x16x32_bf16 v[240:243], v[116:119], v[148:151], v[240:243]
    v_mfma_f32_16x16x32_bf16 v[244:247], v[132:135], v[148:151], v[244:247]
    s_waitcnt lgkmcnt(1)
    v_mfma_f32_16x16x32_bf16 v[240:243], v[120:123], v[152:155], v[240:243]
    v_mfma_f32_16x16x32_bf16 v[244:247], v[136:139], v[152:155], v[244:247]
    s_waitcnt lgkmcnt(0)
    v_mfma_f32_16x16x32_bf16 v[240:243], v[124:127], v[156:159], v[240:243]
    v_mfma_f32_16x16x32_bf16 v[244:247], v[140:143], v[156:159], v[244:247]
    s_waitcnt vmcnt(0)
    v_mfma_f32_16x16x32_bf16 v[248:251], v[16:19], v[144:147], v[248:251]
    v_mfma_f32_16x16x32_bf16 v[252:255], v[32:35], v[144:147], v[252:255]
    v_mfma_f32_16x16x32_bf16 v[248:251], v[20:23], v[148:151], v[248:251]
    v_mfma_f32_16x16x32_bf16 v[252:255], v[36:39], v[148:151], v[252:255]
    v_mfma_f32_16x16x32_bf16 v[248:251], v[24:27], v[152:155], v[248:251]
    v_mfma_f32_16x16x32_bf16 v[252:255], v[40:43], v[152:155], v[252:255]
    v_mfma_f32_16x16x32_bf16 v[248:251], v[28:31], v[156:159], v[248:251]
    v_mfma_f32_16x16x32_bf16 v[252:255], v[44:47], v[156:159], v[252:255]
    v_readfirstlane_b32 s48, v13
    s_lshl_b32 s30, s29, 13
    s_mov_b32 s40, 0x00ff00ff
    s_mov_b32 s41, 0x00ff00ff
    s_cmp_lg_u32 s48, 0
    s_cbranch_scc1 k4b_fb
k4b_epi:
    v_lshlrev_b32 v180, 16, v196
    v_and_b32 v181, 0xffff0000, v196
    v_lshlrev_b32 v182, 16, v197
    v_and_b32 v183, 0xffff0000, v197
    v_lshlrev_b32 v184, 16, v198
    v_and_b32 v185, 0xffff0000, v198
    v_lshlrev_b32 v186, 16, v199
    v_and_b32 v187, 0xffff0000, v199
    v_lshlrev_b32 v188, 16, v200
    v_and_b32 v189, 0xffff0000, v200
    v_lshlrev_b32 v190, 16, v201
    v_and_b32 v191, 0xffff0000, v201
    v_lshlrev_b32 v192, 16, v202
    v_and_b32 v193, 0xffff0000, v202
    v_lshlrev_b32 v194, 16, v203
    v_and_b32 v195, 0xffff0000, v203
    v_pk_add_f32 v[180:181], v[180:181], v[240:241]
    v_pk_add_f32 v[182:183], v[182:183], v[242:243]
    v_pk_add_f32 v[184:185], v[184:185], v[244:245]
    v_pk_add_f32 v[186:187], v[186:187], v[246:247]
    v_pk_add_f32 v[188:189], v[188:189], v[248:249]
    v_pk_add_f32 v[190:191], v[190:191], v[250:251]
    v_pk_add_f32 v[192:193], v[192:193], v[252:253]
    v_pk_add_f32 v[194:195], v[194:195], v[254:255]
    v_cvt_pk_bf16_f32 v196, v180, v181
    v_cvt_pk_bf16_f32 v197, v182, v183
    v_cvt_pk_bf16_f32 v198, v184, v185
    v_cvt_pk_bf16_f32 v199, v186, v187
    v_cvt_pk_bf16_f32 v200, v188, v189
    v_cvt_pk_bf16_f32 v201, v190, v191
    v_cvt_pk_bf16_f32 v202, v192, v193
    v_cvt_pk_bf16_f32 v203, v194, v195
    v_and_b32 v208, 7, v2
    v_lshlrev_b32 v208, 10, v208
    v_bfe_u32 v209, v2, 3, 2
    v_lshl_add_u32 v208, v209, 5, v208
    v_lshrrev_b32 v209, 5, v2
    v_lshl_add_u32 v208, v209, 4, v208
    s_lshl_b32 s31, s3, 7
    s_add_u32 s31, s31, s30
    v_permlane16_swap_b32 v196, v200
    v_permlane16_swap_b32 v197, v201
    v_permlane16_swap_b32 v198, v202
    v_permlane16_swap_b32 v199, v203
    v_cndmask_b32 v204, v198, v196, s[40:41]
    v_cndmask_b32 v205, v199, v197, s[40:41]
    v_cndmask_b32 v206, v202, v200, s[40:41]
    v_cndmask_b32 v207, v203, v201, s[40:41]
    buffer_store_dwordx4 v[204:207], v208, s[24:27], s31 offen
k4b_end:
    s_endpgm
k4b_wsa:
    s_setprio 0
    s_sleep 1
    ds_read_b32 v14, v0
    s_waitcnt lgkmcnt(0)
    v_readfirstlane_b32 s37, v14
    s_cmp_ge_u32 s37, s76
    s_cbranch_scc0 k4b_wsa
    s_branch k4b_woa
k4b_wsb:
    s_setprio 0
    s_sleep 1
    ds_read_b32 v14, v0
    s_waitcnt lgkmcnt(0)
    v_readfirstlane_b32 s37, v14
    s_cmp_ge_u32 s37, s76
    s_cbranch_scc0 k4b_wsb
    s_setprio 1
    s_branch k4b_wob
k4b_rts:
    s_add_u32 s70, s70, 1
    s_cmp_gt_u32 s70, 0x40000
    s_cbranch_scc1 k4b_oks
    s_sleep 1
    buffer_load_dwordx4 v[16:19], v3, s[20:23], s60 offen offset:0 sc1
    s_waitcnt vmcnt(0)
    s_branch k4b_cks
k4b_rt0:
    s_add_u32 s70, s70, 1
    s_cmp_gt_u32 s70, 0x40000
    s_cbranch_scc1 k4b_ok0
    s_sleep 1
    buffer_load_dwordx4 v[20:23], v3, s[20:23], s60 offen offset:1024 sc1
    s_mov_b64 exec, s[40:41]
    buffer_load_dwordx4 v[48:51], v0, s[20:23], s62 offen offset:0 sc1
    buffer_load_dwordx4 v[52:55], v0, s[20:23], s62 offen offset:512 sc1
    s_mov_b64 exec, -1
    s_waitcnt vmcnt(0)
    s_branch k4b_ck0
k4b_rt1:
    s_add_u32 s70, s70, 1
    s_cmp_gt_u32 s70, 0x40000
    s_cbranch_scc1 k4b_ok1
    s_sleep 1
    buffer_load_dwordx4 v[24:27], v3, s[20:23], s60 offen offset:2048 sc1
    s_mov_b64 exec, s[40:41]
    buffer_load_dwordx4 v[56:59], v0, s[20:23], s62 offen offset:1024 sc1
    buffer_load_dwordx4 v[60:63], v0, s[20:23], s62 offen offset:1536 sc1
    s_mov_b64 exec, -1
    s_waitcnt vmcnt(0)
    s_branch k4b_ck1
k4b_rt2:
    s_add_u32 s70, s70, 1
    s_cmp_gt_u32 s70, 0x40000
    s_cbranch_scc1 k4b_ok2
    s_sleep 1
    buffer_load_dwordx4 v[28:31], v3, s[20:23], s60 offen offset:3072 sc1
    s_mov_b64 exec, s[40:41]
    buffer_load_dwordx4 v[64:67], v0, s[20:23], s62 offen offset:2048 sc1
    buffer_load_dwordx4 v[68:71], v0, s[20:23], s62 offen offset:2560 sc1
    s_mov_b64 exec, -1
    s_waitcnt vmcnt(0)
    s_branch k4b_ck2
k4b_rt3:
    s_add_u32 s70, s70, 1
    s_cmp_gt_u32 s70, 0x40000
    s_cbranch_scc1 k4b_ok3
    s_sleep 1
    buffer_load_dwordx4 v[32:35], v3, s[20:23], s61 offen offset:0 sc1
    s_mov_b64 exec, s[40:41]
    buffer_load_dwordx4 v[72:75], v0, s[20:23], s62 offen offset:3072 sc1
    buffer_load_dwordx4 v[76:79], v0, s[20:23], s62 offen offset:3584 sc1
    s_mov_b64 exec, -1
    s_waitcnt vmcnt(0)
    s_branch k4b_ck3
k4b_rt4:
    s_add_u32 s70, s70, 1
    s_cmp_gt_u32 s70, 0x40000
    s_cbranch_scc1 k4b_ok4
    s_sleep 1
    buffer_load_dwordx4 v[36:39], v3, s[20:23], s61 offen offset:1024 sc1
    s_mov_b64 exec, s[40:41]
    buffer_load_dwordx4 v[80:83], v0, s[20:23], s63 offen offset:0 sc1
    buffer_load_dwordx4 v[84:87], v0, s[20:23], s63 offen offset:512 sc1
    s_mov_b64 exec, -1
    s_waitcnt vmcnt(0)
    s_branch k4b_ck4
k4b_rt5:
    s_add_u32 s70, s70, 1
    s_cmp_gt_u32 s70, 0x40000
    s_cbranch_scc1 k4b_ok5
    s_sleep 1
    buffer_load_dwordx4 v[40:43], v3, s[20:23], s61 offen offset:2048 sc1
    s_mov_b64 exec, s[40:41]
    buffer_load_dwordx4 v[88:91], v0, s[20:23], s63 offen offset:1024 sc1
    buffer_load_dwordx4 v[92:95], v0, s[20:23], s63 offen offset:1536 sc1
    s_mov_b64 exec, -1
    s_waitcnt vmcnt(0)
    s_branch k4b_ck5
k4b_rt6:
    s_add_u32 s70, s70, 1
    s_cmp_gt_u32 s70, 0x40000
    s_cbranch_scc1 k4b_ok6
    s_sleep 1
    buffer_load_dwordx4 v[44:47], v3, s[20:23], s61 offen offset:3072 sc1
    s_mov_b64 exec, s[40:41]
    buffer_load_dwordx4 v[96:99], v0, s[20:23], s63 offen offset:2048 sc1
    buffer_load_dwordx4 v[100:103], v0, s[20:23], s63 offen offset:2560 sc1
    s_mov_b64 exec, -1
    s_waitcnt vmcnt(0)
    s_branch k4b_ck6
k4b_rt7:
    s_add_u32 s70, s70, 1
    s_cmp_gt_u32 s70, 0x40000
    s_cbranch_scc1 k4b_ok7
    s_sleep 1
    s_mov_b64 exec, s[40:41]
    buffer_load_dwordx4 v[104:107], v0, s[20:23], s63 offen offset:3072 sc1
    buffer_load_dwordx4 v[108:111], v0, s[20:23], s63 offen offset:3584 sc1
    s_mov_b64 exec, -1
    s_waitcnt vmcnt(0)
    s_branch k4b_ck7
k4b_fb:
    buffer_load_dwordx4 v[16:19], v3, s[20:23], s60 offen offset:0 sc1
    buffer_load_dwordx4 v[20:23], v3, s[20:23], s60 offen offset:1024 sc1
    buffer_load_dwordx4 v[24:27], v3, s[20:23], s60 offen offset:2048 sc1
    buffer_load_dwordx4 v[28:31], v3, s[20:23], s60 offen offset:3072 sc1
    buffer_load_dwordx4 v[32:35], v3, s[20:23], s61 offen offset:0 sc1
    buffer_load_dwordx4 v[36:39], v3, s[20:23], s61 offen offset:1024 sc1
    buffer_load_dwordx4 v[40:43], v3, s[20:23], s61 offen offset:2048 sc1
    buffer_load_dwordx4 v[44:47], v3, s[20:23], s61 offen offset:3072 sc1
    v_subrev_u32 v4, 9216, v4
    v_subrev_u32 v9, 8192, v9
    v_add_u32 v15, 49152, v10
    v_add_u32 v5, 33280, v5
    v_add_u32 v6, 4096, v6
    v_add_u32 v7, 33280, v7
    v_add_u32 v8, 4096, v8
    s_lshl_b32 s59, s3, 16
    s_add_u32 s59, s59, 0x900000
    s_mov_b32 s49, 1
    s_lshl_b32 s66, s3, 8
    s_add_u32 s66, s66, 132160
    s_waitcnt vmcnt(0)
k4b_fbg:
    s_and_b32 s37, s48, s49
    s_cbranch_scc0 k4b_fbn
    s_barrier
    s_mov_b32 s37, 0
k4b_fb1:
    v_add_u32 v13, s37, v4
    ds_read_b128 v[236:239], v13
    v_mov_b32 v14, 0xff800000
    s_waitcnt lgkmcnt(0)
    v_mfma_f32_32x32x16_bf16 v[180:195], v[16:19], v[236:239], 0
    s_nop 11
    v_max3_f32 v14, v14, v180, v181
    v_max3_f32 v14, v14, v182, v183
    v_max3_f32 v14, v14, v184, v185
    v_max3_f32 v14, v14, v186, v187
    v_max3_f32 v14, v14, v188, v189
    v_max3_f32 v14, v14, v190, v191
    v_max3_f32 v14, v14, v192, v193
    v_max3_f32 v14, v14, v194, v195
    v_mfma_f32_32x32x16_bf16 v[180:195], v[20:23], v[236:239], 0
    s_nop 11
    v_max3_f32 v14, v14, v180, v181
    v_max3_f32 v14, v14, v182, v183
    v_max3_f32 v14, v14, v184, v185
    v_max3_f32 v14, v14, v186, v187
    v_max3_f32 v14, v14, v188, v189
    v_max3_f32 v14, v14, v190, v191
    v_max3_f32 v14, v14, v192, v193
    v_max3_f32 v14, v14, v194, v195
    v_mfma_f32_32x32x16_bf16 v[180:195], v[24:27], v[236:239], 0
    s_nop 11
    v_max3_f32 v14, v14, v180, v181
    v_max3_f32 v14, v14, v182, v183
    v_max3_f32 v14, v14, v184, v185
    v_max3_f32 v14, v14, v186, v187
    v_max3_f32 v14, v14, v188, v189
    v_max3_f32 v14, v14, v190, v191
    v_max3_f32 v14, v14, v192, v193
    v_max3_f32 v14, v14, v194, v195
    v_mfma_f32_32x32x16_bf16 v[180:195], v[28:31], v[236:239], 0
    s_nop 11
    v_max3_f32 v14, v14, v180, v181
    v_max3_f32 v14, v14, v182, v183
    v_max3_f32 v14, v14, v184, v185
    v_max3_f32 v14, v14, v186, v187
    v_max3_f32 v14, v14, v188, v189
    v_max3_f32 v14, v14, v190, v191
    v_max3_f32 v14, v14, v192, v193
    v_max3_f32 v14, v14, v194, v195
    v_mfma_f32_32x32x16_bf16 v[180:195], v[32:35], v[236:239], 0
    s_nop 11
    v_max3_f32 v14, v14, v180, v181
    v_max3_f32 v14, v14, v182, v183
    v_max3_f32 v14, v14, v184, v185
    v_max3_f32 v14, v14, v186, v187
    v_max3_f32 v14, v14, v188, v189
    v_max3_f32 v14, v14, v190, v191
    v_max3_f32 v14, v14, v192, v193
    v_max3_f32 v14, v14, v194, v195
    v_mfma_f32_32x32x16_bf16 v[180:195], v[36:39], v[236:239], 0
    s_nop 11
    v_max3_f32 v14, v14, v180, v181
    v_max3_f32 v14, v14, v182, v183
    v_max3_f32 v14, v14, v184, v185
    v_max3_f32 v14, v14, v186, v187
    v_max3_f32 v14, v14, v188, v189
    v_max3_f32 v14, v14, v190, v191
    v_max3_f32 v14, v14, v192, v193
    v_max3_f32 v14, v14, v194, v195
    v_mfma_f32_32x32x16_bf16 v[180:195], v[40:43], v[236:239], 0
    s_nop 11
    v_max3_f32 v14, v14, v180, v181
    v_max3_f32 v14, v14, v182, v183
    v_max3_f32 v14, v14, v184, v185
    v_max3_f32 v14, v14, v186, v187
    v_max3_f32 v14, v14, v188, v189
    v_max3_f32 v14, v14, v190, v191
    v_max3_f32 v14, v14, v192, v193
    v_max3_f32 v14, v14, v194, v195
    v_mfma_f32_32x32x16_bf16 v[180:195], v[44:47], v[236:239], 0
    s_nop 11
    v_max3_f32 v14, v14, v180, v181
    v_max3_f32 v14, v14, v182, v183
    v_max3_f32 v14, v14, v184, v185
    v_max3_f32 v14, v14, v186, v187
    v_max3_f32 v14, v14, v188, v189
    v_max3_f32 v14, v14, v190, v191
    v_max3_f32 v14, v14, v192, v193
    v_max3_f32 v14, v14, v194, v195
    v_mov_b32 v13, v14
    s_nop 1
    v_permlane32_swap_b32 v14, v13
    v_max_f32 v14, v14, v13
    s_lshl_b32 s38, s37, 1
    s_add_u32 s38, s38, s66
    v_lshl_add_u32 v13, v2, 2, s38
    ds_write_b32 v13, v14
    s_add_u32 s37, s37, 1024
    s_cmp_lt_u32 s37, 2048
    s_cbranch_scc1 k4b_fb1
    s_waitcnt lgkmcnt(0)
    s_barrier
    s_mov_b32 s37, 0
k4b_fb2:
    v_add_u32 v13, s37, v4
    ds_read_b128 v[236:239], v13
    s_lshl_b32 s38, s37, 1
    s_add_u32 s38, s38, 132160
    v_lshl_add_u32 v13, v2, 2, s38
    ds_read_b32 v180, v13 offset:0
    ds_read_b32 v181, v13 offset:256
    ds_read_b32 v182, v13 offset:512
    ds_read_b32 v183, v13 offset:768
    ds_read_b32 v184, v13 offset:1024
    ds_read_b32 v185, v13 offset:1280
    ds_read_b32 v186, v13 offset:1536
    ds_read_b32 v187, v13 offset:1792
    s_waitcnt lgkmcnt(0)
    v_max3_f32 v14, v180, v181, v182
    v_max3_f32 v14, v14, v183, v184
    v_max3_f32 v14, v14, v185, v186
    v_max_f32 v14, v14, v187
    v_sub_f32 v160, 0, v14
    v_sub_f32 v161, 0, v14
    v_sub_f32 v162, 0, v14
    v_sub_f32 v163, 0, v14
    v_sub_f32 v164, 0, v14
    v_sub_f32 v165, 0, v14
    v_sub_f32 v166, 0, v14
    v_sub_f32 v167, 0, v14
    v_sub_f32 v168, 0, v14
    v_sub_f32 v169, 0, v14
    v_sub_f32 v170, 0, v14
    v_sub_f32 v171, 0, v14
    v_sub_f32 v172, 0, v14
    v_sub_f32 v173, 0, v14
    v_sub_f32 v174, 0, v14
    v_sub_f32 v175, 0, v14
    s_nop 1
    v_mfma_f32_32x32x16_bf16 v[180:195], v[16:19], v[236:239], v[160:175]
    s_nop 11
    v_exp_f32 v180, v180
    v_exp_f32 v181, v181
    v_exp_f32 v182, v182
    v_exp_f32 v183, v183
    v_exp_f32 v184, v184
    v_exp_f32 v185, v185
    v_exp_f32 v186, v186
    v_exp_f32 v187, v187
    v_exp_f32 v188, v188
    v_exp_f32 v189, v189
    v_exp_f32 v190, v190
    v_exp_f32 v191, v191
    v_exp_f32 v192, v192
    v_exp_f32 v193, v193
    v_exp_f32 v194, v194
    v_exp_f32 v195, v195
    v_cvt_pk_bf16_f32 v212, v180, v181
    v_cvt_pk_bf16_f32 v213, v182, v183
    v_cvt_pk_bf16_f32 v214, v184, v185
    v_cvt_pk_bf16_f32 v215, v186, v187
    v_cvt_pk_bf16_f32 v216, v188, v189
    v_cvt_pk_bf16_f32 v217, v190, v191
    v_cvt_pk_bf16_f32 v218, v192, v193
    v_cvt_pk_bf16_f32 v219, v194, v195
    v_mfma_f32_32x32x16_bf16 v[220:235], v[48:51], v[212:215], 0
    s_nop 0
    v_mfma_f32_32x32x16_bf16 v[220:235], v[52:55], v[216:219], v[220:235]
    v_mfma_f32_32x32x16_bf16 v[180:195], v[20:23], v[236:239], v[160:175]
    s_nop 11
    v_exp_f32 v180, v180
    v_exp_f32 v181, v181
    v_exp_f32 v182, v182
    v_exp_f32 v183, v183
    v_exp_f32 v184, v184
    v_exp_f32 v185, v185
    v_exp_f32 v186, v186
    v_exp_f32 v187, v187
    v_exp_f32 v188, v188
    v_exp_f32 v189, v189
    v_exp_f32 v190, v190
    v_exp_f32 v191, v191
    v_exp_f32 v192, v192
    v_exp_f32 v193, v193
    v_exp_f32 v194, v194
    v_exp_f32 v195, v195
    v_cvt_pk_bf16_f32 v212, v180, v181
    v_cvt_pk_bf16_f32 v213, v182, v183
    v_cvt_pk_bf16_f32 v214, v184, v185
    v_cvt_pk_bf16_f32 v215, v186, v187
    v_cvt_pk_bf16_f32 v216, v188, v189
    v_cvt_pk_bf16_f32 v217, v190, v191
    v_cvt_pk_bf16_f32 v218, v192, v193
    v_cvt_pk_bf16_f32 v219, v194, v195
    v_mfma_f32_32x32x16_bf16 v[220:235], v[56:59], v[212:215], v[220:235]
    s_nop 0
    v_mfma_f32_32x32x16_bf16 v[220:235], v[60:63], v[216:219], v[220:235]
    v_mfma_f32_32x32x16_bf16 v[180:195], v[24:27], v[236:239], v[160:175]
    s_nop 11
    v_exp_f32 v180, v180
    v_exp_f32 v181, v181
    v_exp_f32 v182, v182
    v_exp_f32 v183, v183
    v_exp_f32 v184, v184
    v_exp_f32 v185, v185
    v_exp_f32 v186, v186
    v_exp_f32 v187, v187
    v_exp_f32 v188, v188
    v_exp_f32 v189, v189
    v_exp_f32 v190, v190
    v_exp_f32 v191, v191
    v_exp_f32 v192, v192
    v_exp_f32 v193, v193
    v_exp_f32 v194, v194
    v_exp_f32 v195, v195
    v_cvt_pk_bf16_f32 v212, v180, v181
    v_cvt_pk_bf16_f32 v213, v182, v183
    v_cvt_pk_bf16_f32 v214, v184, v185
    v_cvt_pk_bf16_f32 v215, v186, v187
    v_cvt_pk_bf16_f32 v216, v188, v189
    v_cvt_pk_bf16_f32 v217, v190, v191
    v_cvt_pk_bf16_f32 v218, v192, v193
    v_cvt_pk_bf16_f32 v219, v194, v195
    v_mfma_f32_32x32x16_bf16 v[220:235], v[64:67], v[212:215], v[220:235]
    s_nop 0
    v_mfma_f32_32x32x16_bf16 v[220:235], v[68:71], v[216:219], v[220:235]
    v_mfma_f32_32x32x16_bf16 v[180:195], v[28:31], v[236:239], v[160:175]
    s_nop 11
    v_exp_f32 v180, v180
    v_exp_f32 v181, v181
    v_exp_f32 v182, v182
    v_exp_f32 v183, v183
    v_exp_f32 v184, v184
    v_exp_f32 v185, v185
    v_exp_f32 v186, v186
    v_exp_f32 v187, v187
    v_exp_f32 v188, v188
    v_exp_f32 v189, v189
    v_exp_f32 v190, v190
    v_exp_f32 v191, v191
    v_exp_f32 v192, v192
    v_exp_f32 v193, v193
    v_exp_f32 v194, v194
    v_exp_f32 v195, v195
    v_cvt_pk_bf16_f32 v212, v180, v181
    v_cvt_pk_bf16_f32 v213, v182, v183
    v_cvt_pk_bf16_f32 v214, v184, v185
    v_cvt_pk_bf16_f32 v215, v186, v187
    v_cvt_pk_bf16_f32 v216, v188, v189
    v_cvt_pk_bf16_f32 v217, v190, v191
    v_cvt_pk_bf16_f32 v218, v192, v193
    v_cvt_pk_bf16_f32 v219, v194, v195
    v_mfma_f32_32x32x16_bf16 v[220:235], v[72:75], v[212:215], v[220:235]
    s_nop 0
    v_mfma_f32_32x32x16_bf16 v[220:235], v[76:79], v[216:219], v[220:235]
    v_mfma_f32_32x32x16_bf16 v[180:195], v[32:35], v[236:239], v[160:175]
    s_nop 11
    v_exp_f32 v180, v180
    v_exp_f32 v181, v181
    v_exp_f32 v182, v182
    v_exp_f32 v183, v183
    v_exp_f32 v184, v184
    v_exp_f32 v185, v185
    v_exp_f32 v186, v186
    v_exp_f32 v187, v187
    v_exp_f32 v188, v188
    v_exp_f32 v189, v189
    v_exp_f32 v190, v190
    v_exp_f32 v191, v191
    v_exp_f32 v192, v192
    v_exp_f32 v193, v193
    v_exp_f32 v194, v194
    v_exp_f32 v195, v195
    v_cvt_pk_bf16_f32 v212, v180, v181
    v_cvt_pk_bf16_f32 v213, v182, v183
    v_cvt_pk_bf16_f32 v214, v184, v185
    v_cvt_pk_bf16_f32 v215, v186, v187
    v_cvt_pk_bf16_f32 v216, v188, v189
    v_cvt_pk_bf16_f32 v217, v190, v191
    v_cvt_pk_bf16_f32 v218, v192, v193
    v_cvt_pk_bf16_f32 v219, v194, v195
    v_mfma_f32_32x32x16_bf16 v[220:235], v[80:83], v[212:215], v[220:235]
    s_nop 0
    v_mfma_f32_32x32x16_bf16 v[220:235], v[84:87], v[216:219], v[220:235]
    v_mfma_f32_32x32x16_bf16 v[180:195], v[36:39], v[236:239], v[160:175]
    s_nop 11
    v_exp_f32 v180, v180
    v_exp_f32 v181, v181
    v_exp_f32 v182, v182
    v_exp_f32 v183, v183
    v_exp_f32 v184, v184
    v_exp_f32 v185, v185
    v_exp_f32 v186, v186
    v_exp_f32 v187, v187
    v_exp_f32 v188, v188
    v_exp_f32 v189, v189
    v_exp_f32 v190, v190
    v_exp_f32 v191, v191
    v_exp_f32 v192, v192
    v_exp_f32 v193, v193
    v_exp_f32 v194, v194
    v_exp_f32 v195, v195
    v_cvt_pk_bf16_f32 v212, v180, v181
    v_cvt_pk_bf16_f32 v213, v182, v183
    v_cvt_pk_bf16_f32 v214, v184, v185
    v_cvt_pk_bf16_f32 v215, v186, v187
    v_cvt_pk_bf16_f32 v216, v188, v189
    v_cvt_pk_bf16_f32 v217, v190, v191
    v_cvt_pk_bf16_f32 v218, v192, v193
    v_cvt_pk_bf16_f32 v219, v194, v195
    v_mfma_f32_32x32x16_bf16 v[220:235], v[88:91], v[212:215], v[220:235]
    s_nop 0
    v_mfma_f32_32x32x16_bf16 v[220:235], v[92:95], v[216:219], v[220:235]
    v_mfma_f32_32x32x16_bf16 v[180:195], v[40:43], v[236:239], v[160:175]
    s_nop 11
    v_exp_f32 v180, v180
    v_exp_f32 v181, v181
    v_exp_f32 v182, v182
    v_exp_f32 v183, v183
    v_exp_f32 v184, v184
    v_exp_f32 v185, v185
    v_exp_f32 v186, v186
    v_exp_f32 v187, v187
    v_exp_f32 v188, v188
    v_exp_f32 v189, v189
    v_exp_f32 v190, v190
    v_exp_f32 v191, v191
    v_exp_f32 v192, v192
    v_exp_f32 v193, v193
    v_exp_f32 v194, v194
    v_exp_f32 v195, v195
    v_cvt_pk_bf16_f32 v212, v180, v181
    v_cvt_pk_bf16_f32 v213, v182, v183
    v_cvt_pk_bf16_f32 v214, v184, v185
    v_cvt_pk_bf16_f32 v215, v186, v187
    v_cvt_pk_bf16_f32 v216, v188, v189
    v_cvt_pk_bf16_f32 v217, v190, v191
    v_cvt_pk_bf16_f32 v218, v192, v193
    v_cvt_pk_bf16_f32 v219, v194, v195
    v_mfma_f32_32x32x16_bf16 v[220:235], v[96:99], v[212:215], v[220:235]
    s_nop 0
    v_mfma_f32_32x32x16_bf16 v[220:235], v[100:103], v[216:219], v[220:235]
    v_mfma_f32_32x32x16_bf16 v[180:195], v[44:47], v[236:239], v[160:175]
    s_nop 11
    v_exp_f32 v180, v180
    v_exp_f32 v181, v181
    v_exp_f32 v182, v182
    v_exp_f32 v183, v183
    v_exp_f32 v184, v184
    v_exp_f32 v185, v185
    v_exp_f32 v186, v186
    v_exp_f32 v187, v187
    v_exp_f32 v188, v188
    v_exp_f32 v189, v189
    v_exp_f32 v190, v190
    v_exp_f32 v191, v191
    v_exp_f32 v192, v192
    v_exp_f32 v193, v193
    v_exp_f32 v194, v194
    v_exp_f32 v195, v195
    v_cvt_pk_bf16_f32 v212, v180, v181
    v_cvt_pk_bf16_f32 v213, v182, v183
    v_cvt_pk_bf16_f32 v214, v184, v185
    v_cvt_pk_bf16_f32 v215, v186, v187
    v_cvt_pk_bf16_f32 v216, v188, v189
    v_cvt_pk_bf16_f32 v217, v190, v191
    v_cvt_pk_bf16_f32 v218, v192, v193
    v_cvt_pk_bf16_f32 v219, v194, v195
    v_mfma_f32_32x32x16_bf16 v[220:235], v[104:107], v[212:215], v[220:235]
    s_nop 0
    v_mfma_f32_32x32x16_bf16 v[220:235], v[108:111], v[216:219], v[220:235]
    s_lshr_b32 s38, s37, 10
    s_mul_i32 s39, s38, 16640
    v_add_u32 v13, s39, v5
    s_lshl_b32 s39, s38, 11
    v_add_u32 v14, s39, v6
    s_nop 6
    ds_write_b128 v13, v[220:223]
    ds_write_b128 v13, v[224:227] offset:1024
    ds_write_b32 v14, v228
    s_add_u32 s37, s37, 1024
    s_cmp_lt_u32 s37, 2048
    s_cbranch_scc1 k4b_fb2
    s_mov_b32 s31, s59
    s_waitcnt lgkmcnt(0)
    buffer_load_dwordx4 v[112:115], v3, s[20:23], s31 offen offset:0
    buffer_load_dwordx4 v[116:119], v3, s[20:23], s31 offen offset:1024
    buffer_load_dwordx4 v[120:123], v3, s[20:23], s31 offen offset:2048
    buffer_load_dwordx4 v[124:127], v3, s[20:23], s31 offen offset:3072
    s_add_u32 s31, s31, 4096
    buffer_load_dwordx4 v[128:131], v3, s[20:23], s31 offen offset:0
    buffer_load_dwordx4 v[132:135], v3, s[20:23], s31 offen offset:1024
    buffer_load_dwordx4 v[136:139], v3, s[20:23], s31 offen offset:2048
    buffer_load_dwordx4 v[140:143], v3, s[20:23], s31 offen offset:3072
    s_add_u32 s31, s31, 4096
    buffer_load_dwordx4 v[180:183], v3, s[20:23], s31 offen offset:0
    buffer_load_dwordx4 v[184:187], v3, s[20:23], s31 offen offset:1024
    buffer_load_dwordx4 v[188:191], v3, s[20:23], s31 offen offset:2048
    buffer_load_dwordx4 v[192:195], v3, s[20:23], s31 offen offset:3072
    s_add_u32 s31, s31, 4096
    buffer_load_dwordx4 v[220:223], v3, s[20:23], s31 offen offset:0
    buffer_load_dwordx4 v[224:227], v3, s[20:23], s31 offen offset:1024
    buffer_load_dwordx4 v[228:231], v3, s[20:23], s31 offen offset:2048
    buffer_load_dwordx4 v[232:235], v3, s[20:23], s31 offen offset:3072
    s_barrier
    ds_read_b128 v[160:163], v7 offset:0
    ds_read_b32 v176, v8 offset:0
    ds_read_b128 v[164:167], v7 offset:2080
    ds_read_b32 v177, v8 offset:256
    ds_read_b128 v[168:171], v7 offset:4160
    ds_read_b32 v178, v8 offset:512
    ds_read_b128 v[172:175], v7 offset:6240
    ds_read_b32 v179, v8 offset:768
    s_waitcnt lgkmcnt(0)
    v_pk_add_f32 v[160:161], v[160:161], v[164:165]
    v_pk_add_f32 v[162:163], v[162:163], v[166:167]
    v_add_f32 v176, v176, v177
    v_pk_add_f32 v[168:169], v[168:169], v[172:173]
    v_pk_add_f32 v[170:171], v[170:171], v[174:175]
    v_add_f32 v178, v178, v179
    v_pk_add_f32 v[160:161], v[160:161], v[168:169]
    v_add_f32 v176, v176, v178
    v_pk_add_f32 v[162:163], v[162:163], v[170:171]
    v_add_f32_dpp v160, v160, v160 quad_perm:[1,0,3,2] row_mask:0xf bank_mask:0xf
    v_add_f32_dpp v176, v176, v176 quad_perm:[1,0,3,2] row_mask:0xf bank_mask:0xf
    v_add_f32_dpp v161, v161, v161 quad_perm:[1,0,3,2] row_mask:0xf bank_mask:0xf
    v_add_f32_dpp v162, v162, v162 quad_perm:[1,0,3,2] row_mask:0xf bank_mask:0xf
    v_add_f32_dpp v163, v163, v163 quad_perm:[1,0,3,2] row_mask:0xf bank_mask:0xf
    v_rcp_f32 v177, v176
    v_and_b32 v178, s49, v12
    v_cmp_ne_u32 s[50:51], 0, v178
    v_pk_mul_f32 v[160:161], v[160:161], v[176:177] op_sel:[0,1] op_sel_hi:[1,1]
    v_pk_mul_f32 v[162:163], v[162:163], v[176:177] op_sel:[0,1] op_sel_hi:[1,1]
    v_cvt_pk_bf16_f32 v160, v160, v161
    v_cvt_pk_bf16_f32 v161, v162, v163
    v_cndmask_b32 v160, 0, v160, s[50:51]
    v_cndmask_b32 v161, 0, v161, s[50:51]
    ds_write_b64 v9, v[160:161] offset:0
    s_waitcnt lgkmcnt(0)
    s_barrier
    ds_read_b128 v[144:147], v15 offset:0
    ds_read_b128 v[148:151], v15 offset:512
    ds_read_b128 v[152:155], v15 offset:1024
    ds_read_b128 v[156:159], v15 offset:1536
    s_waitcnt vmcnt(8)
    s_waitcnt lgkmcnt(3)
    v_mfma_f32_16x16x32_bf16 v[240:243], v[112:115], v[144:147], v[240:243]
    v_mfma_f32_16x16x32_bf16 v[244:247], v[128:131], v[144:147], v[244:247]
    s_waitcnt lgkmcnt(2)
    v_mfma_f32_16x16x32_bf16 v[240:243], v[116:119], v[148:151], v[240:243]
    v_mfma_f32_16x16x32_bf16 v[244:247], v[132:135], v[148:151], v[244:247]
    s_waitcnt lgkmcnt(1)
    v_mfma_f32_16x16x32_bf16 v[240:243], v[120:123], v[152:155], v[240:243]
    v_mfma_f32_16x16x32_bf16 v[244:247], v[136:139], v[152:155], v[244:247]
    s_waitcnt lgkmcnt(0)
    v_mfma_f32_16x16x32_bf16 v[240:243], v[124:127], v[156:159], v[240:243]
    v_mfma_f32_16x16x32_bf16 v[244:247], v[140:143], v[156:159], v[244:247]
    s_waitcnt vmcnt(0)
    v_mfma_f32_16x16x32_bf16 v[248:251], v[180:183], v[144:147], v[248:251]
    v_mfma_f32_16x16x32_bf16 v[252:255], v[220:223], v[144:147], v[252:255]
    v_mfma_f32_16x16x32_bf16 v[248:251], v[184:187], v[148:151], v[248:251]
    v_mfma_f32_16x16x32_bf16 v[252:255], v[224:227], v[148:151], v[252:255]
    v_mfma_f32_16x16x32_bf16 v[248:251], v[188:191], v[152:155], v[248:251]
    v_mfma_f32_16x16x32_bf16 v[252:255], v[228:231], v[152:155], v[252:255]
    v_mfma_f32_16x16x32_bf16 v[248:251], v[192:195], v[156:159], v[248:251]
    v_mfma_f32_16x16x32_bf16 v[252:255], v[232:235], v[156:159], v[252:255]
k4b_fbn:
    v_add_u32 v4, 2048, v4
    s_add_u32 s59, s59, 16384
    s_lshl_b32 s49, s49, 1
    s_cmp_lt_u32 s49, 16
    s_cbranch_scc1 k4b_fbg
    s_waitcnt lgkmcnt(0)
    s_barrier
    s_branch k4b_epi
.section .rodata,"a"
.p2align 6
.amdhsa_kernel k0_kernel
  .amdhsa_next_free_vgpr 112
  .amdhsa_next_free_sgpr 56
  .amdhsa_accum_offset 112
  .amdhsa_group_segment_fixed_size 0
  .amdhsa_kernarg_size 88
  .amdhsa_user_sgpr_count 2
  .amdhsa_user_sgpr_kernarg_segment_ptr 1
  .amdhsa_system_sgpr_workgroup_id_x 1
.end_amdhsa_kernel
.p2align 6
.amdhsa_kernel k4a_kernel
  .amdhsa_next_free_vgpr 256
  .amdhsa_next_free_sgpr 97
  .amdhsa_accum_offset 256
  .amdhsa_group_segment_fixed_size 0
  .amdhsa_kernarg_size 88
  .amdhsa_user_sgpr_count 2
  .amdhsa_user_sgpr_kernarg_segment_ptr 1
  .amdhsa_system_sgpr_workgroup_id_x 1
.end_amdhsa_kernel
```
